```python
import torch

def _softmax(x, axis=-1):
    return torch.softmax(x, dim=axis)

def _gelu(x):
    return torch.nn.functional.gelu(x, approximate='tanh')

def _silu(x):
    return torch.nn.functional.silu(x)

def _sigmoid(x):
    return torch.sigmoid(x)

def _layernorm(x, axis=-1, eps=1e-05):
    m = x.mean(dim=axis, keepdim=True)
    v = x.var(dim=axis, keepdim=True, unbiased=False)
    return (x - m) / torch.sqrt(v + eps)

def _scatter_add(tgt, idx, src, axis=0):
    return tgt.clone().index_add_(axis, idx, src)

def _segment_sum(src, seg, n):
    out = torch.zeros((n,) + src.shape[1:], dtype=src.dtype)
    return out.index_add_(0, seg, src)

def _pad(x, pw):
    flat = tuple((v for pair in reversed(pw) for v in pair))
    return torch.nn.functional.pad(x, flat)
kernel_name = 'adaLN_cond__memory_aug_recurrent_mem_tr__geglu_ffn__prompt'

def setup_inputs():

    _w = lambda a: (lambda t: t.to(torch.bfloat16) if t.is_floating_point() else t)(torch.as_tensor(a))

    def _A_setup():
        B, S, Dm = (1, 2048, 512)
        H, Dh = (32, 128)
        M, seg = (8, 32)
        seg = min(seg, S)
        S = S // seg * seg
        return {'x': _w((lambda *s: torch.randn(*s, dtype=torch.bfloat16) * 0.05)(B, S, Dm)), 'mem0': _w((lambda *s: torch.randn(*s, dtype=torch.bfloat16) * 0.4)(B, M, Dm)), 'Wq': _w((lambda *s: torch.randn(*s, dtype=torch.bfloat16) * 3.2)(Dm, H, Dh) * Dm ** (-0.5)), 'Wk': _w((lambda *s: torch.randn(*s, dtype=torch.bfloat16) * 3.2)(Dm, H, Dh) * Dm ** (-0.5)), 'Wv': _w((lambda *s: torch.randn(*s, dtype=torch.bfloat16) * 0.4)(Dm, H, Dh) * Dm ** (-0.5)), 'Wo': _w((lambda *s: torch.randn(*s, dtype=torch.bfloat16) * 0.4)(H, Dh, Dm) * (H * Dh) ** (-0.5)), 'seg_len': seg}
    _A_in = _A_setup()

    def _B_setup():
        B, S, D, F = (1, 2048, 512, 1376)
        return {'x': _w((lambda *s: torch.randn(*s, dtype=torch.bfloat16) * 0.05)(B, S, D)), 'w_gate': _w((lambda *s: torch.randn(*s, dtype=torch.bfloat16) * 0.05)(D, F)), 'w_up': _w((lambda *s: torch.randn(*s, dtype=torch.bfloat16) * 0.05)(D, F)), 'w_down': _w((lambda *s: torch.randn(*s, dtype=torch.bfloat16) * 0.05)(F, D))}
    _B_in = _B_setup()
    return {'A_x': _A_in['x'], 'A_mem0': _A_in['mem0'], 'A_Wq': _A_in['Wq'], 'A_Wk': _A_in['Wk'], 'A_Wv': _A_in['Wv'], 'A_Wo': _A_in['Wo'], 'A_seg_len': _A_in['seg_len'], 'B_x': _B_in['x'], 'B_w_gate': _B_in['w_gate'], 'B_w_up': _B_in['w_up'], 'B_w_down': _B_in['w_down'], 'c': _w((lambda *s: torch.randn(*s, dtype=torch.bfloat16) * 0.1)(1, 512) * 8.0), 'w_mod': _w((lambda *s: torch.randn(*s, dtype=torch.bfloat16) * 0.1)(512, 6 * 512) * 512 ** (-0.5) * 8.0)}

def reference(A_x, A_mem0, A_Wq, A_Wk, A_Wv, A_Wo, A_seg_len, B_x, B_w_gate, B_w_up, B_w_down, c, w_mod):

    def _A_ref(x, mem0, Wq, Wk, Wv, Wo, seg_len):
        B, S, Dm = x.shape
        H, Dh = (Wq.shape[1], Wq.shape[2])
        M = mem0.shape[1]
        scale = Dh ** (-0.5)
        n_seg = S // seg_len
        L = M + seg_len
        idx = torch.arange(L)
        mask = (idx[:, None] < M) | (idx[:, None] >= idx[None, :])
        mem = mem0
        outs = []
        for s in range(n_seg):
            xs = x[:, s * seg_len:(s + 1) * seg_len, :].clone()
            h = torch.concatenate([mem, xs], axis=1)
            q = torch.einsum('btd,dhe->bhte', h, Wq)
            k = torch.einsum('btd,dhe->bhte', h, Wk)
            v = torch.einsum('btd,dhe->bhte', h, Wv)
            scores = torch.einsum('bhqe,bhke->bhqk', q, k) * scale
            scores = torch.where(mask[None, None], scores, -1000000000.0)
            p = _softmax(scores, axis=-1)
            o = torch.einsum('bhqk,bhke->bhqe', p, v)
            o = torch.einsum('bhte,hed->btd', o, Wo)
            mem = o[:, :M, :].clone()
            outs.append(o[:, M:, :])
        return torch.concatenate(outs, axis=1)

    def _B_ref(x, w_gate, w_up, w_down):
        return _gelu(x @ w_gate) * (x @ w_up) @ w_down
    x = A_x
    mod = (_silu(c) @ w_mod).reshape(c.shape[0], 6, 1, -1)
    sa, ca, ga, sb, cb, gb = (mod[:, 0].clone(), mod[:, 1].clone(), mod[:, 2].clone(), mod[:, 3].clone(), mod[:, 4].clone(), mod[:, 5].clone())
    h = _layernorm(x, axis=-1) * (1 + ca) + sa
    x = x + ga * _A_ref(h, A_mem0, A_Wq, A_Wk, A_Wv, A_Wo, A_seg_len)
    h = _layernorm(x, axis=-1) * (1 + cb) + sb
    x = x + gb * _B_ref(h, B_w_gate, B_w_up, B_w_down)
    return x
```

```asm
; @launch grid=(256,1,1) block=(256,1,1) lds=163840
.amdgcn_target "amdgcn-amd-amdhsa--gfx950"
.text
.globl adaLN_cond__memory_aug_recurrent_mem_tr__geglu_ffn__prompt_kernel
.p2align 8
.type adaLN_cond__memory_aug_recurrent_mem_tr__geglu_ffn__prompt_kernel,@function
adaLN_cond__memory_aug_recurrent_mem_tr__geglu_ffn__prompt_kernel:
    s_cmp_ge_u32 s2, 256
    s_cbranch_scc1 L_abort
    s_load_dwordx16 s[32:47], s[0:1], 0
    s_load_dwordx16 s[48:63], s[0:1], 64
    s_getreg_b32 s21, hwreg(HW_REG_XCC_ID, 0, 4)
    v_lshrrev_b32 v1, 6, v0
    s_and_b32 s21, s21, 7
    v_readfirstlane_b32 s20, v1
    s_mov_b32 s31, 0
    s_waitcnt lgkmcnt(0)
    s_mov_b32 s4, s62
    s_and_b32 s5, s63, 0xffff
    s_mov_b32 s6, 0x10000000
    s_mov_b32 s7, 0x20000
    s_mov_b32 s76, s60
    s_and_b32 s77, s61, 0xffff
    s_mov_b32 s78, 0x100
    s_mov_b32 s79, 0x20000
    s_lshl_b32 s23, s21, 4
    s_add_u32 s23, s23, 48
    s_cmp_eq_u32 s21, 0
    s_cselect_b32 s23, 0, s23
    v_mov_b32 v3, 0
    s_cmp_lg_u32 s20, 0
    s_cbranch_scc1 L_tk_pf
    v_mov_b32 v1, s23
    v_mov_b32 v2, 1
    s_mov_b64 exec, 1
    buffer_atomic_add v2, v1, s[76:79], 0 offen sc0
    s_mov_b64 exec, -1
L_tk_pf:
    s_cmp_lg_u32 s21, 0
    s_cbranch_scc1 L_tk_nopf
    s_mov_b32 s8, s42
    s_and_b32 s9, s43, 0xffff
    s_mov_b32 s10, 0x400000
    s_mov_b32 s11, 0x20000
    s_lshr_b32 s24, s2, 3
    s_lshl_b32 s24, s24, 17
    s_lshl_b32 s25, s20, 13
    s_add_u32 s24, s24, s25
    v_and_b32 v4, 63, v0
    v_lshlrev_b32 v4, 4, v4
    s_add_u32 s25, s24, 0x0
    buffer_load_dwordx4 v[128:131], v4, s[8:11], s25 offen offset:0
    buffer_load_dwordx4 v[132:135], v4, s[8:11], s25 offen offset:1024
    buffer_load_dwordx4 v[136:139], v4, s[8:11], s25 offen offset:2048
    buffer_load_dwordx4 v[140:143], v4, s[8:11], s25 offen offset:3072
    s_add_u32 s25, s24, 0x1000
    buffer_load_dwordx4 v[144:147], v4, s[8:11], s25 offen offset:0
    buffer_load_dwordx4 v[148:151], v4, s[8:11], s25 offen offset:1024
    buffer_load_dwordx4 v[152:155], v4, s[8:11], s25 offen offset:2048
    buffer_load_dwordx4 v[156:159], v4, s[8:11], s25 offen offset:3072
    s_add_u32 s25, s24, 0x8000
    buffer_load_dwordx4 v[160:163], v4, s[8:11], s25 offen offset:0
    buffer_load_dwordx4 v[164:167], v4, s[8:11], s25 offen offset:1024
    buffer_load_dwordx4 v[168:171], v4, s[8:11], s25 offen offset:2048
    buffer_load_dwordx4 v[172:175], v4, s[8:11], s25 offen offset:3072
    s_add_u32 s25, s24, 0x9000
    buffer_load_dwordx4 v[176:179], v4, s[8:11], s25 offen offset:0
    buffer_load_dwordx4 v[180:183], v4, s[8:11], s25 offen offset:1024
    buffer_load_dwordx4 v[184:187], v4, s[8:11], s25 offen offset:2048
    buffer_load_dwordx4 v[188:191], v4, s[8:11], s25 offen offset:3072
    s_add_u32 s25, s24, 0x10000
    buffer_load_dwordx4 v[192:195], v4, s[8:11], s25 offen offset:0
    buffer_load_dwordx4 v[196:199], v4, s[8:11], s25 offen offset:1024
    buffer_load_dwordx4 v[200:203], v4, s[8:11], s25 offen offset:2048
    buffer_load_dwordx4 v[204:207], v4, s[8:11], s25 offen offset:3072
    s_add_u32 s25, s24, 0x11000
    buffer_load_dwordx4 v[208:211], v4, s[8:11], s25 offen offset:0
    buffer_load_dwordx4 v[212:215], v4, s[8:11], s25 offen offset:1024
    buffer_load_dwordx4 v[216:219], v4, s[8:11], s25 offen offset:2048
    buffer_load_dwordx4 v[220:223], v4, s[8:11], s25 offen offset:3072
    s_cmp_lg_u32 s20, 0
    s_cbranch_scc1 L_tk_wait
    s_waitcnt vmcnt(24)
    s_branch L_tk_put
L_tk_nopf:
    s_cmp_lg_u32 s20, 0
    s_cbranch_scc1 L_tk_wait
    s_waitcnt vmcnt(0)
L_tk_put:
    s_mov_b64 exec, 1
    ds_write_b32 v3, v2
    s_waitcnt lgkmcnt(0)
    s_mov_b64 exec, -1
L_tk_wait:
    s_barrier
    ds_read_b32 v2, v3
    s_waitcnt lgkmcnt(0)
    v_readfirstlane_b32 s22, v2
    s_barrier
    s_cmp_ge_u32 s22, 32
    s_nop 1
    s_cbranch_scc1 L_abort
    s_cmp_eq_u32 s21, 0
    s_cbranch_scc1 L_team
    s_sub_u32 s70, s21, 1
    s_cmp_eq_u32 s70, 6
    s_cselect_b32 s71, 12, 14
    s_cmp_lt_u32 s22, s71
    s_cbranch_scc0 L_others
    s_mul_i32 s24, s70, 14
    s_add_u32 s24, s24, s22
L_P:
    s_mov_b32 s8, s38
    s_and_b32 s9, s39, 0xffff
    s_mov_b32 s10, 0x400000
    s_mov_b32 s11, 0x20000
    s_mov_b32 s12, s40
    s_and_b32 s13, s41, 0xffff
    s_mov_b32 s14, 0x400000
    s_mov_b32 s15, 0x20000
    s_mov_b32 s16, s36
    s_and_b32 s17, s37, 0xffff
    s_mov_b32 s18, 0x400000
    s_mov_b32 s19, 0x20000
    v_and_b32 v112, 63, v0
    v_lshrrev_b32 v113, 4, v112
    v_and_b32 v114, 15, v112
    v_bfe_u32 v115, v112, 2, 2
    v_and_b32 v116, 3, v112
    s_mul_hi_u32 s25, s24, 0x55555556
    s_mul_i32 s70, s25, 3
    s_sub_u32 s26, s24, s70
    s_cmp_eq_u32 s26, 0
    s_cselect_b32 s28, 22, 21
    v_lshlrev_b32 v1, 4, v112
    s_and_b32 s70, s20, 1
    s_lshl_b32 s70, s70, 12
    s_lshr_b32 s71, s20, 1
    s_lshl_b32 s71, s71, 11
    s_add_u32 s72, s70, s71
    v_add_u32 v10, s72, v1
    v_add_u32 v9, s70, v1
    s_lshl_b32 s70, s26, 5
    s_add_u32 s70, s70, s25
    s_lshl_b32 s64, s70, 13
    s_mov_b32 s68, s64
    s_lshl_b32 s65, s25, 6
    s_lshl_b32 s71, s26, 3
    s_add_u32 s65, s65, s71
    s_add_u32 s65, s65, 0x120000
    v_lshlrev_b32 v117, 5, v113
    v_lshlrev_b32 v118, 4, v114
    v_xor_b32 v117, v117, v118
    v_lshl_add_u32 v12, v113, 13, v117
    v_xor_b32 v13, 128, v12
    v_lshl_add_u32 v117, v113, 3, v115
    v_and_b32 v118, 1, v113
    v_lshl_or_b32 v118, v118, 2, v115
    v_lshlrev_b32 v118, 5, v118
    v_lshl_or_b32 v118, v116, 3, v118
    s_lshl_b32 s70, s20, 6
    v_xor_b32 v118, s70, v118
    v_lshl_add_u32 v14, v117, 8, v118
    v_xor_b32 v15, 32, v14
    s_lshl_b32 s80, s20, 18
    s_lshl_b32 s70, s25, 8
    s_add_u32 s80, s80, s70
    s_lshl_b32 s81, s20, 13
    s_and_b32 s70, s20, 1
    s_lshl_b32 s70, s70, 7
    s_lshl_b32 s71, s20, 13
    s_add_u32 s71, s71, 131072
    v_xor_b32 v117, s70, v1
    v_add_u32 v2, s71, v117
    v_xor_b32 v117, v113, v114
    v_lshlrev_b32 v117, 4, v117
    v_lshl_add_u32 v117, v114, 10, v117
    v_add_u32 v3, 131072, v117
    v_xor_b32 v4, 64, v3
    v_xor_b32 v5, 128, v3
    v_xor_b32 v6, 192, v3
    s_lshl_b32 s70, s20, 10
    v_add_u32 v7, s70, v1
    s_lshr_b32 s70, s20, 1
    s_lshl_b32 s70, s70, 10
    v_and_b32 v117, 31, v112
    v_lshlrev_b32 v117, 3, v117
    v_add_u32 v8, s70, v117
    s_and_b32 s70, s20, 1
    s_lshl_b32 s70, s70, 4
    v_lshlrev_b32 v117, 2, v113
    v_sub_u32 v117, v114, v117
    v_add_u32 v117, s70, v117
    s_add_u32 m0, s81, 0
    s_add_u32 s70, s80, 0x0
    buffer_load_dwordx4 v12, s[8:11], s70 offen lds
    s_add_u32 m0, s81, 1024
    s_add_u32 s70, s80, 0x8000
    buffer_load_dwordx4 v12, s[8:11], s70 offen lds
    s_add_u32 m0, s81, 2048
    s_add_u32 s70, s80, 0x10000
    buffer_load_dwordx4 v13, s[8:11], s70 offen lds
    s_add_u32 m0, s81, 3072
    s_add_u32 s70, s80, 0x18000
    buffer_load_dwordx4 v13, s[8:11], s70 offen lds
    s_add_u32 m0, s81, 4096
    s_add_u32 s70, s80, 0x20000
    buffer_load_dwordx4 v12, s[8:11], s70 offen lds
    s_add_u32 m0, s81, 5120
    s_add_u32 s70, s80, 0x28000
    buffer_load_dwordx4 v12, s[8:11], s70 offen lds
    s_add_u32 m0, s81, 6144
    s_add_u32 s70, s80, 0x30000
    buffer_load_dwordx4 v13, s[8:11], s70 offen lds
    s_add_u32 m0, s81, 7168
    s_add_u32 s70, s80, 0x38000
    buffer_load_dwordx4 v13, s[8:11], s70 offen lds
    s_add_u32 m0, s81, 32768
    s_add_u32 s70, s80, 0x100000
    buffer_load_dwordx4 v12, s[8:11], s70 offen lds
    s_add_u32 m0, s81, 33792
    s_add_u32 s70, s80, 0x108000
    buffer_load_dwordx4 v12, s[8:11], s70 offen lds
    s_add_u32 m0, s81, 34816
    s_add_u32 s70, s80, 0x110000
    buffer_load_dwordx4 v13, s[8:11], s70 offen lds
    s_add_u32 m0, s81, 35840
    s_add_u32 s70, s80, 0x118000
    buffer_load_dwordx4 v13, s[8:11], s70 offen lds
    s_add_u32 m0, s81, 36864
    s_add_u32 s70, s80, 0x120000
    buffer_load_dwordx4 v12, s[8:11], s70 offen lds
    s_add_u32 m0, s81, 37888
    s_add_u32 s70, s80, 0x128000
    buffer_load_dwordx4 v12, s[8:11], s70 offen lds
    s_add_u32 m0, s81, 38912
    s_add_u32 s70, s80, 0x130000
    buffer_load_dwordx4 v13, s[8:11], s70 offen lds
    s_add_u32 m0, s81, 39936
    s_add_u32 s70, s80, 0x138000
    buffer_load_dwordx4 v13, s[8:11], s70 offen lds
    s_add_u32 m0, s81, 65536
    s_add_u32 s70, s80, 0x200000
    buffer_load_dwordx4 v12, s[8:11], s70 offen lds
    s_add_u32 m0, s81, 66560
    s_add_u32 s70, s80, 0x208000
    buffer_load_dwordx4 v12, s[8:11], s70 offen lds
    s_add_u32 m0, s81, 67584
    s_add_u32 s70, s80, 0x210000
    buffer_load_dwordx4 v13, s[8:11], s70 offen lds
    s_add_u32 m0, s81, 68608
    s_add_u32 s70, s80, 0x218000
    buffer_load_dwordx4 v13, s[8:11], s70 offen lds
    s_add_u32 m0, s81, 69632
    s_add_u32 s70, s80, 0x220000
    buffer_load_dwordx4 v12, s[8:11], s70 offen lds
    s_add_u32 m0, s81, 70656
    s_add_u32 s70, s80, 0x228000
    buffer_load_dwordx4 v12, s[8:11], s70 offen lds
    s_add_u32 m0, s81, 71680
    s_add_u32 s70, s80, 0x230000
    buffer_load_dwordx4 v13, s[8:11], s70 offen lds
    s_add_u32 m0, s81, 72704
    s_add_u32 s70, s80, 0x238000
    buffer_load_dwordx4 v13, s[8:11], s70 offen lds
    s_waitcnt vmcnt(16) lgkmcnt(0)
    s_barrier
    s_add_u32 m0, s81, 98304
    s_add_u32 s70, s80, 0x300000
    buffer_load_dwordx4 v12, s[8:11], s70 offen lds
    s_add_u32 m0, s81, 99328
    s_add_u32 s70, s80, 0x308000
    buffer_load_dwordx4 v12, s[8:11], s70 offen lds
    s_add_u32 m0, s81, 100352
    s_add_u32 s70, s80, 0x310000
    buffer_load_dwordx4 v13, s[8:11], s70 offen lds
    s_add_u32 m0, s81, 101376
    s_add_u32 s70, s80, 0x318000
    buffer_load_dwordx4 v13, s[8:11], s70 offen lds
    s_add_u32 m0, s81, 102400
    s_add_u32 s70, s80, 0x320000
    buffer_load_dwordx4 v12, s[8:11], s70 offen lds
    s_add_u32 m0, s81, 103424
    s_add_u32 s70, s80, 0x328000
    buffer_load_dwordx4 v12, s[8:11], s70 offen lds
    s_add_u32 m0, s81, 104448
    s_add_u32 s70, s80, 0x330000
    buffer_load_dwordx4 v13, s[8:11], s70 offen lds
    s_add_u32 m0, s81, 105472
    s_add_u32 s70, s80, 0x338000
    buffer_load_dwordx4 v13, s[8:11], s70 offen lds
    ds_read_b64_tr_b16 a[0:1], v14 offset:0
    ds_read_b64_tr_b16 a[2:3], v14 offset:1024
    ds_read_b64_tr_b16 a[64:65], v15 offset:0
    ds_read_b64_tr_b16 a[66:67], v15 offset:1024
    ds_read_b64_tr_b16 a[4:5], v14 offset:8192
    ds_read_b64_tr_b16 a[6:7], v14 offset:9216
    ds_read_b64_tr_b16 a[68:69], v15 offset:8192
    ds_read_b64_tr_b16 a[70:71], v15 offset:9216
    ds_read_b64_tr_b16 a[8:9], v14 offset:16384
    ds_read_b64_tr_b16 a[10:11], v14 offset:17408
    ds_read_b64_tr_b16 a[72:73], v15 offset:16384
    ds_read_b64_tr_b16 a[74:75], v15 offset:17408
    ds_read_b64_tr_b16 a[12:13], v14 offset:24576
    ds_read_b64_tr_b16 a[14:15], v14 offset:25600
    ds_read_b64_tr_b16 a[76:77], v15 offset:24576
    ds_read_b64_tr_b16 a[78:79], v15 offset:25600
    s_waitcnt vmcnt(16) lgkmcnt(0)
    s_barrier
    s_add_u32 m0, s81, 0
    s_add_u32 s70, s80, 0x0
    buffer_load_dwordx4 v12, s[12:15], s70 offen lds
    s_add_u32 m0, s81, 1024
    s_add_u32 s70, s80, 0x8000
    buffer_load_dwordx4 v12, s[12:15], s70 offen lds
    s_add_u32 m0, s81, 2048
    s_add_u32 s70, s80, 0x10000
    buffer_load_dwordx4 v13, s[12:15], s70 offen lds
    s_add_u32 m0, s81, 3072
    s_add_u32 s70, s80, 0x18000
    buffer_load_dwordx4 v13, s[12:15], s70 offen lds
    s_add_u32 m0, s81, 4096
    s_add_u32 s70, s80, 0x20000
    buffer_load_dwordx4 v12, s[12:15], s70 offen lds
    s_add_u32 m0, s81, 5120
    s_add_u32 s70, s80, 0x28000
    buffer_load_dwordx4 v12, s[12:15], s70 offen lds
    s_add_u32 m0, s81, 6144
    s_add_u32 s70, s80, 0x30000
    buffer_load_dwordx4 v13, s[12:15], s70 offen lds
    s_add_u32 m0, s81, 7168
    s_add_u32 s70, s80, 0x38000
    buffer_load_dwordx4 v13, s[12:15], s70 offen lds
    ds_read_b64_tr_b16 a[16:17], v14 offset:32768
    ds_read_b64_tr_b16 a[18:19], v14 offset:33792
    ds_read_b64_tr_b16 a[80:81], v15 offset:32768
    ds_read_b64_tr_b16 a[82:83], v15 offset:33792
    ds_read_b64_tr_b16 a[20:21], v14 offset:40960
    ds_read_b64_tr_b16 a[22:23], v14 offset:41984
    ds_read_b64_tr_b16 a[84:85], v15 offset:40960
    ds_read_b64_tr_b16 a[86:87], v15 offset:41984
    ds_read_b64_tr_b16 a[24:25], v14 offset:49152
    ds_read_b64_tr_b16 a[26:27], v14 offset:50176
    ds_read_b64_tr_b16 a[88:89], v15 offset:49152
    ds_read_b64_tr_b16 a[90:91], v15 offset:50176
    ds_read_b64_tr_b16 a[28:29], v14 offset:57344
    ds_read_b64_tr_b16 a[30:31], v14 offset:58368
    ds_read_b64_tr_b16 a[92:93], v15 offset:57344
    ds_read_b64_tr_b16 a[94:95], v15 offset:58368
    s_waitcnt vmcnt(16) lgkmcnt(0)
    s_barrier
    s_add_u32 m0, s81, 32768
    s_add_u32 s70, s80, 0x100000
    buffer_load_dwordx4 v12, s[12:15], s70 offen lds
    s_add_u32 m0, s81, 33792
    s_add_u32 s70, s80, 0x108000
    buffer_load_dwordx4 v12, s[12:15], s70 offen lds
    s_add_u32 m0, s81, 34816
    s_add_u32 s70, s80, 0x110000
    buffer_load_dwordx4 v13, s[12:15], s70 offen lds
    s_add_u32 m0, s81, 35840
    s_add_u32 s70, s80, 0x118000
    buffer_load_dwordx4 v13, s[12:15], s70 offen lds
    s_add_u32 m0, s81, 36864
    s_add_u32 s70, s80, 0x120000
    buffer_load_dwordx4 v12, s[12:15], s70 offen lds
    s_add_u32 m0, s81, 37888
    s_add_u32 s70, s80, 0x128000
    buffer_load_dwordx4 v12, s[12:15], s70 offen lds
    s_add_u32 m0, s81, 38912
    s_add_u32 s70, s80, 0x130000
    buffer_load_dwordx4 v13, s[12:15], s70 offen lds
    s_add_u32 m0, s81, 39936
    s_add_u32 s70, s80, 0x138000
    buffer_load_dwordx4 v13, s[12:15], s70 offen lds
    v_add_u32 v16, 0x10000, v14
    v_add_u32 v17, 0x10000, v15
    ds_read_b64_tr_b16 a[32:33], v16 offset:0
    ds_read_b64_tr_b16 a[34:35], v16 offset:1024
    ds_read_b64_tr_b16 a[96:97], v17 offset:0
    ds_read_b64_tr_b16 a[98:99], v17 offset:1024
    ds_read_b64_tr_b16 a[36:37], v16 offset:8192
    ds_read_b64_tr_b16 a[38:39], v16 offset:9216
    ds_read_b64_tr_b16 a[100:101], v17 offset:8192
    ds_read_b64_tr_b16 a[102:103], v17 offset:9216
    ds_read_b64_tr_b16 a[40:41], v16 offset:16384
    ds_read_b64_tr_b16 a[42:43], v16 offset:17408
    ds_read_b64_tr_b16 a[104:105], v17 offset:16384
    ds_read_b64_tr_b16 a[106:107], v17 offset:17408
    ds_read_b64_tr_b16 a[44:45], v16 offset:24576
    ds_read_b64_tr_b16 a[46:47], v16 offset:25600
    ds_read_b64_tr_b16 a[108:109], v17 offset:24576
    ds_read_b64_tr_b16 a[110:111], v17 offset:25600
    s_waitcnt vmcnt(16) lgkmcnt(0)
    s_barrier
    s_add_u32 m0, s81, 65536
    s_add_u32 s70, s80, 0x200000
    buffer_load_dwordx4 v12, s[12:15], s70 offen lds
    s_add_u32 m0, s81, 66560
    s_add_u32 s70, s80, 0x208000
    buffer_load_dwordx4 v12, s[12:15], s70 offen lds
    s_add_u32 m0, s81, 67584
    s_add_u32 s70, s80, 0x210000
    buffer_load_dwordx4 v13, s[12:15], s70 offen lds
    s_add_u32 m0, s81, 68608
    s_add_u32 s70, s80, 0x218000
    buffer_load_dwordx4 v13, s[12:15], s70 offen lds
    s_add_u32 m0, s81, 69632
    s_add_u32 s70, s80, 0x220000
    buffer_load_dwordx4 v12, s[12:15], s70 offen lds
    s_add_u32 m0, s81, 70656
    s_add_u32 s70, s80, 0x228000
    buffer_load_dwordx4 v12, s[12:15], s70 offen lds
    s_add_u32 m0, s81, 71680
    s_add_u32 s70, s80, 0x230000
    buffer_load_dwordx4 v13, s[12:15], s70 offen lds
    s_add_u32 m0, s81, 72704
    s_add_u32 s70, s80, 0x238000
    buffer_load_dwordx4 v13, s[12:15], s70 offen lds
    v_add_u32 v16, 0x10000, v14
    v_add_u32 v17, 0x10000, v15
    ds_read_b64_tr_b16 a[48:49], v16 offset:32768
    ds_read_b64_tr_b16 a[50:51], v16 offset:33792
    ds_read_b64_tr_b16 a[112:113], v17 offset:32768
    ds_read_b64_tr_b16 a[114:115], v17 offset:33792
    ds_read_b64_tr_b16 a[52:53], v16 offset:40960
    ds_read_b64_tr_b16 a[54:55], v16 offset:41984
    ds_read_b64_tr_b16 a[116:117], v17 offset:40960
    ds_read_b64_tr_b16 a[118:119], v17 offset:41984
    ds_read_b64_tr_b16 a[56:57], v16 offset:49152
    ds_read_b64_tr_b16 a[58:59], v16 offset:50176
    ds_read_b64_tr_b16 a[120:121], v17 offset:49152
    ds_read_b64_tr_b16 a[122:123], v17 offset:50176
    ds_read_b64_tr_b16 a[60:61], v16 offset:57344
    ds_read_b64_tr_b16 a[62:63], v16 offset:58368
    ds_read_b64_tr_b16 a[124:125], v17 offset:57344
    ds_read_b64_tr_b16 a[126:127], v17 offset:58368
    s_waitcnt vmcnt(16) lgkmcnt(0)
    s_barrier
    s_add_u32 m0, s81, 98304
    s_add_u32 s70, s80, 0x300000
    buffer_load_dwordx4 v12, s[12:15], s70 offen lds
    s_add_u32 m0, s81, 99328
    s_add_u32 s70, s80, 0x308000
    buffer_load_dwordx4 v12, s[12:15], s70 offen lds
    s_add_u32 m0, s81, 100352
    s_add_u32 s70, s80, 0x310000
    buffer_load_dwordx4 v13, s[12:15], s70 offen lds
    s_add_u32 m0, s81, 101376
    s_add_u32 s70, s80, 0x318000
    buffer_load_dwordx4 v13, s[12:15], s70 offen lds
    s_add_u32 m0, s81, 102400
    s_add_u32 s70, s80, 0x320000
    buffer_load_dwordx4 v12, s[12:15], s70 offen lds
    s_add_u32 m0, s81, 103424
    s_add_u32 s70, s80, 0x328000
    buffer_load_dwordx4 v12, s[12:15], s70 offen lds
    s_add_u32 m0, s81, 104448
    s_add_u32 s70, s80, 0x330000
    buffer_load_dwordx4 v13, s[12:15], s70 offen lds
    s_add_u32 m0, s81, 105472
    s_add_u32 s70, s80, 0x338000
    buffer_load_dwordx4 v13, s[12:15], s70 offen lds
    ds_read_b64_tr_b16 a[128:129], v14 offset:0
    ds_read_b64_tr_b16 a[130:131], v14 offset:1024
    ds_read_b64_tr_b16 a[192:193], v15 offset:0
    ds_read_b64_tr_b16 a[194:195], v15 offset:1024
    ds_read_b64_tr_b16 a[132:133], v14 offset:8192
    ds_read_b64_tr_b16 a[134:135], v14 offset:9216
    ds_read_b64_tr_b16 a[196:197], v15 offset:8192
    ds_read_b64_tr_b16 a[198:199], v15 offset:9216
    ds_read_b64_tr_b16 a[136:137], v14 offset:16384
    ds_read_b64_tr_b16 a[138:139], v14 offset:17408
    ds_read_b64_tr_b16 a[200:201], v15 offset:16384
    ds_read_b64_tr_b16 a[202:203], v15 offset:17408
    ds_read_b64_tr_b16 a[140:141], v14 offset:24576
    ds_read_b64_tr_b16 a[142:143], v14 offset:25600
    ds_read_b64_tr_b16 a[204:205], v15 offset:24576
    ds_read_b64_tr_b16 a[206:207], v15 offset:25600
    s_waitcnt vmcnt(16) lgkmcnt(0)
    s_barrier
    s_add_u32 m0, s81, 0
    s_add_u32 s70, s80, 0x0
    buffer_load_dwordx4 v12, s[16:19], s70 offen lds
    s_add_u32 m0, s81, 1024
    s_add_u32 s70, s80, 0x8000
    buffer_load_dwordx4 v12, s[16:19], s70 offen lds
    s_add_u32 m0, s81, 2048
    s_add_u32 s70, s80, 0x10000
    buffer_load_dwordx4 v13, s[16:19], s70 offen lds
    s_add_u32 m0, s81, 3072
    s_add_u32 s70, s80, 0x18000
    buffer_load_dwordx4 v13, s[16:19], s70 offen lds
    s_add_u32 m0, s81, 4096
    s_add_u32 s70, s80, 0x20000
    buffer_load_dwordx4 v12, s[16:19], s70 offen lds
    s_add_u32 m0, s81, 5120
    s_add_u32 s70, s80, 0x28000
    buffer_load_dwordx4 v12, s[16:19], s70 offen lds
    s_add_u32 m0, s81, 6144
    s_add_u32 s70, s80, 0x30000
    buffer_load_dwordx4 v13, s[16:19], s70 offen lds
    s_add_u32 m0, s81, 7168
    s_add_u32 s70, s80, 0x38000
    buffer_load_dwordx4 v13, s[16:19], s70 offen lds
    ds_read_b64_tr_b16 a[144:145], v14 offset:32768
    ds_read_b64_tr_b16 a[146:147], v14 offset:33792
    ds_read_b64_tr_b16 a[208:209], v15 offset:32768
    ds_read_b64_tr_b16 a[210:211], v15 offset:33792
    ds_read_b64_tr_b16 a[148:149], v14 offset:40960
    ds_read_b64_tr_b16 a[150:151], v14 offset:41984
    ds_read_b64_tr_b16 a[212:213], v15 offset:40960
    ds_read_b64_tr_b16 a[214:215], v15 offset:41984
    ds_read_b64_tr_b16 a[152:153], v14 offset:49152
    ds_read_b64_tr_b16 a[154:155], v14 offset:50176
    ds_read_b64_tr_b16 a[216:217], v15 offset:49152
    ds_read_b64_tr_b16 a[218:219], v15 offset:50176
    ds_read_b64_tr_b16 a[156:157], v14 offset:57344
    ds_read_b64_tr_b16 a[158:159], v14 offset:58368
    ds_read_b64_tr_b16 a[220:221], v15 offset:57344
    ds_read_b64_tr_b16 a[222:223], v15 offset:58368
    s_waitcnt vmcnt(16) lgkmcnt(0)
    s_barrier
    s_add_u32 m0, s81, 32768
    s_add_u32 s70, s80, 0x100000
    buffer_load_dwordx4 v12, s[16:19], s70 offen lds
    s_add_u32 m0, s81, 33792
    s_add_u32 s70, s80, 0x108000
    buffer_load_dwordx4 v12, s[16:19], s70 offen lds
    s_add_u32 m0, s81, 34816
    s_add_u32 s70, s80, 0x110000
    buffer_load_dwordx4 v13, s[16:19], s70 offen lds
    s_add_u32 m0, s81, 35840
    s_add_u32 s70, s80, 0x118000
    buffer_load_dwordx4 v13, s[16:19], s70 offen lds
    s_add_u32 m0, s81, 36864
    s_add_u32 s70, s80, 0x120000
    buffer_load_dwordx4 v12, s[16:19], s70 offen lds
    s_add_u32 m0, s81, 37888
    s_add_u32 s70, s80, 0x128000
    buffer_load_dwordx4 v12, s[16:19], s70 offen lds
    s_add_u32 m0, s81, 38912
    s_add_u32 s70, s80, 0x130000
    buffer_load_dwordx4 v13, s[16:19], s70 offen lds
    s_add_u32 m0, s81, 39936
    s_add_u32 s70, s80, 0x138000
    buffer_load_dwordx4 v13, s[16:19], s70 offen lds
    v_add_u32 v16, 0x10000, v14
    v_add_u32 v17, 0x10000, v15
    ds_read_b64_tr_b16 a[160:161], v16 offset:0
    ds_read_b64_tr_b16 a[162:163], v16 offset:1024
    ds_read_b64_tr_b16 a[224:225], v17 offset:0
    ds_read_b64_tr_b16 a[226:227], v17 offset:1024
    ds_read_b64_tr_b16 a[164:165], v16 offset:8192
    ds_read_b64_tr_b16 a[166:167], v16 offset:9216
    ds_read_b64_tr_b16 a[228:229], v17 offset:8192
    ds_read_b64_tr_b16 a[230:231], v17 offset:9216
    ds_read_b64_tr_b16 a[168:169], v16 offset:16384
    ds_read_b64_tr_b16 a[170:171], v16 offset:17408
    ds_read_b64_tr_b16 a[232:233], v17 offset:16384
    ds_read_b64_tr_b16 a[234:235], v17 offset:17408
    ds_read_b64_tr_b16 a[172:173], v16 offset:24576
    ds_read_b64_tr_b16 a[174:175], v16 offset:25600
    ds_read_b64_tr_b16 a[236:237], v17 offset:24576
    ds_read_b64_tr_b16 a[238:239], v17 offset:25600
    s_waitcnt vmcnt(16) lgkmcnt(0)
    s_barrier
    s_add_u32 m0, s81, 65536
    s_add_u32 s70, s80, 0x200000
    buffer_load_dwordx4 v12, s[16:19], s70 offen lds
    s_add_u32 m0, s81, 66560
    s_add_u32 s70, s80, 0x208000
    buffer_load_dwordx4 v12, s[16:19], s70 offen lds
    s_add_u32 m0, s81, 67584
    s_add_u32 s70, s80, 0x210000
    buffer_load_dwordx4 v13, s[16:19], s70 offen lds
    s_add_u32 m0, s81, 68608
    s_add_u32 s70, s80, 0x218000
    buffer_load_dwordx4 v13, s[16:19], s70 offen lds
    s_add_u32 m0, s81, 69632
    s_add_u32 s70, s80, 0x220000
    buffer_load_dwordx4 v12, s[16:19], s70 offen lds
    s_add_u32 m0, s81, 70656
    s_add_u32 s70, s80, 0x228000
    buffer_load_dwordx4 v12, s[16:19], s70 offen lds
    s_add_u32 m0, s81, 71680
    s_add_u32 s70, s80, 0x230000
    buffer_load_dwordx4 v13, s[16:19], s70 offen lds
    s_add_u32 m0, s81, 72704
    s_add_u32 s70, s80, 0x238000
    buffer_load_dwordx4 v13, s[16:19], s70 offen lds
    v_add_u32 v16, 0x10000, v14
    v_add_u32 v17, 0x10000, v15
    ds_read_b64_tr_b16 a[176:177], v16 offset:32768
    ds_read_b64_tr_b16 a[178:179], v16 offset:33792
    ds_read_b64_tr_b16 a[240:241], v17 offset:32768
    ds_read_b64_tr_b16 a[242:243], v17 offset:33792
    ds_read_b64_tr_b16 a[180:181], v16 offset:40960
    ds_read_b64_tr_b16 a[182:183], v16 offset:41984
    ds_read_b64_tr_b16 a[244:245], v17 offset:40960
    ds_read_b64_tr_b16 a[246:247], v17 offset:41984
    ds_read_b64_tr_b16 a[184:185], v16 offset:49152
    ds_read_b64_tr_b16 a[186:187], v16 offset:50176
    ds_read_b64_tr_b16 a[248:249], v17 offset:49152
    ds_read_b64_tr_b16 a[250:251], v17 offset:50176
    ds_read_b64_tr_b16 a[188:189], v16 offset:57344
    ds_read_b64_tr_b16 a[190:191], v16 offset:58368
    ds_read_b64_tr_b16 a[252:253], v17 offset:57344
    ds_read_b64_tr_b16 a[254:255], v17 offset:58368
    s_waitcnt lgkmcnt(0)
    s_barrier
    s_add_u32 m0, s81, 98304
    s_add_u32 s70, s80, 0x300000
    buffer_load_dwordx4 v12, s[16:19], s70 offen lds
    s_add_u32 m0, s81, 99328
    s_add_u32 s70, s80, 0x308000
    buffer_load_dwordx4 v12, s[16:19], s70 offen lds
    s_add_u32 m0, s81, 100352
    s_add_u32 s70, s80, 0x310000
    buffer_load_dwordx4 v13, s[16:19], s70 offen lds
    s_add_u32 m0, s81, 101376
    s_add_u32 s70, s80, 0x318000
    buffer_load_dwordx4 v13, s[16:19], s70 offen lds
    s_add_u32 m0, s81, 102400
    s_add_u32 s70, s80, 0x320000
    buffer_load_dwordx4 v12, s[16:19], s70 offen lds
    s_add_u32 m0, s81, 103424
    s_add_u32 s70, s80, 0x328000
    buffer_load_dwordx4 v12, s[16:19], s70 offen lds
    s_add_u32 m0, s81, 104448
    s_add_u32 s70, s80, 0x330000
    buffer_load_dwordx4 v13, s[16:19], s70 offen lds
    s_add_u32 m0, s81, 105472
    s_add_u32 s70, s80, 0x338000
    buffer_load_dwordx4 v13, s[16:19], s70 offen lds
    s_lshl_b32 s30, s26, 15
    s_lshl_b32 s70, s20, 13
    s_add_u32 s30, s30, s70
    s_add_u32 s30, s30, 0x200000
    s_add_u32 s72, s30, 4096
    s_cmp_lg_u32 s20, 0
    s_cbranch_scc1 L_wd_2
    s_branch L_wf_3
L_wc_1:
    s_sleep 8
L_wf_3:
    buffer_load_dword v122, off, s[76:79], 0 offset:192 sc1
    buffer_load_dword v123, off, s[76:79], 0 offset:176 sc1
    s_add_u32 s31, s31, 1
    s_cmp_gt_u32 s31, 1048576
    s_cbranch_scc1 L_abort
    s_waitcnt vmcnt(0)
    v_add_u32 v122, v122, v123
    s_nop 0
    v_readfirstlane_b32 s70, v122
    s_cmp_lg_u32 s70, 64
    s_nop 2
    s_cbranch_scc1 L_wc_1
L_wd_2:
    s_barrier
    s_branch L_pi_6
L_pa_4:
    buffer_load_dwordx4 v[60:63], v1, s[4:7], s30 offen offset:0 sc1
    buffer_load_dwordx4 v[64:67], v1, s[4:7], s30 offen offset:1024 sc1
    buffer_load_dwordx4 v[68:71], v1, s[4:7], s30 offen offset:2048 sc1
    buffer_load_dwordx4 v[72:75], v1, s[4:7], s30 offen offset:3072 sc1
    buffer_load_dwordx4 v[76:79], v1, s[4:7], s72 offen offset:0 sc1
    buffer_load_dwordx4 v[80:83], v1, s[4:7], s72 offen offset:1024 sc1
    buffer_load_dwordx4 v[84:87], v1, s[4:7], s72 offen offset:2048 sc1
    buffer_load_dwordx4 v[88:91], v1, s[4:7], s72 offen offset:3072 sc1
    s_waitcnt vmcnt(0)
L_pc_7:
    v_max3_u32 v92, v60, v61, v62
    v_max3_u32 v93, v63, v64, v65
    v_max3_u32 v94, v66, v67, v68
    v_max3_u32 v95, v69, v70, v71
    v_max3_u32 v96, v72, v73, v74
    v_max3_u32 v97, v75, v76, v77
    v_max3_u32 v98, v78, v79, v80
    v_max3_u32 v99, v81, v82, v83
    v_max3_u32 v100, v84, v85, v86
    v_max3_u32 v101, v87, v88, v89
    v_max3_u32 v102, v92, v93, v94
    v_max3_u32 v103, v95, v96, v97
    v_max3_u32 v104, v98, v99, v100
    v_max3_u32 v105, v101, v90, v91
    v_max3_u32 v106, v102, v103, v104
    v_max_u32 v107, v106, v105
    v_cmp_eq_u32 vcc, -1, v107
    s_nop 0
    s_cbranch_vccz L_pk_5
    s_add_u32 s31, s31, 1
    s_cmp_gt_u32 s31, 1048576
    s_cbranch_scc1 L_abort
L_pi_6:
    s_sleep 6
    buffer_load_dwordx4 v[88:91], v1, s[4:7], s72 offen offset:3072 sc1
    s_add_u32 s31, s31, 1
    s_cmp_gt_u32 s31, 1048576
    s_cbranch_scc1 L_abort
    s_waitcnt vmcnt(0)
    v_max3_u32 v92, v88, v89, v90
    v_max_u32 v93, v92, v91
    v_cmp_eq_u32 vcc, -1, v93
    s_nop 0
    s_cbranch_vccnz L_pi_6
    s_branch L_pa_4
L_pk_5:
    v_xor_b32 v11, 0, v2
    ds_write_b128 v11, v[60:63] offset:0
    v_xor_b32 v11, 16, v2
    ds_write_b128 v11, v[64:67] offset:1024
    v_xor_b32 v11, 32, v2
    ds_write_b128 v11, v[68:71] offset:2048
    v_xor_b32 v11, 48, v2
    ds_write_b128 v11, v[72:75] offset:3072
    v_xor_b32 v11, 64, v2
    ds_write_b128 v11, v[76:79] offset:4096
    v_xor_b32 v11, 80, v2
    ds_write_b128 v11, v[80:83] offset:5120
    v_xor_b32 v11, 96, v2
    ds_write_b128 v11, v[84:87] offset:6144
    v_xor_b32 v11, 112, v2
    ds_write_b128 v11, v[88:91] offset:7168
    s_mov_b32 s27, 0
    s_mov_b32 s66, 0
    s_waitcnt lgkmcnt(0)
    s_barrier
    s_branch L_P_kv
L_P_t0:
    ds_read_b64_tr_b16 v[128:129], v14 offset:0
    ds_read_b64_tr_b16 v[130:131], v14 offset:1024
    ds_read_b64_tr_b16 v[192:193], v15 offset:0
    ds_read_b64_tr_b16 v[194:195], v15 offset:1024
    ds_read_b64_tr_b16 v[132:133], v14 offset:8192
    ds_read_b64_tr_b16 v[134:135], v14 offset:9216
    ds_read_b64_tr_b16 v[196:197], v15 offset:8192
    ds_read_b64_tr_b16 v[198:199], v15 offset:9216
    ds_read_b64_tr_b16 v[136:137], v14 offset:16384
    ds_read_b64_tr_b16 v[138:139], v14 offset:17408
    ds_read_b64_tr_b16 v[200:201], v15 offset:16384
    ds_read_b64_tr_b16 v[202:203], v15 offset:17408
    ds_read_b64_tr_b16 v[140:141], v14 offset:24576
    ds_read_b64_tr_b16 v[142:143], v14 offset:25600
    ds_read_b64_tr_b16 v[204:205], v15 offset:24576
    ds_read_b64_tr_b16 v[206:207], v15 offset:25600
    ds_read_b64_tr_b16 v[144:145], v14 offset:32768
    ds_read_b64_tr_b16 v[146:147], v14 offset:33792
    ds_read_b64_tr_b16 v[208:209], v15 offset:32768
    ds_read_b64_tr_b16 v[210:211], v15 offset:33792
    ds_read_b64_tr_b16 v[148:149], v14 offset:40960
    ds_read_b64_tr_b16 v[150:151], v14 offset:41984
    ds_read_b64_tr_b16 v[212:213], v15 offset:40960
    ds_read_b64_tr_b16 v[214:215], v15 offset:41984
    ds_read_b64_tr_b16 v[152:153], v14 offset:49152
    ds_read_b64_tr_b16 v[154:155], v14 offset:50176
    ds_read_b64_tr_b16 v[216:217], v15 offset:49152
    ds_read_b64_tr_b16 v[218:219], v15 offset:50176
    ds_read_b64_tr_b16 v[156:157], v14 offset:57344
    ds_read_b64_tr_b16 v[158:159], v14 offset:58368
    ds_read_b64_tr_b16 v[220:221], v15 offset:57344
    ds_read_b64_tr_b16 v[222:223], v15 offset:58368
    v_add_u32 v16, 0x10000, v14
    v_add_u32 v17, 0x10000, v15
    ds_read_b64_tr_b16 v[160:161], v16 offset:0
    ds_read_b64_tr_b16 v[162:163], v16 offset:1024
    ds_read_b64_tr_b16 v[224:225], v17 offset:0
    ds_read_b64_tr_b16 v[226:227], v17 offset:1024
    ds_read_b64_tr_b16 v[164:165], v16 offset:8192
    ds_read_b64_tr_b16 v[166:167], v16 offset:9216
    ds_read_b64_tr_b16 v[228:229], v17 offset:8192
    ds_read_b64_tr_b16 v[230:231], v17 offset:9216
    ds_read_b64_tr_b16 v[168:169], v16 offset:16384
    ds_read_b64_tr_b16 v[170:171], v16 offset:17408
    ds_read_b64_tr_b16 v[232:233], v17 offset:16384
    ds_read_b64_tr_b16 v[234:235], v17 offset:17408
    ds_read_b64_tr_b16 v[172:173], v16 offset:24576
    ds_read_b64_tr_b16 v[174:175], v16 offset:25600
    ds_read_b64_tr_b16 v[236:237], v17 offset:24576
    ds_read_b64_tr_b16 v[238:239], v17 offset:25600
    v_add_u32 v16, 0x10000, v14
    v_add_u32 v17, 0x10000, v15
    ds_read_b64_tr_b16 v[176:177], v16 offset:32768
    ds_read_b64_tr_b16 v[178:179], v16 offset:33792
    ds_read_b64_tr_b16 v[240:241], v17 offset:32768
    ds_read_b64_tr_b16 v[242:243], v17 offset:33792
    ds_read_b64_tr_b16 v[180:181], v16 offset:40960
    ds_read_b64_tr_b16 v[182:183], v16 offset:41984
    ds_read_b64_tr_b16 v[244:245], v17 offset:40960
    ds_read_b64_tr_b16 v[246:247], v17 offset:41984
    ds_read_b64_tr_b16 v[184:185], v16 offset:49152
    ds_read_b64_tr_b16 v[186:187], v16 offset:50176
    ds_read_b64_tr_b16 v[248:249], v17 offset:49152
    ds_read_b64_tr_b16 v[250:251], v17 offset:50176
    ds_read_b64_tr_b16 v[188:189], v16 offset:57344
    ds_read_b64_tr_b16 v[190:191], v16 offset:58368
    ds_read_b64_tr_b16 v[252:253], v17 offset:57344
    ds_read_b64_tr_b16 v[254:255], v17 offset:58368
    v_cmp_ge_i32 s[80:81], v117, 0
    v_cmp_ge_i32 s[82:83], v117, 1
    v_cmp_ge_i32 s[84:85], v117, 2
    v_cmp_ge_i32 s[86:87], v117, 3
    v_cmp_ge_i32 s[88:89], v117, 16
    v_cmp_ge_i32 s[90:91], v117, 17
    v_cmp_ge_i32 s[92:93], v117, 18
    v_cmp_ge_i32 s[94:95], v117, 19
    s_mov_b32 s96, 0
    s_mov_b32 s97, -1
    s_mov_b32 s98, 0x3db504f3
    s_mov_b32 s99, 0x3fb8aa3b
    s_mov_b32 s67, 0
    s_waitcnt lgkmcnt(0)
    s_barrier
    ds_read_b128 v[44:47], v3 offset:0
    ds_read_b128 v[48:51], v3 offset:16384
    s_branch L_P_q
L_P_loop:
    s_cmp_ge_u32 s27, s28
    s_cbranch_scc1 L_P_last
    s_cmp_lg_u32 s27, 1
    s_cbranch_scc1 L_hok_8
    s_waitcnt vmcnt(0)
    s_branch L_pc_12
L_pa_9:
    buffer_load_dwordx4 v[12:15], v1, s[4:7], s30 offen offset:0 sc1
    buffer_load_dwordx4 v[16:19], v1, s[4:7], s30 offen offset:1024 sc1
    buffer_load_dwordx4 v[20:23], v1, s[4:7], s30 offen offset:2048 sc1
    buffer_load_dwordx4 v[24:27], v1, s[4:7], s30 offen offset:3072 sc1
    buffer_load_dwordx4 v[28:31], v1, s[4:7], s72 offen offset:0 sc1
    buffer_load_dwordx4 v[32:35], v1, s[4:7], s72 offen offset:1024 sc1
    buffer_load_dwordx4 v[36:39], v1, s[4:7], s72 offen offset:2048 sc1
    buffer_load_dwordx4 v[40:43], v1, s[4:7], s72 offen offset:3072 sc1
    s_waitcnt vmcnt(0)
L_pc_12:
    v_max3_u32 v60, v12, v13, v14
    v_max3_u32 v61, v15, v16, v17
    v_max3_u32 v62, v18, v19, v20
    v_max3_u32 v63, v21, v22, v23
    v_max3_u32 v64, v24, v25, v26
    v_max3_u32 v65, v27, v28, v29
    v_max3_u32 v66, v30, v31, v32
    v_max3_u32 v67, v33, v34, v35
    v_max3_u32 v68, v36, v37, v38
    v_max3_u32 v69, v39, v40, v41
    v_max3_u32 v70, v60, v61, v62
    v_max3_u32 v71, v63, v64, v65
    v_max3_u32 v72, v66, v67, v68
    v_max3_u32 v73, v69, v42, v43
    v_max3_u32 v74, v70, v71, v72
    v_max_u32 v75, v74, v73
    v_cmp_eq_u32 vcc, -1, v75
    s_nop 0
    s_cbranch_vccz L_pk_10
    s_add_u32 s31, s31, 1
    s_cmp_gt_u32 s31, 1048576
    s_cbranch_scc1 L_abort
L_pi_11:
    s_sleep 2
    buffer_load_dwordx4 v[40:43], v1, s[4:7], s72 offen offset:3072 sc1
    s_add_u32 s31, s31, 1
    s_cmp_gt_u32 s31, 1048576
    s_cbranch_scc1 L_abort
    s_waitcnt vmcnt(0)
    v_max3_u32 v60, v40, v41, v42
    v_max_u32 v61, v60, v43
    v_cmp_eq_u32 vcc, -1, v61
    s_nop 0
    s_cbranch_vccnz L_pi_11
    s_branch L_pa_9
L_pk_10:
    s_cmp_lg_u32 s20, 0
    s_cbranch_scc1 L_wd_14
    s_branch L_wf_15
L_wc_13:
    s_sleep 8
L_wf_15:
    buffer_load_dword v122, off, s[76:79], 0 offset:200 sc1
    buffer_load_dword v123, off, s[76:79], 0 offset:184 sc1
    s_add_u32 s31, s31, 1
    s_cmp_gt_u32 s31, 1048576
    s_cbranch_scc1 L_abort
    s_waitcnt vmcnt(0)
    v_add_u32 v122, v122, v123
    s_nop 0
    v_readfirstlane_b32 s70, v122
    s_cmp_lg_u32 s70, 64
    s_nop 2
    s_cbranch_scc1 L_wc_13
L_wd_14:
    s_barrier
L_hok_8:
    s_waitcnt lgkmcnt(0)
    s_barrier
    v_xor_b32 v11, 0, v2
    s_waitcnt vmcnt(7)
    ds_write_b128 v11, v[12:15] offset:0
    v_xor_b32 v11, 16, v2
    s_waitcnt vmcnt(6)
    ds_write_b128 v11, v[16:19] offset:1024
    v_xor_b32 v11, 32, v2
    s_waitcnt vmcnt(5)
    ds_write_b128 v11, v[20:23] offset:2048
    v_xor_b32 v11, 48, v2
    s_waitcnt vmcnt(4)
    ds_write_b128 v11, v[24:27] offset:3072
    v_xor_b32 v11, 64, v2
    s_waitcnt vmcnt(3)
    ds_write_b128 v11, v[28:31] offset:4096
    v_xor_b32 v11, 80, v2
    s_waitcnt vmcnt(2)
    ds_write_b128 v11, v[32:35] offset:5120
    v_xor_b32 v11, 96, v2
    s_waitcnt vmcnt(1)
    ds_write_b128 v11, v[36:39] offset:6144
    v_xor_b32 v11, 112, v2
    s_waitcnt vmcnt(0)
    ds_write_b128 v11, v[40:43] offset:7168
    s_waitcnt lgkmcnt(0)
    s_barrier
L_P_kv:
    ds_read_b128 v[44:47], v3 offset:0
    ds_read_b128 v[48:51], v3 offset:16384
    ds_read_b128 v[52:55], v4 offset:0
    ds_read_b128 v[56:59], v4 offset:16384
    s_waitcnt lgkmcnt(3)
    v_mfma_f32_16x16x32_bf16 v[60:63], a[0:3], v[44:47], 0
    v_mfma_f32_16x16x32_bf16 v[76:79], v[44:47], a[128:131], 0
    v_mfma_f32_16x16x32_bf16 v[64:67], a[64:67], v[44:47], 0
    v_mfma_f32_16x16x32_bf16 v[84:87], v[44:47], a[192:195], 0
    s_waitcnt lgkmcnt(2)
    v_mfma_f32_16x16x32_bf16 v[68:71], a[0:3], v[48:51], 0
    v_mfma_f32_16x16x32_bf16 v[80:83], v[48:51], a[128:131], 0
    v_mfma_f32_16x16x32_bf16 v[72:75], a[64:67], v[48:51], 0
    v_mfma_f32_16x16x32_bf16 v[88:91], v[48:51], a[192:195], 0
    v_mov_b64 v[120:121], -1
    v_mov_b64 v[122:123], -1
    s_lshr_b32 s70, s64, 1
    s_add_u32 s70, s70, 0x1000000
    ds_read_b128 v[44:47], v5 offset:0
    ds_read_b128 v[48:51], v5 offset:16384
    s_waitcnt lgkmcnt(3)
    v_mfma_f32_16x16x32_bf16 v[60:63], a[4:7], v[52:55], v[60:63]
    v_mfma_f32_16x16x32_bf16 v[76:79], v[52:55], a[132:135], v[76:79]
    v_mfma_f32_16x16x32_bf16 v[64:67], a[68:71], v[52:55], v[64:67]
    v_mfma_f32_16x16x32_bf16 v[84:87], v[52:55], a[196:199], v[84:87]
    s_waitcnt lgkmcnt(2)
    v_mfma_f32_16x16x32_bf16 v[68:71], a[4:7], v[56:59], v[68:71]
    v_mfma_f32_16x16x32_bf16 v[80:83], v[56:59], a[132:135], v[80:83]
    v_mfma_f32_16x16x32_bf16 v[72:75], a[68:71], v[56:59], v[72:75]
    v_mfma_f32_16x16x32_bf16 v[88:91], v[56:59], a[196:199], v[88:91]
    buffer_store_dwordx4 v[120:123], v7, s[4:7], s70 offen sc1
    s_lshr_b32 s70, s64, 2
    s_add_u32 s70, s70, 0x1840000
    v_lshrrev_b32 v11, 1, v7
    ds_read_b128 v[52:55], v6 offset:0
    ds_read_b128 v[56:59], v6 offset:16384
    s_waitcnt lgkmcnt(3)
    v_mfma_f32_16x16x32_bf16 v[60:63], a[8:11], v[44:47], v[60:63]
    v_mfma_f32_16x16x32_bf16 v[76:79], v[44:47], a[136:139], v[76:79]
    v_mfma_f32_16x16x32_bf16 v[64:67], a[72:75], v[44:47], v[64:67]
    v_mfma_f32_16x16x32_bf16 v[84:87], v[44:47], a[200:203], v[84:87]
    s_waitcnt lgkmcnt(2)
    v_mfma_f32_16x16x32_bf16 v[68:71], a[8:11], v[48:51], v[68:71]
    v_mfma_f32_16x16x32_bf16 v[80:83], v[48:51], a[136:139], v[80:83]
    v_mfma_f32_16x16x32_bf16 v[72:75], a[72:75], v[48:51], v[72:75]
    v_mfma_f32_16x16x32_bf16 v[88:91], v[48:51], a[200:203], v[88:91]
    buffer_store_dwordx2 v[120:121], v11, s[4:7], s70 offen sc1
    s_add_u32 s70, s64, 0x4000000
    s_cmp_eq_u32 s27, 0
    s_cselect_b32 s70, 0x40000000, s70
    ds_read_b128 v[44:47], v3 offset:256
    ds_read_b128 v[48:51], v3 offset:16640
    s_waitcnt lgkmcnt(3)
    v_mfma_f32_16x16x32_bf16 v[60:63], a[12:15], v[52:55], v[60:63]
    v_mfma_f32_16x16x32_bf16 v[76:79], v[52:55], a[140:143], v[76:79]
    v_mfma_f32_16x16x32_bf16 v[64:67], a[76:79], v[52:55], v[64:67]
    v_mfma_f32_16x16x32_bf16 v[84:87], v[52:55], a[204:207], v[84:87]
    s_waitcnt lgkmcnt(2)
    v_mfma_f32_16x16x32_bf16 v[68:71], a[12:15], v[56:59], v[68:71]
    v_mfma_f32_16x16x32_bf16 v[80:83], v[56:59], a[140:143], v[80:83]
    v_mfma_f32_16x16x32_bf16 v[72:75], a[76:79], v[56:59], v[72:75]
    v_mfma_f32_16x16x32_bf16 v[88:91], v[56:59], a[204:207], v[88:91]
    buffer_store_dwordx4 v[120:123], v10, s[4:7], s70 offen sc1
    ds_read_b128 v[52:55], v4 offset:256
    ds_read_b128 v[56:59], v4 offset:16640
    s_waitcnt lgkmcnt(3)
    v_mfma_f32_16x16x32_bf16 v[60:63], a[16:19], v[44:47], v[60:63]
    v_mfma_f32_16x16x32_bf16 v[76:79], v[44:47], a[144:147], v[76:79]
    v_mfma_f32_16x16x32_bf16 v[64:67], a[80:83], v[44:47], v[64:67]
    v_mfma_f32_16x16x32_bf16 v[84:87], v[44:47], a[208:211], v[84:87]
    s_waitcnt lgkmcnt(2)
    v_mfma_f32_16x16x32_bf16 v[68:71], a[16:19], v[48:51], v[68:71]
    v_mfma_f32_16x16x32_bf16 v[80:83], v[48:51], a[144:147], v[80:83]
    v_mfma_f32_16x16x32_bf16 v[72:75], a[80:83], v[48:51], v[72:75]
    v_mfma_f32_16x16x32_bf16 v[88:91], v[48:51], a[208:211], v[88:91]
    buffer_store_dwordx4 v[120:123], v10, s[4:7], s70 offen offset:1024 sc1
    ds_read_b128 v[44:47], v5 offset:256
    ds_read_b128 v[48:51], v5 offset:16640
    s_waitcnt lgkmcnt(3)
    v_mfma_f32_16x16x32_bf16 v[60:63], a[20:23], v[52:55], v[60:63]
    v_mfma_f32_16x16x32_bf16 v[76:79], v[52:55], a[148:151], v[76:79]
    v_mfma_f32_16x16x32_bf16 v[64:67], a[84:87], v[52:55], v[64:67]
    v_mfma_f32_16x16x32_bf16 v[84:87], v[52:55], a[212:215], v[84:87]
    s_waitcnt lgkmcnt(2)
    v_mfma_f32_16x16x32_bf16 v[68:71], a[20:23], v[56:59], v[68:71]
    v_mfma_f32_16x16x32_bf16 v[80:83], v[56:59], a[148:151], v[80:83]
    v_mfma_f32_16x16x32_bf16 v[72:75], a[84:87], v[56:59], v[72:75]
    v_mfma_f32_16x16x32_bf16 v[88:91], v[56:59], a[212:215], v[88:91]
    ds_read_b128 v[52:55], v6 offset:256
    ds_read_b128 v[56:59], v6 offset:16640
    s_waitcnt lgkmcnt(3)
    v_mfma_f32_16x16x32_bf16 v[60:63], a[24:27], v[44:47], v[60:63]
    v_mfma_f32_16x16x32_bf16 v[76:79], v[44:47], a[152:155], v[76:79]
    v_mfma_f32_16x16x32_bf16 v[64:67], a[88:91], v[44:47], v[64:67]
    v_mfma_f32_16x16x32_bf16 v[84:87], v[44:47], a[216:219], v[84:87]
    s_waitcnt lgkmcnt(2)
    v_mfma_f32_16x16x32_bf16 v[68:71], a[24:27], v[48:51], v[68:71]
    v_mfma_f32_16x16x32_bf16 v[80:83], v[48:51], a[152:155], v[80:83]
    v_mfma_f32_16x16x32_bf16 v[72:75], a[88:91], v[48:51], v[72:75]
    v_mfma_f32_16x16x32_bf16 v[88:91], v[48:51], a[216:219], v[88:91]
    ds_read_b128 v[44:47], v3 offset:512
    ds_read_b128 v[48:51], v3 offset:16896
    s_waitcnt lgkmcnt(3)
    v_mfma_f32_16x16x32_bf16 v[60:63], a[28:31], v[52:55], v[60:63]
    v_mfma_f32_16x16x32_bf16 v[76:79], v[52:55], a[156:159], v[76:79]
    v_mfma_f32_16x16x32_bf16 v[64:67], a[92:95], v[52:55], v[64:67]
    v_mfma_f32_16x16x32_bf16 v[84:87], v[52:55], a[220:223], v[84:87]
    s_waitcnt lgkmcnt(2)
    v_mfma_f32_16x16x32_bf16 v[68:71], a[28:31], v[56:59], v[68:71]
    v_mfma_f32_16x16x32_bf16 v[80:83], v[56:59], a[156:159], v[80:83]
    v_mfma_f32_16x16x32_bf16 v[72:75], a[92:95], v[56:59], v[72:75]
    v_mfma_f32_16x16x32_bf16 v[88:91], v[56:59], a[220:223], v[88:91]
    ds_read_b128 v[52:55], v4 offset:512
    ds_read_b128 v[56:59], v4 offset:16896
    s_waitcnt lgkmcnt(3)
    v_mfma_f32_16x16x32_bf16 v[60:63], a[32:35], v[44:47], v[60:63]
    v_mfma_f32_16x16x32_bf16 v[76:79], v[44:47], a[160:163], v[76:79]
    v_mfma_f32_16x16x32_bf16 v[64:67], a[96:99], v[44:47], v[64:67]
    v_mfma_f32_16x16x32_bf16 v[84:87], v[44:47], a[224:227], v[84:87]
    s_waitcnt lgkmcnt(2)
    v_mfma_f32_16x16x32_bf16 v[68:71], a[32:35], v[48:51], v[68:71]
    v_mfma_f32_16x16x32_bf16 v[80:83], v[48:51], a[160:163], v[80:83]
    v_mfma_f32_16x16x32_bf16 v[72:75], a[96:99], v[48:51], v[72:75]
    v_mfma_f32_16x16x32_bf16 v[88:91], v[48:51], a[224:227], v[88:91]
    ds_read_b128 v[44:47], v5 offset:512
    ds_read_b128 v[48:51], v5 offset:16896
    s_waitcnt lgkmcnt(3)
    v_mfma_f32_16x16x32_bf16 v[60:63], a[36:39], v[52:55], v[60:63]
    v_mfma_f32_16x16x32_bf16 v[76:79], v[52:55], a[164:167], v[76:79]
    v_mfma_f32_16x16x32_bf16 v[64:67], a[100:103], v[52:55], v[64:67]
    v_mfma_f32_16x16x32_bf16 v[84:87], v[52:55], a[228:231], v[84:87]
    s_waitcnt lgkmcnt(2)
    v_mfma_f32_16x16x32_bf16 v[68:71], a[36:39], v[56:59], v[68:71]
    v_mfma_f32_16x16x32_bf16 v[80:83], v[56:59], a[164:167], v[80:83]
    v_mfma_f32_16x16x32_bf16 v[72:75], a[100:103], v[56:59], v[72:75]
    v_mfma_f32_16x16x32_bf16 v[88:91], v[56:59], a[228:231], v[88:91]
    ds_read_b128 v[52:55], v6 offset:512
    ds_read_b128 v[56:59], v6 offset:16896
    s_waitcnt lgkmcnt(3)
    v_mfma_f32_16x16x32_bf16 v[60:63], a[40:43], v[44:47], v[60:63]
    v_mfma_f32_16x16x32_bf16 v[76:79], v[44:47], a[168:171], v[76:79]
    v_mfma_f32_16x16x32_bf16 v[64:67], a[104:107], v[44:47], v[64:67]
    v_mfma_f32_16x16x32_bf16 v[84:87], v[44:47], a[232:235], v[84:87]
    s_waitcnt lgkmcnt(2)
    v_mfma_f32_16x16x32_bf16 v[68:71], a[40:43], v[48:51], v[68:71]
    v_mfma_f32_16x16x32_bf16 v[80:83], v[48:51], a[168:171], v[80:83]
    v_mfma_f32_16x16x32_bf16 v[72:75], a[104:107], v[48:51], v[72:75]
    v_mfma_f32_16x16x32_bf16 v[88:91], v[48:51], a[232:235], v[88:91]
    ds_read_b128 v[44:47], v3 offset:768
    ds_read_b128 v[48:51], v3 offset:17152
    s_waitcnt lgkmcnt(3)
    v_mfma_f32_16x16x32_bf16 v[60:63], a[44:47], v[52:55], v[60:63]
    v_mfma_f32_16x16x32_bf16 v[76:79], v[52:55], a[172:175], v[76:79]
    v_mfma_f32_16x16x32_bf16 v[64:67], a[108:111], v[52:55], v[64:67]
    v_mfma_f32_16x16x32_bf16 v[84:87], v[52:55], a[236:239], v[84:87]
    s_waitcnt lgkmcnt(2)
    v_mfma_f32_16x16x32_bf16 v[68:71], a[44:47], v[56:59], v[68:71]
    v_mfma_f32_16x16x32_bf16 v[80:83], v[56:59], a[172:175], v[80:83]
    v_mfma_f32_16x16x32_bf16 v[72:75], a[108:111], v[56:59], v[72:75]
    v_mfma_f32_16x16x32_bf16 v[88:91], v[56:59], a[236:239], v[88:91]
    ds_read_b128 v[52:55], v4 offset:768
    ds_read_b128 v[56:59], v4 offset:17152
    s_waitcnt lgkmcnt(3)
    v_mfma_f32_16x16x32_bf16 v[60:63], a[48:51], v[44:47], v[60:63]
    v_mfma_f32_16x16x32_bf16 v[76:79], v[44:47], a[176:179], v[76:79]
    v_mfma_f32_16x16x32_bf16 v[64:67], a[112:115], v[44:47], v[64:67]
    v_mfma_f32_16x16x32_bf16 v[84:87], v[44:47], a[240:243], v[84:87]
    s_waitcnt lgkmcnt(2)
    v_mfma_f32_16x16x32_bf16 v[68:71], a[48:51], v[48:51], v[68:71]
    v_mfma_f32_16x16x32_bf16 v[80:83], v[48:51], a[176:179], v[80:83]
    v_mfma_f32_16x16x32_bf16 v[72:75], a[112:115], v[48:51], v[72:75]
    v_mfma_f32_16x16x32_bf16 v[88:91], v[48:51], a[240:243], v[88:91]
    ds_read_b128 v[44:47], v5 offset:768
    ds_read_b128 v[48:51], v5 offset:17152
    s_waitcnt lgkmcnt(3)
    v_mfma_f32_16x16x32_bf16 v[60:63], a[52:55], v[52:55], v[60:63]
    v_mfma_f32_16x16x32_bf16 v[76:79], v[52:55], a[180:183], v[76:79]
    v_mfma_f32_16x16x32_bf16 v[64:67], a[116:119], v[52:55], v[64:67]
    v_mfma_f32_16x16x32_bf16 v[84:87], v[52:55], a[244:247], v[84:87]
    s_waitcnt lgkmcnt(2)
    v_mfma_f32_16x16x32_bf16 v[68:71], a[52:55], v[56:59], v[68:71]
    v_mfma_f32_16x16x32_bf16 v[80:83], v[56:59], a[180:183], v[80:83]
    v_mfma_f32_16x16x32_bf16 v[72:75], a[116:119], v[56:59], v[72:75]
    v_mfma_f32_16x16x32_bf16 v[88:91], v[56:59], a[244:247], v[88:91]
    ds_read_b128 v[52:55], v6 offset:768
    ds_read_b128 v[56:59], v6 offset:17152
    s_waitcnt lgkmcnt(3)
    v_mfma_f32_16x16x32_bf16 v[60:63], a[56:59], v[44:47], v[60:63]
    v_mfma_f32_16x16x32_bf16 v[76:79], v[44:47], a[184:187], v[76:79]
    v_mfma_f32_16x16x32_bf16 v[64:67], a[120:123], v[44:47], v[64:67]
    v_mfma_f32_16x16x32_bf16 v[84:87], v[44:47], a[248:251], v[84:87]
    s_waitcnt lgkmcnt(2)
    v_mfma_f32_16x16x32_bf16 v[68:71], a[56:59], v[48:51], v[68:71]
    v_mfma_f32_16x16x32_bf16 v[80:83], v[48:51], a[184:187], v[80:83]
    v_mfma_f32_16x16x32_bf16 v[72:75], a[120:123], v[48:51], v[72:75]
    v_mfma_f32_16x16x32_bf16 v[88:91], v[48:51], a[248:251], v[88:91]
    s_waitcnt lgkmcnt(1)
    v_mfma_f32_16x16x32_bf16 v[60:63], a[60:63], v[52:55], v[60:63]
    v_mfma_f32_16x16x32_bf16 v[76:79], v[52:55], a[188:191], v[76:79]
    v_mfma_f32_16x16x32_bf16 v[64:67], a[124:127], v[52:55], v[64:67]
    v_mfma_f32_16x16x32_bf16 v[84:87], v[52:55], a[252:255], v[84:87]
    s_waitcnt lgkmcnt(0)
    v_mfma_f32_16x16x32_bf16 v[68:71], a[60:63], v[56:59], v[68:71]
    v_mfma_f32_16x16x32_bf16 v[80:83], v[56:59], a[188:191], v[80:83]
    v_mfma_f32_16x16x32_bf16 v[72:75], a[124:127], v[56:59], v[72:75]
    v_mfma_f32_16x16x32_bf16 v[88:91], v[56:59], a[252:255], v[88:91]
    ds_read_b128 v[44:47], v3 offset:0
    ds_read_b128 v[48:51], v3 offset:16384
    v_cvt_pk_bf16_f32 v92, v60, v61
    v_cvt_pk_bf16_f32 v93, v62, v63
    v_cvt_pk_bf16_f32 v94, v64, v65
    v_cvt_pk_bf16_f32 v95, v66, v67
    v_cvt_pk_bf16_f32 v96, v68, v69
    v_cvt_pk_bf16_f32 v97, v70, v71
    v_cvt_pk_bf16_f32 v98, v72, v73
    v_cvt_pk_bf16_f32 v99, v74, v75
    v_cvt_pk_bf16_f32 v100, v76, v77
    v_cvt_pk_bf16_f32 v101, v78, v79
    v_cvt_pk_bf16_f32 v102, v80, v81
    v_cvt_pk_bf16_f32 v103, v82, v83
    v_cvt_pk_bf16_f32 v104, v84, v85
    v_cvt_pk_bf16_f32 v105, v86, v87
    v_cvt_pk_bf16_f32 v106, v88, v89
    v_cvt_pk_bf16_f32 v107, v90, v91
    s_add_u32 s70, s64, 0x2000000
    s_add_u32 s71, s70, 4096
    buffer_store_dwordx4 v[92:95], v7, s[4:7], s70 offen sc1
    buffer_store_dwordx4 v[96:99], v7, s[4:7], s71 offen sc1
    s_lshl_b32 s71, s20, 10
    s_add_u32 s70, s64, s71
    s_add_u32 s70, s70, 0x3000000
    buffer_store_dwordx4 v[100:103], v7, s[4:7], s70 offen offset:0 sc1
    buffer_store_dwordx4 v[104:107], v7, s[4:7], s70 offen offset:1024 sc1
    s_waitcnt vmcnt(0)
    s_barrier
    s_add_u32 s27, s27, 1
    s_cmp_lg_u32 s20, 0
    s_cbranch_scc1 L_pf_16
    v_mov_b32 v11, s27
    buffer_store_dword v11, off, s[4:7], s65 sc1
L_pf_16:
    s_cmp_eq_u32 s27, 1
    s_cbranch_scc1 L_P_t0
L_P_q:
    ds_read_b128 v[52:55], v4 offset:0
    ds_read_b128 v[56:59], v4 offset:16384
    s_waitcnt lgkmcnt(3)
    v_mfma_f32_16x16x32_bf16 v[60:63], v[128:131], v[44:47], 0
    v_mfma_f32_16x16x32_bf16 v[64:67], v[192:195], v[44:47], 0
    s_waitcnt lgkmcnt(2)
    v_mfma_f32_16x16x32_bf16 v[68:71], v[128:131], v[48:51], 0
    v_mfma_f32_16x16x32_bf16 v[72:75], v[192:195], v[48:51], 0
    s_add_u32 s30, s30, 0x18000
    s_add_u32 s72, s30, 4096
    ds_read_b128 v[44:47], v5 offset:0
    ds_read_b128 v[48:51], v5 offset:16384
    s_waitcnt lgkmcnt(3)
    v_mfma_f32_16x16x32_bf16 v[60:63], v[132:135], v[52:55], v[60:63]
    v_mfma_f32_16x16x32_bf16 v[64:67], v[196:199], v[52:55], v[64:67]
    s_waitcnt lgkmcnt(2)
    v_mfma_f32_16x16x32_bf16 v[68:71], v[132:135], v[56:59], v[68:71]
    v_mfma_f32_16x16x32_bf16 v[72:75], v[196:199], v[56:59], v[72:75]
    buffer_load_dwordx4 v[12:15], v1, s[4:7], s30 offen offset:0 sc1
    ds_read_b128 v[52:55], v6 offset:0
    ds_read_b128 v[56:59], v6 offset:16384
    s_waitcnt lgkmcnt(3)
    v_mfma_f32_16x16x32_bf16 v[60:63], v[136:139], v[44:47], v[60:63]
    v_mfma_f32_16x16x32_bf16 v[64:67], v[200:203], v[44:47], v[64:67]
    s_waitcnt lgkmcnt(2)
    v_mfma_f32_16x16x32_bf16 v[68:71], v[136:139], v[48:51], v[68:71]
    v_mfma_f32_16x16x32_bf16 v[72:75], v[200:203], v[48:51], v[72:75]
    buffer_load_dwordx4 v[16:19], v1, s[4:7], s30 offen offset:1024 sc1
    ds_read_b128 v[44:47], v3 offset:256
    ds_read_b128 v[48:51], v3 offset:16640
    s_waitcnt lgkmcnt(3)
    v_mfma_f32_16x16x32_bf16 v[60:63], v[140:143], v[52:55], v[60:63]
    v_mfma_f32_16x16x32_bf16 v[64:67], v[204:207], v[52:55], v[64:67]
    s_waitcnt lgkmcnt(2)
    v_mfma_f32_16x16x32_bf16 v[68:71], v[140:143], v[56:59], v[68:71]
    v_mfma_f32_16x16x32_bf16 v[72:75], v[204:207], v[56:59], v[72:75]
    buffer_load_dwordx4 v[20:23], v1, s[4:7], s30 offen offset:2048 sc1
    ds_read_b128 v[52:55], v4 offset:256
    ds_read_b128 v[56:59], v4 offset:16640
    s_waitcnt lgkmcnt(3)
    v_mfma_f32_16x16x32_bf16 v[60:63], v[144:147], v[44:47], v[60:63]
    v_mfma_f32_16x16x32_bf16 v[64:67], v[208:211], v[44:47], v[64:67]
    s_waitcnt lgkmcnt(2)
    v_mfma_f32_16x16x32_bf16 v[68:71], v[144:147], v[48:51], v[68:71]
    v_mfma_f32_16x16x32_bf16 v[72:75], v[208:211], v[48:51], v[72:75]
    buffer_load_dwordx4 v[24:27], v1, s[4:7], s30 offen offset:3072 sc1
    ds_read_b128 v[44:47], v5 offset:256
    ds_read_b128 v[48:51], v5 offset:16640
    s_waitcnt lgkmcnt(3)
    v_mfma_f32_16x16x32_bf16 v[60:63], v[148:151], v[52:55], v[60:63]
    v_mfma_f32_16x16x32_bf16 v[64:67], v[212:215], v[52:55], v[64:67]
    s_waitcnt lgkmcnt(2)
    v_mfma_f32_16x16x32_bf16 v[68:71], v[148:151], v[56:59], v[68:71]
    v_mfma_f32_16x16x32_bf16 v[72:75], v[212:215], v[56:59], v[72:75]
    buffer_load_dwordx4 v[28:31], v1, s[4:7], s72 offen offset:0 sc1
    ds_read_b128 v[52:55], v6 offset:256
    ds_read_b128 v[56:59], v6 offset:16640
    s_waitcnt lgkmcnt(3)
    v_mfma_f32_16x16x32_bf16 v[60:63], v[152:155], v[44:47], v[60:63]
    v_mfma_f32_16x16x32_bf16 v[64:67], v[216:219], v[44:47], v[64:67]
    s_waitcnt lgkmcnt(2)
    v_mfma_f32_16x16x32_bf16 v[68:71], v[152:155], v[48:51], v[68:71]
    v_mfma_f32_16x16x32_bf16 v[72:75], v[216:219], v[48:51], v[72:75]
    buffer_load_dwordx4 v[32:35], v1, s[4:7], s72 offen offset:1024 sc1
    ds_read_b128 v[44:47], v3 offset:512
    ds_read_b128 v[48:51], v3 offset:16896
    s_waitcnt lgkmcnt(3)
    v_mfma_f32_16x16x32_bf16 v[60:63], v[156:159], v[52:55], v[60:63]
    v_mfma_f32_16x16x32_bf16 v[64:67], v[220:223], v[52:55], v[64:67]
    s_waitcnt lgkmcnt(2)
    v_mfma_f32_16x16x32_bf16 v[68:71], v[156:159], v[56:59], v[68:71]
    v_mfma_f32_16x16x32_bf16 v[72:75], v[220:223], v[56:59], v[72:75]
    buffer_load_dwordx4 v[36:39], v1, s[4:7], s72 offen offset:2048 sc1
    ds_read_b128 v[52:55], v4 offset:512
    ds_read_b128 v[56:59], v4 offset:16896
    s_waitcnt lgkmcnt(3)
    v_mfma_f32_16x16x32_bf16 v[60:63], v[160:163], v[44:47], v[60:63]
    v_mfma_f32_16x16x32_bf16 v[64:67], v[224:227], v[44:47], v[64:67]
    s_waitcnt lgkmcnt(2)
    v_mfma_f32_16x16x32_bf16 v[68:71], v[160:163], v[48:51], v[68:71]
    v_mfma_f32_16x16x32_bf16 v[72:75], v[224:227], v[48:51], v[72:75]
    buffer_load_dwordx4 v[40:43], v1, s[4:7], s72 offen offset:3072 sc1
    ds_read_b128 v[44:47], v5 offset:512
    ds_read_b128 v[48:51], v5 offset:16896
    s_waitcnt lgkmcnt(3)
    v_mfma_f32_16x16x32_bf16 v[60:63], v[164:167], v[52:55], v[60:63]
    v_mfma_f32_16x16x32_bf16 v[64:67], v[228:231], v[52:55], v[64:67]
    s_waitcnt lgkmcnt(2)
    v_mfma_f32_16x16x32_bf16 v[68:71], v[164:167], v[56:59], v[68:71]
    v_mfma_f32_16x16x32_bf16 v[72:75], v[228:231], v[56:59], v[72:75]
    ds_read_b128 v[52:55], v6 offset:512
    ds_read_b128 v[56:59], v6 offset:16896
    s_waitcnt lgkmcnt(3)
    v_mfma_f32_16x16x32_bf16 v[60:63], v[168:171], v[44:47], v[60:63]
    v_mfma_f32_16x16x32_bf16 v[64:67], v[232:235], v[44:47], v[64:67]
    s_waitcnt lgkmcnt(2)
    v_mfma_f32_16x16x32_bf16 v[68:71], v[168:171], v[48:51], v[68:71]
    v_mfma_f32_16x16x32_bf16 v[72:75], v[232:235], v[48:51], v[72:75]
    ds_read_b128 v[44:47], v3 offset:768
    ds_read_b128 v[48:51], v3 offset:17152
    s_waitcnt lgkmcnt(3)
    v_mfma_f32_16x16x32_bf16 v[60:63], v[172:175], v[52:55], v[60:63]
    v_mfma_f32_16x16x32_bf16 v[64:67], v[236:239], v[52:55], v[64:67]
    s_waitcnt lgkmcnt(2)
    v_mfma_f32_16x16x32_bf16 v[68:71], v[172:175], v[56:59], v[68:71]
    v_mfma_f32_16x16x32_bf16 v[72:75], v[236:239], v[56:59], v[72:75]
    ds_read_b128 v[52:55], v4 offset:768
    ds_read_b128 v[56:59], v4 offset:17152
    s_waitcnt lgkmcnt(3)
    v_mfma_f32_16x16x32_bf16 v[60:63], v[176:179], v[44:47], v[60:63]
    v_mfma_f32_16x16x32_bf16 v[64:67], v[240:243], v[44:47], v[64:67]
    s_waitcnt lgkmcnt(2)
    v_mfma_f32_16x16x32_bf16 v[68:71], v[176:179], v[48:51], v[68:71]
    v_mfma_f32_16x16x32_bf16 v[72:75], v[240:243], v[48:51], v[72:75]
    ds_read_b128 v[44:47], v5 offset:768
    ds_read_b128 v[48:51], v5 offset:17152
    s_waitcnt lgkmcnt(3)
    v_mfma_f32_16x16x32_bf16 v[60:63], v[180:183], v[52:55], v[60:63]
    v_mfma_f32_16x16x32_bf16 v[64:67], v[244:247], v[52:55], v[64:67]
    s_waitcnt lgkmcnt(2)
    v_mfma_f32_16x16x32_bf16 v[68:71], v[180:183], v[56:59], v[68:71]
    v_mfma_f32_16x16x32_bf16 v[72:75], v[244:247], v[56:59], v[72:75]
    ds_read_b128 v[52:55], v6 offset:768
    ds_read_b128 v[56:59], v6 offset:17152
    s_waitcnt lgkmcnt(3)
    v_mfma_f32_16x16x32_bf16 v[60:63], v[184:187], v[44:47], v[60:63]
    v_mfma_f32_16x16x32_bf16 v[64:67], v[248:251], v[44:47], v[64:67]
    s_waitcnt lgkmcnt(2)
    v_mfma_f32_16x16x32_bf16 v[68:71], v[184:187], v[48:51], v[68:71]
    v_mfma_f32_16x16x32_bf16 v[72:75], v[248:251], v[48:51], v[72:75]
    s_waitcnt lgkmcnt(1)
    v_mfma_f32_16x16x32_bf16 v[60:63], v[188:191], v[52:55], v[60:63]
    v_mfma_f32_16x16x32_bf16 v[64:67], v[252:255], v[52:55], v[64:67]
    s_waitcnt lgkmcnt(0)
    v_mfma_f32_16x16x32_bf16 v[68:71], v[188:191], v[56:59], v[68:71]
    v_mfma_f32_16x16x32_bf16 v[72:75], v[252:255], v[56:59], v[72:75]
    v_add_u32 v11, s66, v7
    ds_write_b128 v11, v[92:95] offset:8192
    ds_write_b128 v11, v[96:99] offset:12288
    s_nop 0
    v_cvt_pk_bf16_f32 v108, v60, v61
    v_cvt_pk_bf16_f32 v109, v62, v63
    v_cvt_pk_bf16_f32 v110, v64, v65
    v_cvt_pk_bf16_f32 v111, v66, v67
    v_cvt_pk_bf16_f32 v112, v68, v69
    v_cvt_pk_bf16_f32 v113, v70, v71
    v_cvt_pk_bf16_f32 v114, v72, v73
    v_cvt_pk_bf16_f32 v115, v74, v75
    ds_write_b128 v11, v[108:111] offset:0
    ds_write_b128 v11, v[112:115] offset:4096
    s_lshl_b32 s70, s20, 10
    v_add_u32 v11, s70, v11
    ds_write_b128 v11, v[100:103] offset:16384
    ds_write_b128 v11, v[104:107] offset:17408
    s_xor_b32 s66, s66, 24576
    s_add_u32 s64, s64, 0xc0000
    s_cmp_eq_u32 s27, 1
    s_cbranch_scc1 L_P_loop
    s_branch L_P_att
L_P_last:
    s_add_u32 s27, s27, 1
    s_waitcnt lgkmcnt(0)
    s_barrier
L_P_att:
    s_cmp_lg_u32 s27, 2
    s_cbranch_scc1 L_P_att2
    s_cmp_lg_u32 s20, 0
    s_cbranch_scc1 L_wd_18
    s_branch L_wf_19
L_wc_17:
    s_sleep 8
L_wf_19:
    buffer_load_dword v122, off, s[76:79], 0 offset:196 sc1
    buffer_load_dword v123, off, s[76:79], 0 offset:180 sc1
    s_add_u32 s31, s31, 1
    s_cmp_gt_u32 s31, 1048576
    s_cbranch_scc1 L_abort
    s_waitcnt vmcnt(0)
    v_add_u32 v122, v122, v123
    s_nop 0
    v_readfirstlane_b32 s70, v122
    s_cmp_lg_u32 s70, 128
    s_nop 2
    s_cbranch_scc1 L_wc_17
L_wd_18:
    s_barrier
L_P_att2:
    v_add_u32 v11, s67, v9
    ds_read_b128 v[44:47], v11 offset:0
    ds_read_b128 v[48:51], v11 offset:1024
    ds_read_b128 v[52:55], v11 offset:2048
    ds_read_b128 v[56:59], v11 offset:3072
    v_add_u32 v11, s67, v1
    ds_read_b128 v[60:63], v11 offset:8192
    ds_read_b128 v[64:67], v11 offset:9216
    ds_read_b128 v[68:71], v11 offset:10240
    ds_read_b128 v[72:75], v11 offset:11264
    s_waitcnt lgkmcnt(3)
    v_mfma_f32_16x16x32_bf16 v[76:79], v[60:63], v[44:47], 0
    s_waitcnt lgkmcnt(2)
    v_mfma_f32_16x16x32_bf16 v[76:79], v[64:67], v[48:51], v[76:79]
    s_waitcnt lgkmcnt(1)
    v_mfma_f32_16x16x32_bf16 v[76:79], v[68:71], v[52:55], v[76:79]
    s_waitcnt lgkmcnt(0)
    v_mfma_f32_16x16x32_bf16 v[76:79], v[72:75], v[56:59], v[76:79]
    ds_read_b128 v[60:63], v11 offset:12288
    ds_read_b128 v[64:67], v11 offset:13312
    ds_read_b128 v[68:71], v11 offset:14336
    ds_read_b128 v[72:75], v11 offset:15360
    s_waitcnt lgkmcnt(3)
    v_mfma_f32_16x16x32_bf16 v[80:83], v[60:63], v[44:47], 0
    s_waitcnt lgkmcnt(2)
    v_mfma_f32_16x16x32_bf16 v[80:83], v[64:67], v[48:51], v[80:83]
    s_waitcnt lgkmcnt(1)
    v_mfma_f32_16x16x32_bf16 v[80:83], v[68:71], v[52:55], v[80:83]
    s_waitcnt lgkmcnt(0)
    v_mfma_f32_16x16x32_bf16 v[80:83], v[72:75], v[56:59], v[80:83]
    s_lshr_b32 s70, s20, 1
    s_lshl_b32 s70, s70, 12
    v_add_u32 v11, s70, v11
    ds_read_b128 v[96:99], v11 offset:16384
    ds_read_b128 v[100:103], v11 offset:17408
    ds_read_b128 v[104:107], v11 offset:18432
    ds_read_b128 v[108:111], v11 offset:19456
    s_lshr_b32 s69, s68, 1
    s_add_u32 s69, s69, 0x1000000
    s_lshr_b32 s73, s68, 2
    s_add_u32 s73, s73, 0x1840000
    s_add_u32 s74, s68, 0x4000000
    v_cvt_pk_bf16_f32 v112, v76, v77
    v_cvt_pk_bf16_f32 v113, v78, v79
    v_cvt_pk_bf16_f32 v114, v80, v81
    v_cvt_pk_bf16_f32 v115, v82, v83
    v_lshlrev_b32 v76, 16, v112
    v_and_b32 v77, 0xffff0000, v112
    v_lshlrev_b32 v78, 16, v113
    v_and_b32 v79, 0xffff0000, v113
    v_lshlrev_b32 v80, 16, v114
    v_and_b32 v81, 0xffff0000, v114
    v_lshlrev_b32 v82, 16, v115
    v_and_b32 v83, 0xffff0000, v115
    v_mul_f32 v76, s98, v76
    v_mul_f32 v77, s98, v77
    v_mul_f32 v78, s98, v78
    v_mul_f32 v79, s98, v79
    v_mul_f32 v80, s98, v80
    v_mul_f32 v81, s98, v81
    v_mul_f32 v82, s98, v82
    v_mul_f32 v83, s98, v83
    v_cvt_pk_bf16_f32 v112, v76, v77
    v_cvt_pk_bf16_f32 v113, v78, v79
    v_cvt_pk_bf16_f32 v114, v80, v81
    v_cvt_pk_bf16_f32 v115, v82, v83
    v_lshlrev_b32 v76, 16, v112
    v_and_b32 v77, 0xffff0000, v112
    v_lshlrev_b32 v78, 16, v113
    v_and_b32 v79, 0xffff0000, v113
    v_lshlrev_b32 v80, 16, v114
    v_and_b32 v81, 0xffff0000, v114
    v_lshlrev_b32 v82, 16, v115
    v_and_b32 v83, 0xffff0000, v115
    v_mov_b32 v112, 0xce6e0000
    v_cndmask_b32 v76, v112, v76, s[80:81]
    v_cndmask_b32 v77, v112, v77, s[82:83]
    v_cndmask_b32 v78, v112, v78, s[84:85]
    v_cndmask_b32 v79, v112, v79, s[86:87]
    v_cndmask_b32 v80, v112, v80, s[88:89]
    v_cndmask_b32 v81, v112, v81, s[90:91]
    v_cndmask_b32 v82, v112, v82, s[92:93]
    v_cndmask_b32 v83, v112, v83, s[94:95]
    v_max3_f32 v112, v76, v77, v78
    v_max3_f32 v113, v79, v80, v81
    v_max3_f32 v112, v112, v82, v83
    v_max_f32 v124, v112, v113
L_pa_20:
    buffer_load_dwordx2 v[88:89], v8, s[4:7], s73 offen offset:0 sc1
    buffer_load_dwordx2 v[90:91], v8, s[4:7], s73 offen offset:256 sc1
    buffer_load_dwordx2 v[92:93], v8, s[4:7], s73 offen offset:512 sc1
    buffer_load_dwordx2 v[94:95], v8, s[4:7], s73 offen offset:768 sc1
    buffer_load_dwordx4 v[60:63], v1, s[4:7], s69 offen offset:0 sc1
    buffer_load_dwordx4 v[64:67], v1, s[4:7], s69 offen offset:1024 sc1
    buffer_load_dwordx4 v[68:71], v1, s[4:7], s69 offen offset:2048 sc1
    buffer_load_dwordx4 v[72:75], v1, s[4:7], s69 offen offset:3072 sc1
    s_waitcnt vmcnt(0)
L_pc_23:
    v_max3_u32 v112, v60, v61, v62
    v_max3_u32 v113, v63, v64, v65
    v_max3_u32 v114, v66, v67, v68
    v_max3_u32 v115, v69, v70, v71
    v_max3_u32 v116, v72, v73, v74
    v_max3_u32 v117, v75, v88, v89
    v_max3_u32 v118, v90, v91, v92
    v_max3_u32 v119, v93, v94, v95
    v_max3_u32 v120, v112, v113, v114
    v_max3_u32 v121, v115, v116, v117
    v_max3_u32 v122, v120, v121, v118
    v_max_u32 v123, v122, v119
    v_cmp_eq_u32 vcc, -1, v123
    s_nop 0
    s_cbranch_vccz L_pk_21
    s_add_u32 s31, s31, 1
    s_cmp_gt_u32 s31, 1048576
    s_cbranch_scc1 L_abort
    s_cmp_ge_u32 s68, 0xd80000
    s_cbranch_scc1 L_pa_20
L_pi_22:
    s_sleep 4
    buffer_load_dwordx4 v[72:75], v1, s[4:7], s69 offen offset:3072 sc1
    s_add_u32 s31, s31, 1
    s_cmp_gt_u32 s31, 1048576
    s_cbranch_scc1 L_abort
    s_waitcnt vmcnt(0)
    v_max3_u32 v112, v72, v73, v74
    v_max_u32 v113, v112, v75
    v_cmp_eq_u32 vcc, -1, v113
    s_nop 0
    s_cbranch_vccnz L_pi_22
    s_branch L_pa_20
L_pk_21:
    v_mfma_f32_16x16x32_bf16 v[84:87], v[60:63], v[44:47], 0
    v_mfma_f32_16x16x32_bf16 v[84:87], v[64:67], v[48:51], v[84:87]
    v_mfma_f32_16x16x32_bf16 v[84:87], v[68:71], v[52:55], v[84:87]
    v_mfma_f32_16x16x32_bf16 v[84:87], v[72:75], v[56:59], v[84:87]
    s_nop 7
    v_cvt_pk_bf16_f32 v112, v84, v85
    v_cvt_pk_bf16_f32 v113, v86, v87
    v_lshlrev_b32 v84, 16, v112
    v_and_b32 v85, 0xffff0000, v112
    v_lshlrev_b32 v86, 16, v113
    v_and_b32 v87, 0xffff0000, v113
    v_mul_f32 v84, s98, v84
    v_mul_f32 v85, s98, v85
    v_mul_f32 v86, s98, v86
    v_mul_f32 v87, s98, v87
    v_cvt_pk_bf16_f32 v112, v84, v85
    v_cvt_pk_bf16_f32 v113, v86, v87
    v_lshlrev_b32 v84, 16, v112
    v_and_b32 v85, 0xffff0000, v112
    v_lshlrev_b32 v86, 16, v113
    v_and_b32 v87, 0xffff0000, v113
    v_mov_b32 v112, 0xff61b1e6
    v_cndmask_b32 v84, v112, v84, s[96:97]
    v_cndmask_b32 v85, v112, v85, s[96:97]
    v_cndmask_b32 v86, v112, v86, s[96:97]
    v_cndmask_b32 v87, v112, v87, s[96:97]
    v_max3_f32 v124, v124, v84, v85
    v_max3_f32 v124, v124, v86, v87
    v_mov_b32 v112, v124
    s_nop 1
    v_permlane16_swap_b32 v124, v112
    v_max_f32 v124, v124, v112
    v_mov_b32 v112, v124
    s_nop 1
    v_permlane32_swap_b32 v124, v112
    v_max_f32 v124, v124, v112
    v_sub_f32 v76, v76, v124
    v_sub_f32 v77, v77, v124
    v_sub_f32 v78, v78, v124
    v_sub_f32 v79, v79, v124
    v_sub_f32 v80, v80, v124
    v_sub_f32 v81, v81, v124
    v_sub_f32 v82, v82, v124
    v_sub_f32 v83, v83, v124
    v_sub_f32 v84, v84, v124
    v_sub_f32 v85, v85, v124
    v_sub_f32 v86, v86, v124
    v_sub_f32 v87, v87, v124
    v_mul_f32 v76, s99, v76
    v_mul_f32 v77, s99, v77
    v_mul_f32 v78, s99, v78
    v_mul_f32 v79, s99, v79
    v_mul_f32 v80, s99, v80
    v_mul_f32 v81, s99, v81
    v_mul_f32 v82, s99, v82
    v_mul_f32 v83, s99, v83
    v_mul_f32 v84, s99, v84
    v_mul_f32 v85, s99, v85
    v_mul_f32 v86, s99, v86
    v_mul_f32 v87, s99, v87
    v_exp_f32 v76, v76
    v_exp_f32 v77, v77
    v_exp_f32 v78, v78
    v_exp_f32 v79, v79
    v_exp_f32 v80, v80
    v_exp_f32 v81, v81
    v_exp_f32 v82, v82
    v_exp_f32 v83, v83
    v_exp_f32 v84, v84
    v_exp_f32 v85, v85
    v_exp_f32 v86, v86
    v_exp_f32 v87, v87
    v_pk_add_f32 v[112:113], v[76:77], v[82:83]
    v_pk_add_f32 v[114:115], v[78:79], v[84:85]
    v_pk_add_f32 v[116:117], v[80:81], v[86:87]
    v_pk_add_f32 v[112:113], v[112:113], v[114:115]
    v_pk_add_f32 v[112:113], v[112:113], v[116:117]
    v_add_f32 v124, v112, v113
    v_mov_b32 v112, v124
    s_nop 1
    v_permlane16_swap_b32 v124, v112
    v_add_f32 v124, v124, v112
    v_mov_b32 v112, v124
    s_nop 1
    v_permlane32_swap_b32 v124, v112
    v_add_f32 v124, v124, v112
    v_rcp_f32 v124, v124
    s_nop 0
    v_pk_mul_f32 v[76:77], v[76:77], v[124:125] op_sel_hi:[1,0]
    v_pk_mul_f32 v[78:79], v[78:79], v[124:125] op_sel_hi:[1,0]
    v_pk_mul_f32 v[80:81], v[80:81], v[124:125] op_sel_hi:[1,0]
    v_pk_mul_f32 v[82:83], v[82:83], v[124:125] op_sel_hi:[1,0]
    v_pk_mul_f32 v[84:85], v[84:85], v[124:125] op_sel_hi:[1,0]
    v_pk_mul_f32 v[86:87], v[86:87], v[124:125] op_sel_hi:[1,0]
    v_cvt_pk_bf16_f32 v112, v76, v77
    v_cvt_pk_bf16_f32 v113, v78, v79
    v_cvt_pk_bf16_f32 v114, v80, v81
    v_cvt_pk_bf16_f32 v115, v82, v83
    v_cvt_pk_bf16_f32 v116, v84, v85
    v_cvt_pk_bf16_f32 v117, v86, v87
    s_waitcnt lgkmcnt(3)
    v_mfma_f32_16x16x32_bf16 v[60:63], v[96:99], v[112:115], 0
    s_waitcnt lgkmcnt(2)
    v_mfma_f32_16x16x32_bf16 v[64:67], v[100:103], v[112:115], 0
    s_waitcnt lgkmcnt(1)
    v_mfma_f32_16x16x32_bf16 v[68:71], v[104:107], v[112:115], 0
    s_waitcnt lgkmcnt(0)
    v_mfma_f32_16x16x32_bf16 v[72:75], v[108:111], v[112:115], 0
    v_mfma_f32_16x16x16_bf16 v[60:63], v[88:89], v[116:117], v[60:63]
    v_mfma_f32_16x16x16_bf16 v[64:67], v[90:91], v[116:117], v[64:67]
    v_mfma_f32_16x16x16_bf16 v[68:71], v[92:93], v[116:117], v[68:71]
    v_mfma_f32_16x16x16_bf16 v[72:75], v[94:95], v[116:117], v[72:75]
    s_nop 4
    v_cvt_pk_bf16_f32 v76, v60, v61
    v_cvt_pk_bf16_f32 v77, v62, v63
    v_cvt_pk_bf16_f32 v78, v64, v65
    v_cvt_pk_bf16_f32 v79, v66, v67
    v_min_u32 v76, -2, v76
    v_min_u32 v77, -2, v77
    v_min_u32 v78, -2, v78
    v_min_u32 v79, -2, v79
    buffer_store_dwordx4 v[76:79], v10, s[4:7], s74 offen offset:0 sc1
    v_cvt_pk_bf16_f32 v80, v68, v69
    v_cvt_pk_bf16_f32 v81, v70, v71
    v_cvt_pk_bf16_f32 v82, v72, v73
    v_cvt_pk_bf16_f32 v83, v74, v75
    v_min_u32 v80, -2, v80
    v_min_u32 v81, -2, v81
    v_min_u32 v82, -2, v82
    v_min_u32 v83, -2, v83
    buffer_store_dwordx4 v[80:83], v10, s[4:7], s74 offen offset:1024 sc1
    s_add_u32 s68, s68, 0xc0000
    s_xor_b32 s67, s67, 24576
    s_cmp_le_u32 s27, s28
    s_cbranch_scc1 L_P_loop
    s_endpgm
L_others:
    s_mul_i32 s24, s70, 18
    s_add_u32 s24, s24, s22
    s_sub_u32 s24, s24, s71
    v_and_b32 v2, 63, v0
    v_lshrrev_b32 v3, 4, v2
    v_and_b32 v4, 15, v2
    v_bfe_u32 v5, v2, 2, 2
    v_and_b32 v6, 3, v2
    v_lshlrev_b32 v1, 4, v2
    v_mov_b32 v10, 0
    v_mov_b64 v[12:13], -1
    v_mov_b64 v[14:15], -1
    s_bitcmp1_b32 s24, 0
    s_cbranch_scc1 L_not_ln1
    s_lshl_b32 s26, s24, 1
    s_add_u32 s26, s26, s20
    s_mul_i32 s71, s26, 48
    s_lshl_b32 s72, s26, 3
    s_lshl_b32 s26, s26, 13
    s_add_u32 s70, s26, 0x200000
    s_add_u32 s25, s70, 4096
    v_lshlrev_b32 v7, 2, v2
    v_mov_b32 v16, 0
    s_add_u32 s71, s71, 0x110000
    s_add_u32 s72, s72, 0x120000
    s_cmp_ge_u32 s24, 12
    s_cbranch_scc1 L_nopf
    buffer_store_dwordx4 v[12:15], v1, s[4:7], s70 offen offset:0 sc1
    buffer_store_dwordx4 v[12:15], v1, s[4:7], s70 offen offset:1024 sc1
    buffer_store_dwordx4 v[12:15], v1, s[4:7], s70 offen offset:2048 sc1
    buffer_store_dwordx4 v[12:15], v1, s[4:7], s70 offen offset:3072 sc1
    buffer_store_dwordx4 v[12:15], v1, s[4:7], s25 offen offset:0 sc1
    buffer_store_dwordx4 v[12:15], v1, s[4:7], s25 offen offset:1024 sc1
    buffer_store_dwordx4 v[12:15], v1, s[4:7], s25 offen offset:2048 sc1
    buffer_store_dwordx4 v[12:15], v1, s[4:7], s25 offen offset:3072 sc1
L_nopf:
    s_mov_b64 exec, 0xfff
    buffer_store_dword v12, v7, s[4:7], s71 offen sc1
    s_mov_b64 exec, 3
    buffer_store_dword v16, v7, s[4:7], s72 offen sc1
    s_mov_b64 exec, -1
    s_mov_b32 s8, s32
    s_and_b32 s9, s33, 0xffff
    s_mov_b32 s10, 0x200000
    s_mov_b32 s11, 0x20000
    s_add_u32 s72, s26, 4096
    s_waitcnt vmcnt(0)
    s_barrier
    s_cmp_lg_u32 s20, 0
    s_cbranch_scc1 L_ai_24
    s_and_b32 s23, s22, 2
    s_lshl_b32 s23, s23, 3
    s_add_u32 s23, s23, 176
    v_mov_b32 v16, s23
    v_mov_b32 v17, 1
    s_mov_b64 exec, 1
    buffer_atomic_add v17, v16, s[76:79], 0 offen offset:0
    s_mov_b64 exec, -1
L_ai_24:
    buffer_load_dwordx4 v[64:67], v1, s[8:11], s26 offen offset:0
    buffer_load_dwordx4 v[68:71], v1, s[8:11], s26 offen offset:1024
    buffer_load_dwordx4 v[72:75], v1, s[8:11], s26 offen offset:2048
    buffer_load_dwordx4 v[76:79], v1, s[8:11], s26 offen offset:3072
    buffer_load_dwordx4 v[80:83], v1, s[8:11], s72 offen offset:0
    buffer_load_dwordx4 v[84:87], v1, s[8:11], s72 offen offset:1024
    buffer_load_dwordx4 v[88:91], v1, s[8:11], s72 offen offset:2048
    buffer_load_dwordx4 v[92:95], v1, s[8:11], s72 offen offset:3072
    s_waitcnt vmcnt(7)
    v_lshlrev_b32 v128, 16, v64
    v_and_b32 v129, 0xffff0000, v64
    v_lshlrev_b32 v130, 16, v65
    v_and_b32 v131, 0xffff0000, v65
    v_lshlrev_b32 v132, 16, v66
    v_and_b32 v133, 0xffff0000, v66
    v_lshlrev_b32 v134, 16, v67
    v_and_b32 v135, 0xffff0000, v67
    s_waitcnt vmcnt(6)
    v_lshlrev_b32 v136, 16, v68
    v_and_b32 v137, 0xffff0000, v68
    v_lshlrev_b32 v138, 16, v69
    v_and_b32 v139, 0xffff0000, v69
    v_lshlrev_b32 v140, 16, v70
    v_and_b32 v141, 0xffff0000, v70
    v_lshlrev_b32 v142, 16, v71
    v_and_b32 v143, 0xffff0000, v71
    s_waitcnt vmcnt(5)
    v_lshlrev_b32 v144, 16, v72
    v_and_b32 v145, 0xffff0000, v72
    v_lshlrev_b32 v146, 16, v73
    v_and_b32 v147, 0xffff0000, v73
    v_lshlrev_b32 v148, 16, v74
    v_and_b32 v149, 0xffff0000, v74
    v_lshlrev_b32 v150, 16, v75
    v_and_b32 v151, 0xffff0000, v75
    s_waitcnt vmcnt(4)
    v_lshlrev_b32 v152, 16, v76
    v_and_b32 v153, 0xffff0000, v76
    v_lshlrev_b32 v154, 16, v77
    v_and_b32 v155, 0xffff0000, v77
    v_lshlrev_b32 v156, 16, v78
    v_and_b32 v157, 0xffff0000, v78
    v_lshlrev_b32 v158, 16, v79
    v_and_b32 v159, 0xffff0000, v79
    s_waitcnt vmcnt(3)
    v_lshlrev_b32 v160, 16, v80
    v_and_b32 v161, 0xffff0000, v80
    v_lshlrev_b32 v162, 16, v81
    v_and_b32 v163, 0xffff0000, v81
    v_lshlrev_b32 v164, 16, v82
    v_and_b32 v165, 0xffff0000, v82
    v_lshlrev_b32 v166, 16, v83
    v_and_b32 v167, 0xffff0000, v83
    s_waitcnt vmcnt(2)
    v_lshlrev_b32 v168, 16, v84
    v_and_b32 v169, 0xffff0000, v84
    v_lshlrev_b32 v170, 16, v85
    v_and_b32 v171, 0xffff0000, v85
    v_lshlrev_b32 v172, 16, v86
    v_and_b32 v173, 0xffff0000, v86
    v_lshlrev_b32 v174, 16, v87
    v_and_b32 v175, 0xffff0000, v87
    s_waitcnt vmcnt(1)
    v_lshlrev_b32 v176, 16, v88
    v_and_b32 v177, 0xffff0000, v88
    v_lshlrev_b32 v178, 16, v89
    v_and_b32 v179, 0xffff0000, v89
    v_lshlrev_b32 v180, 16, v90
    v_and_b32 v181, 0xffff0000, v90
    v_lshlrev_b32 v182, 16, v91
    v_and_b32 v183, 0xffff0000, v91
    s_waitcnt vmcnt(0)
    v_lshlrev_b32 v184, 16, v92
    v_and_b32 v185, 0xffff0000, v92
    v_lshlrev_b32 v186, 16, v93
    v_and_b32 v187, 0xffff0000, v93
    v_lshlrev_b32 v188, 16, v94
    v_and_b32 v189, 0xffff0000, v94
    v_lshlrev_b32 v190, 16, v95
    v_and_b32 v191, 0xffff0000, v95
    v_pk_add_f32 v[192:193], v[128:129], v[132:133]
    v_pk_add_f32 v[194:195], v[130:131], v[134:135]
    v_pk_add_f32 v[192:193], v[192:193], v[194:195]
    v_add_f32 v96, v192, v193
    v_pk_add_f32 v[200:201], v[136:137], v[140:141]
    v_pk_add_f32 v[202:203], v[138:139], v[142:143]
    v_pk_add_f32 v[200:201], v[200:201], v[202:203]
    v_add_f32 v97, v200, v201
    v_pk_add_f32 v[208:209], v[144:145], v[148:149]
    v_pk_add_f32 v[210:211], v[146:147], v[150:151]
    v_pk_add_f32 v[208:209], v[208:209], v[210:211]
    v_add_f32 v98, v208, v209
    v_pk_add_f32 v[216:217], v[152:153], v[156:157]
    v_pk_add_f32 v[218:219], v[154:155], v[158:159]
    v_pk_add_f32 v[216:217], v[216:217], v[218:219]
    v_add_f32 v99, v216, v217
    v_pk_add_f32 v[224:225], v[160:161], v[164:165]
    v_pk_add_f32 v[226:227], v[162:163], v[166:167]
    v_pk_add_f32 v[224:225], v[224:225], v[226:227]
    v_add_f32 v100, v224, v225
    v_pk_add_f32 v[232:233], v[168:169], v[172:173]
    v_pk_add_f32 v[234:235], v[170:171], v[174:175]
    v_pk_add_f32 v[232:233], v[232:233], v[234:235]
    v_add_f32 v101, v232, v233
    v_pk_add_f32 v[240:241], v[176:177], v[180:181]
    v_pk_add_f32 v[242:243], v[178:179], v[182:183]
    v_pk_add_f32 v[240:241], v[240:241], v[242:243]
    v_add_f32 v102, v240, v241
    v_pk_add_f32 v[248:249], v[184:185], v[188:189]
    v_pk_add_f32 v[250:251], v[186:187], v[190:191]
    v_pk_add_f32 v[248:249], v[248:249], v[250:251]
    v_add_f32 v103, v248, v249
    v_add_f32_dpp v96, v96, v96 quad_perm:[1,0,3,2] row_mask:0xf bank_mask:0xf
    v_add_f32_dpp v97, v97, v97 quad_perm:[1,0,3,2] row_mask:0xf bank_mask:0xf
    v_add_f32_dpp v98, v98, v98 quad_perm:[1,0,3,2] row_mask:0xf bank_mask:0xf
    v_add_f32_dpp v99, v99, v99 quad_perm:[1,0,3,2] row_mask:0xf bank_mask:0xf
    v_add_f32_dpp v100, v100, v100 quad_perm:[1,0,3,2] row_mask:0xf bank_mask:0xf
    v_add_f32_dpp v101, v101, v101 quad_perm:[1,0,3,2] row_mask:0xf bank_mask:0xf
    v_add_f32_dpp v102, v102, v102 quad_perm:[1,0,3,2] row_mask:0xf bank_mask:0xf
    v_add_f32_dpp v103, v103, v103 quad_perm:[1,0,3,2] row_mask:0xf bank_mask:0xf
    v_add_f32_dpp v96, v96, v96 quad_perm:[2,3,0,1] row_mask:0xf bank_mask:0xf
    v_add_f32_dpp v97, v97, v97 quad_perm:[2,3,0,1] row_mask:0xf bank_mask:0xf
    v_add_f32_dpp v98, v98, v98 quad_perm:[2,3,0,1] row_mask:0xf bank_mask:0xf
    v_add_f32_dpp v99, v99, v99 quad_perm:[2,3,0,1] row_mask:0xf bank_mask:0xf
    v_add_f32_dpp v100, v100, v100 quad_perm:[2,3,0,1] row_mask:0xf bank_mask:0xf
    v_add_f32_dpp v101, v101, v101 quad_perm:[2,3,0,1] row_mask:0xf bank_mask:0xf
    v_add_f32_dpp v102, v102, v102 quad_perm:[2,3,0,1] row_mask:0xf bank_mask:0xf
    v_add_f32_dpp v103, v103, v103 quad_perm:[2,3,0,1] row_mask:0xf bank_mask:0xf
    v_add_f32_dpp v96, v96, v96 row_half_mirror row_mask:0xf bank_mask:0xf
    v_add_f32_dpp v97, v97, v97 row_half_mirror row_mask:0xf bank_mask:0xf
    v_add_f32_dpp v98, v98, v98 row_half_mirror row_mask:0xf bank_mask:0xf
    v_add_f32_dpp v99, v99, v99 row_half_mirror row_mask:0xf bank_mask:0xf
    v_add_f32_dpp v100, v100, v100 row_half_mirror row_mask:0xf bank_mask:0xf
    v_add_f32_dpp v101, v101, v101 row_half_mirror row_mask:0xf bank_mask:0xf
    v_add_f32_dpp v102, v102, v102 row_half_mirror row_mask:0xf bank_mask:0xf
    v_add_f32_dpp v103, v103, v103 row_half_mirror row_mask:0xf bank_mask:0xf
    v_add_f32_dpp v96, v96, v96 row_mirror row_mask:0xf bank_mask:0xf
    v_add_f32_dpp v97, v97, v97 row_mirror row_mask:0xf bank_mask:0xf
    v_add_f32_dpp v98, v98, v98 row_mirror row_mask:0xf bank_mask:0xf
    v_add_f32_dpp v99, v99, v99 row_mirror row_mask:0xf bank_mask:0xf
    v_add_f32_dpp v100, v100, v100 row_mirror row_mask:0xf bank_mask:0xf
    v_add_f32_dpp v101, v101, v101 row_mirror row_mask:0xf bank_mask:0xf
    v_add_f32_dpp v102, v102, v102 row_mirror row_mask:0xf bank_mask:0xf
    v_add_f32_dpp v103, v103, v103 row_mirror row_mask:0xf bank_mask:0xf
    v_mov_b32 v192, v96
    v_mov_b32 v200, v97
    v_mov_b32 v208, v98
    v_mov_b32 v216, v99
    v_mov_b32 v224, v100
    v_mov_b32 v232, v101
    v_mov_b32 v240, v102
    v_mov_b32 v248, v103
    v_permlane16_swap_b32 v96, v192
    v_permlane16_swap_b32 v97, v200
    v_permlane16_swap_b32 v98, v208
    v_permlane16_swap_b32 v99, v216
    v_permlane16_swap_b32 v100, v224
    v_permlane16_swap_b32 v101, v232
    v_permlane16_swap_b32 v102, v240
    v_permlane16_swap_b32 v103, v248
    v_add_f32 v96, v96, v192
    v_add_f32 v97, v97, v200
    v_add_f32 v98, v98, v208
    v_add_f32 v99, v99, v216
    v_add_f32 v100, v100, v224
    v_add_f32 v101, v101, v232
    v_add_f32 v102, v102, v240
    v_add_f32 v103, v103, v248
    v_mov_b32 v192, v96
    v_mov_b32 v200, v97
    v_mov_b32 v208, v98
    v_mov_b32 v216, v99
    v_mov_b32 v224, v100
    v_mov_b32 v232, v101
    v_mov_b32 v240, v102
    v_mov_b32 v248, v103
    v_permlane32_swap_b32 v96, v192
    v_permlane32_swap_b32 v97, v200
    v_permlane32_swap_b32 v98, v208
    v_permlane32_swap_b32 v99, v216
    v_permlane32_swap_b32 v100, v224
    v_permlane32_swap_b32 v101, v232
    v_permlane32_swap_b32 v102, v240
    v_permlane32_swap_b32 v103, v248
    v_add_f32 v96, v96, v192
    v_add_f32 v97, v97, v200
    v_add_f32 v98, v98, v208
    v_add_f32 v99, v99, v216
    v_add_f32 v100, v100, v224
    v_add_f32 v101, v101, v232
    v_add_f32 v102, v102, v240
    v_add_f32 v103, v103, v248
    v_mul_f32 v96, 0x3b000000, v96
    v_mul_f32 v97, 0x3b000000, v97
    v_mul_f32 v98, 0x3b000000, v98
    v_mul_f32 v99, 0x3b000000, v99
    v_mul_f32 v100, 0x3b000000, v100
    v_mul_f32 v101, 0x3b000000, v101
    v_mul_f32 v102, 0x3b000000, v102
    v_mul_f32 v103, 0x3b000000, v103
    v_sub_f32 v192, v128, v96
    v_sub_f32 v193, v129, v96
    v_sub_f32 v194, v130, v96
    v_sub_f32 v195, v131, v96
    v_sub_f32 v196, v132, v96
    v_sub_f32 v197, v133, v96
    v_sub_f32 v198, v134, v96
    v_sub_f32 v199, v135, v96
    v_mul_f32 v104, v192, v192
    v_mul_f32 v192, v193, v193
    v_fmac_f32 v104, v194, v194
    v_fmac_f32 v192, v195, v195
    v_fmac_f32 v104, v196, v196
    v_fmac_f32 v192, v197, v197
    v_fmac_f32 v104, v198, v198
    v_fmac_f32 v192, v199, v199
    v_add_f32 v104, v104, v192
    v_sub_f32 v200, v136, v97
    v_sub_f32 v201, v137, v97
    v_sub_f32 v202, v138, v97
    v_sub_f32 v203, v139, v97
    v_sub_f32 v204, v140, v97
    v_sub_f32 v205, v141, v97
    v_sub_f32 v206, v142, v97
    v_sub_f32 v207, v143, v97
    v_mul_f32 v105, v200, v200
    v_mul_f32 v200, v201, v201
    v_fmac_f32 v105, v202, v202
    v_fmac_f32 v200, v203, v203
    v_fmac_f32 v105, v204, v204
    v_fmac_f32 v200, v205, v205
    v_fmac_f32 v105, v206, v206
    v_fmac_f32 v200, v207, v207
    v_add_f32 v105, v105, v200
    v_sub_f32 v208, v144, v98
    v_sub_f32 v209, v145, v98
    v_sub_f32 v210, v146, v98
    v_sub_f32 v211, v147, v98
    v_sub_f32 v212, v148, v98
    v_sub_f32 v213, v149, v98
    v_sub_f32 v214, v150, v98
    v_sub_f32 v215, v151, v98
    v_mul_f32 v106, v208, v208
    v_mul_f32 v208, v209, v209
    v_fmac_f32 v106, v210, v210
    v_fmac_f32 v208, v211, v211
    v_fmac_f32 v106, v212, v212
    v_fmac_f32 v208, v213, v213
    v_fmac_f32 v106, v214, v214
    v_fmac_f32 v208, v215, v215
    v_add_f32 v106, v106, v208
    v_sub_f32 v216, v152, v99
    v_sub_f32 v217, v153, v99
    v_sub_f32 v218, v154, v99
    v_sub_f32 v219, v155, v99
    v_sub_f32 v220, v156, v99
    v_sub_f32 v221, v157, v99
    v_sub_f32 v222, v158, v99
    v_sub_f32 v223, v159, v99
    v_mul_f32 v107, v216, v216
    v_mul_f32 v216, v217, v217
    v_fmac_f32 v107, v218, v218
    v_fmac_f32 v216, v219, v219
    v_fmac_f32 v107, v220, v220
    v_fmac_f32 v216, v221, v221
    v_fmac_f32 v107, v222, v222
    v_fmac_f32 v216, v223, v223
    v_add_f32 v107, v107, v216
    v_sub_f32 v224, v160, v100
    v_sub_f32 v225, v161, v100
    v_sub_f32 v226, v162, v100
    v_sub_f32 v227, v163, v100
    v_sub_f32 v228, v164, v100
    v_sub_f32 v229, v165, v100
    v_sub_f32 v230, v166, v100
    v_sub_f32 v231, v167, v100
    v_mul_f32 v108, v224, v224
    v_mul_f32 v224, v225, v225
    v_fmac_f32 v108, v226, v226
    v_fmac_f32 v224, v227, v227
    v_fmac_f32 v108, v228, v228
    v_fmac_f32 v224, v229, v229
    v_fmac_f32 v108, v230, v230
    v_fmac_f32 v224, v231, v231
    v_add_f32 v108, v108, v224
    v_sub_f32 v232, v168, v101
    v_sub_f32 v233, v169, v101
    v_sub_f32 v234, v170, v101
    v_sub_f32 v235, v171, v101
    v_sub_f32 v236, v172, v101
    v_sub_f32 v237, v173, v101
    v_sub_f32 v238, v174, v101
    v_sub_f32 v239, v175, v101
    v_mul_f32 v109, v232, v232
    v_mul_f32 v232, v233, v233
    v_fmac_f32 v109, v234, v234
    v_fmac_f32 v232, v235, v235
    v_fmac_f32 v109, v236, v236
    v_fmac_f32 v232, v237, v237
    v_fmac_f32 v109, v238, v238
    v_fmac_f32 v232, v239, v239
    v_add_f32 v109, v109, v232
    v_sub_f32 v240, v176, v102
    v_sub_f32 v241, v177, v102
    v_sub_f32 v242, v178, v102
    v_sub_f32 v243, v179, v102
    v_sub_f32 v244, v180, v102
    v_sub_f32 v245, v181, v102
    v_sub_f32 v246, v182, v102
    v_sub_f32 v247, v183, v102
    v_mul_f32 v110, v240, v240
    v_mul_f32 v240, v241, v241
    v_fmac_f32 v110, v242, v242
    v_fmac_f32 v240, v243, v243
    v_fmac_f32 v110, v244, v244
    v_fmac_f32 v240, v245, v245
    v_fmac_f32 v110, v246, v246
    v_fmac_f32 v240, v247, v247
    v_add_f32 v110, v110, v240
    v_sub_f32 v248, v184, v103
    v_sub_f32 v249, v185, v103
    v_sub_f32 v250, v186, v103
    v_sub_f32 v251, v187, v103
    v_sub_f32 v252, v188, v103
    v_sub_f32 v253, v189, v103
    v_sub_f32 v254, v190, v103
    v_sub_f32 v255, v191, v103
    v_mul_f32 v111, v248, v248
    v_mul_f32 v248, v249, v249
    v_fmac_f32 v111, v250, v250
    v_fmac_f32 v248, v251, v251
    v_fmac_f32 v111, v252, v252
    v_fmac_f32 v248, v253, v253
    v_fmac_f32 v111, v254, v254
    v_fmac_f32 v248, v255, v255
    v_add_f32 v111, v111, v248
    v_add_f32_dpp v104, v104, v104 quad_perm:[1,0,3,2] row_mask:0xf bank_mask:0xf
    v_add_f32_dpp v105, v105, v105 quad_perm:[1,0,3,2] row_mask:0xf bank_mask:0xf
    v_add_f32_dpp v106, v106, v106 quad_perm:[1,0,3,2] row_mask:0xf bank_mask:0xf
    v_add_f32_dpp v107, v107, v107 quad_perm:[1,0,3,2] row_mask:0xf bank_mask:0xf
    v_add_f32_dpp v108, v108, v108 quad_perm:[1,0,3,2] row_mask:0xf bank_mask:0xf
    v_add_f32_dpp v109, v109, v109 quad_perm:[1,0,3,2] row_mask:0xf bank_mask:0xf
    v_add_f32_dpp v110, v110, v110 quad_perm:[1,0,3,2] row_mask:0xf bank_mask:0xf
    v_add_f32_dpp v111, v111, v111 quad_perm:[1,0,3,2] row_mask:0xf bank_mask:0xf
    v_add_f32_dpp v104, v104, v104 quad_perm:[2,3,0,1] row_mask:0xf bank_mask:0xf
    v_add_f32_dpp v105, v105, v105 quad_perm:[2,3,0,1] row_mask:0xf bank_mask:0xf
    v_add_f32_dpp v106, v106, v106 quad_perm:[2,3,0,1] row_mask:0xf bank_mask:0xf
    v_add_f32_dpp v107, v107, v107 quad_perm:[2,3,0,1] row_mask:0xf bank_mask:0xf
    v_add_f32_dpp v108, v108, v108 quad_perm:[2,3,0,1] row_mask:0xf bank_mask:0xf
    v_add_f32_dpp v109, v109, v109 quad_perm:[2,3,0,1] row_mask:0xf bank_mask:0xf
    v_add_f32_dpp v110, v110, v110 quad_perm:[2,3,0,1] row_mask:0xf bank_mask:0xf
    v_add_f32_dpp v111, v111, v111 quad_perm:[2,3,0,1] row_mask:0xf bank_mask:0xf
    v_add_f32_dpp v104, v104, v104 row_half_mirror row_mask:0xf bank_mask:0xf
    v_add_f32_dpp v105, v105, v105 row_half_mirror row_mask:0xf bank_mask:0xf
    v_add_f32_dpp v106, v106, v106 row_half_mirror row_mask:0xf bank_mask:0xf
    v_add_f32_dpp v107, v107, v107 row_half_mirror row_mask:0xf bank_mask:0xf
    v_add_f32_dpp v108, v108, v108 row_half_mirror row_mask:0xf bank_mask:0xf
    v_add_f32_dpp v109, v109, v109 row_half_mirror row_mask:0xf bank_mask:0xf
    v_add_f32_dpp v110, v110, v110 row_half_mirror row_mask:0xf bank_mask:0xf
    v_add_f32_dpp v111, v111, v111 row_half_mirror row_mask:0xf bank_mask:0xf
    v_add_f32_dpp v104, v104, v104 row_mirror row_mask:0xf bank_mask:0xf
    v_add_f32_dpp v105, v105, v105 row_mirror row_mask:0xf bank_mask:0xf
    v_add_f32_dpp v106, v106, v106 row_mirror row_mask:0xf bank_mask:0xf
    v_add_f32_dpp v107, v107, v107 row_mirror row_mask:0xf bank_mask:0xf
    v_add_f32_dpp v108, v108, v108 row_mirror row_mask:0xf bank_mask:0xf
    v_add_f32_dpp v109, v109, v109 row_mirror row_mask:0xf bank_mask:0xf
    v_add_f32_dpp v110, v110, v110 row_mirror row_mask:0xf bank_mask:0xf
    v_add_f32_dpp v111, v111, v111 row_mirror row_mask:0xf bank_mask:0xf
    v_mov_b32 v192, v104
    v_mov_b32 v200, v105
    v_mov_b32 v208, v106
    v_mov_b32 v216, v107
    v_mov_b32 v224, v108
    v_mov_b32 v232, v109
    v_mov_b32 v240, v110
    v_mov_b32 v248, v111
    v_permlane16_swap_b32 v104, v192
    v_permlane16_swap_b32 v105, v200
    v_permlane16_swap_b32 v106, v208
    v_permlane16_swap_b32 v107, v216
    v_permlane16_swap_b32 v108, v224
    v_permlane16_swap_b32 v109, v232
    v_permlane16_swap_b32 v110, v240
    v_permlane16_swap_b32 v111, v248
    v_add_f32 v104, v104, v192
    v_add_f32 v105, v105, v200
    v_add_f32 v106, v106, v208
    v_add_f32 v107, v107, v216
    v_add_f32 v108, v108, v224
    v_add_f32 v109, v109, v232
    v_add_f32 v110, v110, v240
    v_add_f32 v111, v111, v248
    v_mov_b32 v192, v104
    v_mov_b32 v200, v105
    v_mov_b32 v208, v106
    v_mov_b32 v216, v107
    v_mov_b32 v224, v108
    v_mov_b32 v232, v109
    v_mov_b32 v240, v110
    v_mov_b32 v248, v111
    v_permlane32_swap_b32 v104, v192
    v_permlane32_swap_b32 v105, v200
    v_permlane32_swap_b32 v106, v208
    v_permlane32_swap_b32 v107, v216
    v_permlane32_swap_b32 v108, v224
    v_permlane32_swap_b32 v109, v232
    v_permlane32_swap_b32 v110, v240
    v_permlane32_swap_b32 v111, v248
    v_add_f32 v104, v104, v192
    v_add_f32 v105, v105, v200
    v_add_f32 v106, v106, v208
    v_add_f32 v107, v107, v216
    v_add_f32 v108, v108, v224
    v_add_f32 v109, v109, v232
    v_add_f32 v110, v110, v240
    v_add_f32 v111, v111, v248
    v_mul_f32 v104, 0x3b000000, v104
    v_cvt_pk_bf16_f32 v192, v96, v104
    v_lshlrev_b32 v96, 16, v192
    v_and_b32 v104, 0xffff0000, v192
    v_add_f32 v104, 0x3727c5ac, v104
    v_cvt_pk_bf16_f32 v104, v104, v104
    v_and_b32 v104, 0xffff0000, v104
    v_sqrt_f32 v104, v104
    s_nop 0
    v_cvt_pk_bf16_f32 v104, v104, v104
    v_and_b32 v104, 0xffff0000, v104
    v_rcp_f32 v104, v104
    v_mul_f32 v105, 0x3b000000, v105
    v_cvt_pk_bf16_f32 v200, v97, v105
    v_lshlrev_b32 v97, 16, v200
    v_and_b32 v105, 0xffff0000, v200
    v_add_f32 v105, 0x3727c5ac, v105
    v_cvt_pk_bf16_f32 v105, v105, v105
    v_and_b32 v105, 0xffff0000, v105
    v_sqrt_f32 v105, v105
    s_nop 0
    v_cvt_pk_bf16_f32 v105, v105, v105
    v_and_b32 v105, 0xffff0000, v105
    v_rcp_f32 v105, v105
    v_mul_f32 v106, 0x3b000000, v106
    v_cvt_pk_bf16_f32 v208, v98, v106
    v_lshlrev_b32 v98, 16, v208
    v_and_b32 v106, 0xffff0000, v208
    v_add_f32 v106, 0x3727c5ac, v106
    v_cvt_pk_bf16_f32 v106, v106, v106
    v_and_b32 v106, 0xffff0000, v106
    v_sqrt_f32 v106, v106
    s_nop 0
    v_cvt_pk_bf16_f32 v106, v106, v106
    v_and_b32 v106, 0xffff0000, v106
    v_rcp_f32 v106, v106
    v_mul_f32 v107, 0x3b000000, v107
    v_cvt_pk_bf16_f32 v216, v99, v107
    v_lshlrev_b32 v99, 16, v216
    v_and_b32 v107, 0xffff0000, v216
    v_add_f32 v107, 0x3727c5ac, v107
    v_cvt_pk_bf16_f32 v107, v107, v107
    v_and_b32 v107, 0xffff0000, v107
    v_sqrt_f32 v107, v107
    s_nop 0
    v_cvt_pk_bf16_f32 v107, v107, v107
    v_and_b32 v107, 0xffff0000, v107
    v_rcp_f32 v107, v107
    v_mul_f32 v108, 0x3b000000, v108
    v_cvt_pk_bf16_f32 v224, v100, v108
    v_lshlrev_b32 v100, 16, v224
    v_and_b32 v108, 0xffff0000, v224
    v_add_f32 v108, 0x3727c5ac, v108
    v_cvt_pk_bf16_f32 v108, v108, v108
    v_and_b32 v108, 0xffff0000, v108
    v_sqrt_f32 v108, v108
    s_nop 0
    v_cvt_pk_bf16_f32 v108, v108, v108
    v_and_b32 v108, 0xffff0000, v108
    v_rcp_f32 v108, v108
    v_mul_f32 v109, 0x3b000000, v109
    v_cvt_pk_bf16_f32 v232, v101, v109
    v_lshlrev_b32 v101, 16, v232
    v_and_b32 v109, 0xffff0000, v232
    v_add_f32 v109, 0x3727c5ac, v109
    v_cvt_pk_bf16_f32 v109, v109, v109
    v_and_b32 v109, 0xffff0000, v109
    v_sqrt_f32 v109, v109
    s_nop 0
    v_cvt_pk_bf16_f32 v109, v109, v109
    v_and_b32 v109, 0xffff0000, v109
    v_rcp_f32 v109, v109
    v_mul_f32 v110, 0x3b000000, v110
    v_cvt_pk_bf16_f32 v240, v102, v110
    v_lshlrev_b32 v102, 16, v240
    v_and_b32 v110, 0xffff0000, v240
    v_add_f32 v110, 0x3727c5ac, v110
    v_cvt_pk_bf16_f32 v110, v110, v110
    v_and_b32 v110, 0xffff0000, v110
    v_sqrt_f32 v110, v110
    s_nop 0
    v_cvt_pk_bf16_f32 v110, v110, v110
    v_and_b32 v110, 0xffff0000, v110
    v_rcp_f32 v110, v110
    v_mul_f32 v111, 0x3b000000, v111
    v_cvt_pk_bf16_f32 v248, v103, v111
    v_lshlrev_b32 v103, 16, v248
    v_and_b32 v111, 0xffff0000, v248
    v_add_f32 v111, 0x3727c5ac, v111
    v_cvt_pk_bf16_f32 v111, v111, v111
    v_and_b32 v111, 0xffff0000, v111
    v_sqrt_f32 v111, v111
    s_nop 0
    v_cvt_pk_bf16_f32 v111, v111, v111
    v_and_b32 v111, 0xffff0000, v111
    v_rcp_f32 v111, v111
    s_cmp_lg_u32 s20, 0
    s_cbranch_scc1 L_wd_26
    s_branch L_wf_27
L_wc_25:
    s_sleep 8
L_wf_27:
    buffer_load_dword v18, off, s[76:79], 0 offset:192 sc1
    buffer_load_dword v19, off, s[76:79], 0 offset:176 sc1
    s_add_u32 s31, s31, 1
    s_cmp_gt_u32 s31, 1048576
    s_cbranch_scc1 L_abort
    s_waitcnt vmcnt(0)
    v_add_u32 v18, v18, v19
    s_nop 0
    v_readfirstlane_b32 s70, v18
    s_cmp_lg_u32 s70, 64
    s_nop 2
    s_cbranch_scc1 L_wc_25
L_wd_26:
    s_barrier
    v_lshlrev_b32 v7, 5, v2
    s_mov_b32 s70, 0x110000
L_pa_28:
    buffer_load_dwordx4 v[20:23], v7, s[4:7], s70 offen offset:0 sc1
    buffer_load_dwordx4 v[24:27], v7, s[4:7], s70 offen offset:16 sc1
    buffer_load_dwordx4 v[28:31], v7, s[4:7], s70 offen offset:2048 sc1
    buffer_load_dwordx4 v[32:35], v7, s[4:7], s70 offen offset:2064 sc1
    s_waitcnt vmcnt(0)
L_pc_31:
    v_max3_u32 v36, v20, v21, v22
    v_max3_u32 v37, v23, v24, v25
    v_max3_u32 v38, v26, v27, v28
    v_max3_u32 v39, v29, v30, v31
    v_max3_u32 v40, v32, v33, v34
    v_max3_u32 v41, v36, v37, v38
    v_max3_u32 v42, v39, v40, v35
    v_max_u32 v43, v41, v42
    v_cmp_eq_u32 vcc, -1, v43
    s_nop 0
    s_cbranch_vccz L_pk_29
    s_add_u32 s31, s31, 1
    s_cmp_gt_u32 s31, 1048576
    s_cbranch_scc1 L_abort
L_pi_30:
    s_sleep 2
    buffer_load_dwordx4 v[32:35], v7, s[4:7], s70 offen offset:2064 sc1
    s_add_u32 s31, s31, 1
    s_cmp_gt_u32 s31, 1048576
    s_cbranch_scc1 L_abort
    s_waitcnt vmcnt(0)
    v_max3_u32 v36, v32, v33, v34
    v_max_u32 v37, v36, v35
    v_cmp_eq_u32 vcc, -1, v37
    s_nop 0
    s_cbranch_vccnz L_pi_30
    s_branch L_pa_28
L_pk_29:
    v_add_f32 v28, 1.0, v28
    v_add_f32 v29, 1.0, v29
    v_add_f32 v30, 1.0, v30
    v_add_f32 v31, 1.0, v31
    v_add_f32 v32, 1.0, v32
    v_add_f32 v33, 1.0, v33
    v_add_f32 v34, 1.0, v34
    v_add_f32 v35, 1.0, v35
    v_cvt_pk_bf16_f32 v36, v28, v29
    v_cvt_pk_bf16_f32 v37, v30, v31
    v_cvt_pk_bf16_f32 v38, v32, v33
    v_cvt_pk_bf16_f32 v39, v34, v35
    v_lshlrev_b32 v28, 16, v36
    v_and_b32 v29, 0xffff0000, v36
    v_lshlrev_b32 v30, 16, v37
    v_and_b32 v31, 0xffff0000, v37
    v_lshlrev_b32 v32, 16, v38
    v_and_b32 v33, 0xffff0000, v38
    v_lshlrev_b32 v34, 16, v39
    v_and_b32 v35, 0xffff0000, v39
    s_add_u32 s70, s26, 0x200000
    v_sub_f32 v128, v128, v96
    v_sub_f32 v129, v129, v96
    v_sub_f32 v130, v130, v96
    v_sub_f32 v131, v131, v96
    v_sub_f32 v132, v132, v96
    v_sub_f32 v133, v133, v96
    v_sub_f32 v134, v134, v96
    v_sub_f32 v135, v135, v96
    v_cvt_pk_bf16_f32 v36, v128, v129
    v_cvt_pk_bf16_f32 v37, v130, v131
    v_cvt_pk_bf16_f32 v38, v132, v133
    v_cvt_pk_bf16_f32 v39, v134, v135
    v_lshlrev_b32 v128, 16, v36
    v_and_b32 v129, 0xffff0000, v36
    v_lshlrev_b32 v130, 16, v37
    v_and_b32 v131, 0xffff0000, v37
    v_lshlrev_b32 v132, 16, v38
    v_and_b32 v133, 0xffff0000, v38
    v_lshlrev_b32 v134, 16, v39
    v_and_b32 v135, 0xffff0000, v39
    v_mul_f32 v128, v128, v104
    v_mul_f32 v129, v129, v104
    v_mul_f32 v130, v130, v104
    v_mul_f32 v131, v131, v104
    v_mul_f32 v132, v132, v104
    v_mul_f32 v133, v133, v104
    v_mul_f32 v134, v134, v104
    v_mul_f32 v135, v135, v104
    v_cvt_pk_bf16_f32 v36, v128, v129
    v_cvt_pk_bf16_f32 v37, v130, v131
    v_cvt_pk_bf16_f32 v38, v132, v133
    v_cvt_pk_bf16_f32 v39, v134, v135
    v_lshlrev_b32 v128, 16, v36
    v_and_b32 v129, 0xffff0000, v36
    v_lshlrev_b32 v130, 16, v37
    v_and_b32 v131, 0xffff0000, v37
    v_lshlrev_b32 v132, 16, v38
    v_and_b32 v133, 0xffff0000, v38
    v_lshlrev_b32 v134, 16, v39
    v_and_b32 v135, 0xffff0000, v39
    v_pk_mul_f32 v[128:129], v[128:129], v[28:29]
    v_pk_mul_f32 v[130:131], v[130:131], v[30:31]
    v_pk_mul_f32 v[132:133], v[132:133], v[32:33]
    v_pk_mul_f32 v[134:135], v[134:135], v[34:35]
    v_cvt_pk_bf16_f32 v36, v128, v129
    v_cvt_pk_bf16_f32 v37, v130, v131
    v_cvt_pk_bf16_f32 v38, v132, v133
    v_cvt_pk_bf16_f32 v39, v134, v135
    v_lshlrev_b32 v128, 16, v36
    v_and_b32 v129, 0xffff0000, v36
    v_lshlrev_b32 v130, 16, v37
    v_and_b32 v131, 0xffff0000, v37
    v_lshlrev_b32 v132, 16, v38
    v_and_b32 v133, 0xffff0000, v38
    v_lshlrev_b32 v134, 16, v39
    v_and_b32 v135, 0xffff0000, v39
    v_pk_add_f32 v[128:129], v[128:129], v[20:21]
    v_pk_add_f32 v[130:131], v[130:131], v[22:23]
    v_pk_add_f32 v[132:133], v[132:133], v[24:25]
    v_pk_add_f32 v[134:135], v[134:135], v[26:27]
    v_cvt_pk_bf16_f32 v40, v128, v129
    v_cvt_pk_bf16_f32 v41, v130, v131
    v_cvt_pk_bf16_f32 v42, v132, v133
    v_cvt_pk_bf16_f32 v43, v134, v135
    v_min_u32 v40, -2, v40
    v_min_u32 v41, -2, v41
    v_min_u32 v42, -2, v42
    v_min_u32 v43, -2, v43
    buffer_store_dwordx4 v[40:43], v1, s[4:7], s70 offen offset:0 sc1
    v_sub_f32 v136, v136, v97
    v_sub_f32 v137, v137, v97
    v_sub_f32 v138, v138, v97
    v_sub_f32 v139, v139, v97
    v_sub_f32 v140, v140, v97
    v_sub_f32 v141, v141, v97
    v_sub_f32 v142, v142, v97
    v_sub_f32 v143, v143, v97
    v_cvt_pk_bf16_f32 v36, v136, v137
    v_cvt_pk_bf16_f32 v37, v138, v139
    v_cvt_pk_bf16_f32 v38, v140, v141
    v_cvt_pk_bf16_f32 v39, v142, v143
    v_lshlrev_b32 v136, 16, v36
    v_and_b32 v137, 0xffff0000, v36
    v_lshlrev_b32 v138, 16, v37
    v_and_b32 v139, 0xffff0000, v37
    v_lshlrev_b32 v140, 16, v38
    v_and_b32 v141, 0xffff0000, v38
    v_lshlrev_b32 v142, 16, v39
    v_and_b32 v143, 0xffff0000, v39
    v_mul_f32 v136, v136, v105
    v_mul_f32 v137, v137, v105
    v_mul_f32 v138, v138, v105
    v_mul_f32 v139, v139, v105
    v_mul_f32 v140, v140, v105
    v_mul_f32 v141, v141, v105
    v_mul_f32 v142, v142, v105
    v_mul_f32 v143, v143, v105
    v_cvt_pk_bf16_f32 v36, v136, v137
    v_cvt_pk_bf16_f32 v37, v138, v139
    v_cvt_pk_bf16_f32 v38, v140, v141
    v_cvt_pk_bf16_f32 v39, v142, v143
    v_lshlrev_b32 v136, 16, v36
    v_and_b32 v137, 0xffff0000, v36
    v_lshlrev_b32 v138, 16, v37
    v_and_b32 v139, 0xffff0000, v37
    v_lshlrev_b32 v140, 16, v38
    v_and_b32 v141, 0xffff0000, v38
    v_lshlrev_b32 v142, 16, v39
    v_and_b32 v143, 0xffff0000, v39
    v_pk_mul_f32 v[136:137], v[136:137], v[28:29]
    v_pk_mul_f32 v[138:139], v[138:139], v[30:31]
    v_pk_mul_f32 v[140:141], v[140:141], v[32:33]
    v_pk_mul_f32 v[142:143], v[142:143], v[34:35]
    v_cvt_pk_bf16_f32 v36, v136, v137
    v_cvt_pk_bf16_f32 v37, v138, v139
    v_cvt_pk_bf16_f32 v38, v140, v141
    v_cvt_pk_bf16_f32 v39, v142, v143
    v_lshlrev_b32 v136, 16, v36
    v_and_b32 v137, 0xffff0000, v36
    v_lshlrev_b32 v138, 16, v37
    v_and_b32 v139, 0xffff0000, v37
    v_lshlrev_b32 v140, 16, v38
    v_and_b32 v141, 0xffff0000, v38
    v_lshlrev_b32 v142, 16, v39
    v_and_b32 v143, 0xffff0000, v39
    v_pk_add_f32 v[136:137], v[136:137], v[20:21]
    v_pk_add_f32 v[138:139], v[138:139], v[22:23]
    v_pk_add_f32 v[140:141], v[140:141], v[24:25]
    v_pk_add_f32 v[142:143], v[142:143], v[26:27]
    v_cvt_pk_bf16_f32 v44, v136, v137
    v_cvt_pk_bf16_f32 v45, v138, v139
    v_cvt_pk_bf16_f32 v46, v140, v141
    v_cvt_pk_bf16_f32 v47, v142, v143
    v_min_u32 v44, -2, v44
    v_min_u32 v45, -2, v45
    v_min_u32 v46, -2, v46
    v_min_u32 v47, -2, v47
    buffer_store_dwordx4 v[44:47], v1, s[4:7], s70 offen offset:1024 sc1
    v_sub_f32 v144, v144, v98
    v_sub_f32 v145, v145, v98
    v_sub_f32 v146, v146, v98
    v_sub_f32 v147, v147, v98
    v_sub_f32 v148, v148, v98
    v_sub_f32 v149, v149, v98
    v_sub_f32 v150, v150, v98
    v_sub_f32 v151, v151, v98
    v_cvt_pk_bf16_f32 v36, v144, v145
    v_cvt_pk_bf16_f32 v37, v146, v147
    v_cvt_pk_bf16_f32 v38, v148, v149
    v_cvt_pk_bf16_f32 v39, v150, v151
    v_lshlrev_b32 v144, 16, v36
    v_and_b32 v145, 0xffff0000, v36
    v_lshlrev_b32 v146, 16, v37
    v_and_b32 v147, 0xffff0000, v37
    v_lshlrev_b32 v148, 16, v38
    v_and_b32 v149, 0xffff0000, v38
    v_lshlrev_b32 v150, 16, v39
    v_and_b32 v151, 0xffff0000, v39
    v_mul_f32 v144, v144, v106
    v_mul_f32 v145, v145, v106
    v_mul_f32 v146, v146, v106
    v_mul_f32 v147, v147, v106
    v_mul_f32 v148, v148, v106
    v_mul_f32 v149, v149, v106
    v_mul_f32 v150, v150, v106
    v_mul_f32 v151, v151, v106
    v_cvt_pk_bf16_f32 v36, v144, v145
    v_cvt_pk_bf16_f32 v37, v146, v147
    v_cvt_pk_bf16_f32 v38, v148, v149
    v_cvt_pk_bf16_f32 v39, v150, v151
    v_lshlrev_b32 v144, 16, v36
    v_and_b32 v145, 0xffff0000, v36
    v_lshlrev_b32 v146, 16, v37
    v_and_b32 v147, 0xffff0000, v37
    v_lshlrev_b32 v148, 16, v38
    v_and_b32 v149, 0xffff0000, v38
    v_lshlrev_b32 v150, 16, v39
    v_and_b32 v151, 0xffff0000, v39
    v_pk_mul_f32 v[144:145], v[144:145], v[28:29]
    v_pk_mul_f32 v[146:147], v[146:147], v[30:31]
    v_pk_mul_f32 v[148:149], v[148:149], v[32:33]
    v_pk_mul_f32 v[150:151], v[150:151], v[34:35]
    v_cvt_pk_bf16_f32 v36, v144, v145
    v_cvt_pk_bf16_f32 v37, v146, v147
    v_cvt_pk_bf16_f32 v38, v148, v149
    v_cvt_pk_bf16_f32 v39, v150, v151
    v_lshlrev_b32 v144, 16, v36
    v_and_b32 v145, 0xffff0000, v36
    v_lshlrev_b32 v146, 16, v37
    v_and_b32 v147, 0xffff0000, v37
    v_lshlrev_b32 v148, 16, v38
    v_and_b32 v149, 0xffff0000, v38
    v_lshlrev_b32 v150, 16, v39
    v_and_b32 v151, 0xffff0000, v39
    v_pk_add_f32 v[144:145], v[144:145], v[20:21]
    v_pk_add_f32 v[146:147], v[146:147], v[22:23]
    v_pk_add_f32 v[148:149], v[148:149], v[24:25]
    v_pk_add_f32 v[150:151], v[150:151], v[26:27]
    v_cvt_pk_bf16_f32 v48, v144, v145
    v_cvt_pk_bf16_f32 v49, v146, v147
    v_cvt_pk_bf16_f32 v50, v148, v149
    v_cvt_pk_bf16_f32 v51, v150, v151
    v_min_u32 v48, -2, v48
    v_min_u32 v49, -2, v49
    v_min_u32 v50, -2, v50
    v_min_u32 v51, -2, v51
    buffer_store_dwordx4 v[48:51], v1, s[4:7], s70 offen offset:2048 sc1
    v_sub_f32 v152, v152, v99
    v_sub_f32 v153, v153, v99
    v_sub_f32 v154, v154, v99
    v_sub_f32 v155, v155, v99
    v_sub_f32 v156, v156, v99
    v_sub_f32 v157, v157, v99
    v_sub_f32 v158, v158, v99
    v_sub_f32 v159, v159, v99
    v_cvt_pk_bf16_f32 v36, v152, v153
    v_cvt_pk_bf16_f32 v37, v154, v155
    v_cvt_pk_bf16_f32 v38, v156, v157
    v_cvt_pk_bf16_f32 v39, v158, v159
    v_lshlrev_b32 v152, 16, v36
    v_and_b32 v153, 0xffff0000, v36
    v_lshlrev_b32 v154, 16, v37
    v_and_b32 v155, 0xffff0000, v37
    v_lshlrev_b32 v156, 16, v38
    v_and_b32 v157, 0xffff0000, v38
    v_lshlrev_b32 v158, 16, v39
    v_and_b32 v159, 0xffff0000, v39
    v_mul_f32 v152, v152, v107
    v_mul_f32 v153, v153, v107
    v_mul_f32 v154, v154, v107
    v_mul_f32 v155, v155, v107
    v_mul_f32 v156, v156, v107
    v_mul_f32 v157, v157, v107
    v_mul_f32 v158, v158, v107
    v_mul_f32 v159, v159, v107
    v_cvt_pk_bf16_f32 v36, v152, v153
    v_cvt_pk_bf16_f32 v37, v154, v155
    v_cvt_pk_bf16_f32 v38, v156, v157
    v_cvt_pk_bf16_f32 v39, v158, v159
    v_lshlrev_b32 v152, 16, v36
    v_and_b32 v153, 0xffff0000, v36
    v_lshlrev_b32 v154, 16, v37
    v_and_b32 v155, 0xffff0000, v37
    v_lshlrev_b32 v156, 16, v38
    v_and_b32 v157, 0xffff0000, v38
    v_lshlrev_b32 v158, 16, v39
    v_and_b32 v159, 0xffff0000, v39
    v_pk_mul_f32 v[152:153], v[152:153], v[28:29]
    v_pk_mul_f32 v[154:155], v[154:155], v[30:31]
    v_pk_mul_f32 v[156:157], v[156:157], v[32:33]
    v_pk_mul_f32 v[158:159], v[158:159], v[34:35]
    v_cvt_pk_bf16_f32 v36, v152, v153
    v_cvt_pk_bf16_f32 v37, v154, v155
    v_cvt_pk_bf16_f32 v38, v156, v157
    v_cvt_pk_bf16_f32 v39, v158, v159
    v_lshlrev_b32 v152, 16, v36
    v_and_b32 v153, 0xffff0000, v36
    v_lshlrev_b32 v154, 16, v37
    v_and_b32 v155, 0xffff0000, v37
    v_lshlrev_b32 v156, 16, v38
    v_and_b32 v157, 0xffff0000, v38
    v_lshlrev_b32 v158, 16, v39
    v_and_b32 v159, 0xffff0000, v39
    v_pk_add_f32 v[152:153], v[152:153], v[20:21]
    v_pk_add_f32 v[154:155], v[154:155], v[22:23]
    v_pk_add_f32 v[156:157], v[156:157], v[24:25]
    v_pk_add_f32 v[158:159], v[158:159], v[26:27]
    v_cvt_pk_bf16_f32 v52, v152, v153
    v_cvt_pk_bf16_f32 v53, v154, v155
    v_cvt_pk_bf16_f32 v54, v156, v157
    v_cvt_pk_bf16_f32 v55, v158, v159
    v_min_u32 v52, -2, v52
    v_min_u32 v53, -2, v53
    v_min_u32 v54, -2, v54
    v_min_u32 v55, -2, v55
    buffer_store_dwordx4 v[52:55], v1, s[4:7], s70 offen offset:3072 sc1
    v_sub_f32 v160, v160, v100
    v_sub_f32 v161, v161, v100
    v_sub_f32 v162, v162, v100
    v_sub_f32 v163, v163, v100
    v_sub_f32 v164, v164, v100
    v_sub_f32 v165, v165, v100
    v_sub_f32 v166, v166, v100
    v_sub_f32 v167, v167, v100
    v_cvt_pk_bf16_f32 v36, v160, v161
    v_cvt_pk_bf16_f32 v37, v162, v163
    v_cvt_pk_bf16_f32 v38, v164, v165
    v_cvt_pk_bf16_f32 v39, v166, v167
    v_lshlrev_b32 v160, 16, v36
    v_and_b32 v161, 0xffff0000, v36
    v_lshlrev_b32 v162, 16, v37
    v_and_b32 v163, 0xffff0000, v37
    v_lshlrev_b32 v164, 16, v38
    v_and_b32 v165, 0xffff0000, v38
    v_lshlrev_b32 v166, 16, v39
    v_and_b32 v167, 0xffff0000, v39
    v_mul_f32 v160, v160, v108
    v_mul_f32 v161, v161, v108
    v_mul_f32 v162, v162, v108
    v_mul_f32 v163, v163, v108
    v_mul_f32 v164, v164, v108
    v_mul_f32 v165, v165, v108
    v_mul_f32 v166, v166, v108
    v_mul_f32 v167, v167, v108
    v_cvt_pk_bf16_f32 v36, v160, v161
    v_cvt_pk_bf16_f32 v37, v162, v163
    v_cvt_pk_bf16_f32 v38, v164, v165
    v_cvt_pk_bf16_f32 v39, v166, v167
    v_lshlrev_b32 v160, 16, v36
    v_and_b32 v161, 0xffff0000, v36
    v_lshlrev_b32 v162, 16, v37
    v_and_b32 v163, 0xffff0000, v37
    v_lshlrev_b32 v164, 16, v38
    v_and_b32 v165, 0xffff0000, v38
    v_lshlrev_b32 v166, 16, v39
    v_and_b32 v167, 0xffff0000, v39
    v_pk_mul_f32 v[160:161], v[160:161], v[28:29]
    v_pk_mul_f32 v[162:163], v[162:163], v[30:31]
    v_pk_mul_f32 v[164:165], v[164:165], v[32:33]
    v_pk_mul_f32 v[166:167], v[166:167], v[34:35]
    v_cvt_pk_bf16_f32 v36, v160, v161
    v_cvt_pk_bf16_f32 v37, v162, v163
    v_cvt_pk_bf16_f32 v38, v164, v165
    v_cvt_pk_bf16_f32 v39, v166, v167
    v_lshlrev_b32 v160, 16, v36
    v_and_b32 v161, 0xffff0000, v36
    v_lshlrev_b32 v162, 16, v37
    v_and_b32 v163, 0xffff0000, v37
    v_lshlrev_b32 v164, 16, v38
    v_and_b32 v165, 0xffff0000, v38
    v_lshlrev_b32 v166, 16, v39
    v_and_b32 v167, 0xffff0000, v39
    v_pk_add_f32 v[160:161], v[160:161], v[20:21]
    v_pk_add_f32 v[162:163], v[162:163], v[22:23]
    v_pk_add_f32 v[164:165], v[164:165], v[24:25]
    v_pk_add_f32 v[166:167], v[166:167], v[26:27]
    v_cvt_pk_bf16_f32 v40, v160, v161
    v_cvt_pk_bf16_f32 v41, v162, v163
    v_cvt_pk_bf16_f32 v42, v164, v165
    v_cvt_pk_bf16_f32 v43, v166, v167
    v_min_u32 v40, -2, v40
    v_min_u32 v41, -2, v41
    v_min_u32 v42, -2, v42
    v_min_u32 v43, -2, v43
    buffer_store_dwordx4 v[40:43], v1, s[4:7], s25 offen offset:0 sc1
    v_sub_f32 v168, v168, v101
    v_sub_f32 v169, v169, v101
    v_sub_f32 v170, v170, v101
    v_sub_f32 v171, v171, v101
    v_sub_f32 v172, v172, v101
    v_sub_f32 v173, v173, v101
    v_sub_f32 v174, v174, v101
    v_sub_f32 v175, v175, v101
    v_cvt_pk_bf16_f32 v36, v168, v169
    v_cvt_pk_bf16_f32 v37, v170, v171
    v_cvt_pk_bf16_f32 v38, v172, v173
    v_cvt_pk_bf16_f32 v39, v174, v175
    v_lshlrev_b32 v168, 16, v36
    v_and_b32 v169, 0xffff0000, v36
    v_lshlrev_b32 v170, 16, v37
    v_and_b32 v171, 0xffff0000, v37
    v_lshlrev_b32 v172, 16, v38
    v_and_b32 v173, 0xffff0000, v38
    v_lshlrev_b32 v174, 16, v39
    v_and_b32 v175, 0xffff0000, v39
    v_mul_f32 v168, v168, v109
    v_mul_f32 v169, v169, v109
    v_mul_f32 v170, v170, v109
    v_mul_f32 v171, v171, v109
    v_mul_f32 v172, v172, v109
    v_mul_f32 v173, v173, v109
    v_mul_f32 v174, v174, v109
    v_mul_f32 v175, v175, v109
    v_cvt_pk_bf16_f32 v36, v168, v169
    v_cvt_pk_bf16_f32 v37, v170, v171
    v_cvt_pk_bf16_f32 v38, v172, v173
    v_cvt_pk_bf16_f32 v39, v174, v175
    v_lshlrev_b32 v168, 16, v36
    v_and_b32 v169, 0xffff0000, v36
    v_lshlrev_b32 v170, 16, v37
    v_and_b32 v171, 0xffff0000, v37
    v_lshlrev_b32 v172, 16, v38
    v_and_b32 v173, 0xffff0000, v38
    v_lshlrev_b32 v174, 16, v39
    v_and_b32 v175, 0xffff0000, v39
    v_pk_mul_f32 v[168:169], v[168:169], v[28:29]
    v_pk_mul_f32 v[170:171], v[170:171], v[30:31]
    v_pk_mul_f32 v[172:173], v[172:173], v[32:33]
    v_pk_mul_f32 v[174:175], v[174:175], v[34:35]
    v_cvt_pk_bf16_f32 v36, v168, v169
    v_cvt_pk_bf16_f32 v37, v170, v171
    v_cvt_pk_bf16_f32 v38, v172, v173
    v_cvt_pk_bf16_f32 v39, v174, v175
    v_lshlrev_b32 v168, 16, v36
    v_and_b32 v169, 0xffff0000, v36
    v_lshlrev_b32 v170, 16, v37
    v_and_b32 v171, 0xffff0000, v37
    v_lshlrev_b32 v172, 16, v38
    v_and_b32 v173, 0xffff0000, v38
    v_lshlrev_b32 v174, 16, v39
    v_and_b32 v175, 0xffff0000, v39
    v_pk_add_f32 v[168:169], v[168:169], v[20:21]
    v_pk_add_f32 v[170:171], v[170:171], v[22:23]
    v_pk_add_f32 v[172:173], v[172:173], v[24:25]
    v_pk_add_f32 v[174:175], v[174:175], v[26:27]
    v_cvt_pk_bf16_f32 v44, v168, v169
    v_cvt_pk_bf16_f32 v45, v170, v171
    v_cvt_pk_bf16_f32 v46, v172, v173
    v_cvt_pk_bf16_f32 v47, v174, v175
    v_min_u32 v44, -2, v44
    v_min_u32 v45, -2, v45
    v_min_u32 v46, -2, v46
    v_min_u32 v47, -2, v47
    buffer_store_dwordx4 v[44:47], v1, s[4:7], s25 offen offset:1024 sc1
    v_sub_f32 v176, v176, v102
    v_sub_f32 v177, v177, v102
    v_sub_f32 v178, v178, v102
    v_sub_f32 v179, v179, v102
    v_sub_f32 v180, v180, v102
    v_sub_f32 v181, v181, v102
    v_sub_f32 v182, v182, v102
    v_sub_f32 v183, v183, v102
    v_cvt_pk_bf16_f32 v36, v176, v177
    v_cvt_pk_bf16_f32 v37, v178, v179
    v_cvt_pk_bf16_f32 v38, v180, v181
    v_cvt_pk_bf16_f32 v39, v182, v183
    v_lshlrev_b32 v176, 16, v36
    v_and_b32 v177, 0xffff0000, v36
    v_lshlrev_b32 v178, 16, v37
    v_and_b32 v179, 0xffff0000, v37
    v_lshlrev_b32 v180, 16, v38
    v_and_b32 v181, 0xffff0000, v38
    v_lshlrev_b32 v182, 16, v39
    v_and_b32 v183, 0xffff0000, v39
    v_mul_f32 v176, v176, v110
    v_mul_f32 v177, v177, v110
    v_mul_f32 v178, v178, v110
    v_mul_f32 v179, v179, v110
    v_mul_f32 v180, v180, v110
    v_mul_f32 v181, v181, v110
    v_mul_f32 v182, v182, v110
    v_mul_f32 v183, v183, v110
    v_cvt_pk_bf16_f32 v36, v176, v177
    v_cvt_pk_bf16_f32 v37, v178, v179
    v_cvt_pk_bf16_f32 v38, v180, v181
    v_cvt_pk_bf16_f32 v39, v182, v183
    v_lshlrev_b32 v176, 16, v36
    v_and_b32 v177, 0xffff0000, v36
    v_lshlrev_b32 v178, 16, v37
    v_and_b32 v179, 0xffff0000, v37
    v_lshlrev_b32 v180, 16, v38
    v_and_b32 v181, 0xffff0000, v38
    v_lshlrev_b32 v182, 16, v39
    v_and_b32 v183, 0xffff0000, v39
    v_pk_mul_f32 v[176:177], v[176:177], v[28:29]
    v_pk_mul_f32 v[178:179], v[178:179], v[30:31]
    v_pk_mul_f32 v[180:181], v[180:181], v[32:33]
    v_pk_mul_f32 v[182:183], v[182:183], v[34:35]
    v_cvt_pk_bf16_f32 v36, v176, v177
    v_cvt_pk_bf16_f32 v37, v178, v179
    v_cvt_pk_bf16_f32 v38, v180, v181
    v_cvt_pk_bf16_f32 v39, v182, v183
    v_lshlrev_b32 v176, 16, v36
    v_and_b32 v177, 0xffff0000, v36
    v_lshlrev_b32 v178, 16, v37
    v_and_b32 v179, 0xffff0000, v37
    v_lshlrev_b32 v180, 16, v38
    v_and_b32 v181, 0xffff0000, v38
    v_lshlrev_b32 v182, 16, v39
    v_and_b32 v183, 0xffff0000, v39
    v_pk_add_f32 v[176:177], v[176:177], v[20:21]
    v_pk_add_f32 v[178:179], v[178:179], v[22:23]
    v_pk_add_f32 v[180:181], v[180:181], v[24:25]
    v_pk_add_f32 v[182:183], v[182:183], v[26:27]
    v_cvt_pk_bf16_f32 v48, v176, v177
    v_cvt_pk_bf16_f32 v49, v178, v179
    v_cvt_pk_bf16_f32 v50, v180, v181
    v_cvt_pk_bf16_f32 v51, v182, v183
    v_min_u32 v48, -2, v48
    v_min_u32 v49, -2, v49
    v_min_u32 v50, -2, v50
    v_min_u32 v51, -2, v51
    buffer_store_dwordx4 v[48:51], v1, s[4:7], s25 offen offset:2048 sc1
    v_sub_f32 v184, v184, v103
    v_sub_f32 v185, v185, v103
    v_sub_f32 v186, v186, v103
    v_sub_f32 v187, v187, v103
    v_sub_f32 v188, v188, v103
    v_sub_f32 v189, v189, v103
    v_sub_f32 v190, v190, v103
    v_sub_f32 v191, v191, v103
    v_cvt_pk_bf16_f32 v36, v184, v185
    v_cvt_pk_bf16_f32 v37, v186, v187
    v_cvt_pk_bf16_f32 v38, v188, v189
    v_cvt_pk_bf16_f32 v39, v190, v191
    v_lshlrev_b32 v184, 16, v36
    v_and_b32 v185, 0xffff0000, v36
    v_lshlrev_b32 v186, 16, v37
    v_and_b32 v187, 0xffff0000, v37
    v_lshlrev_b32 v188, 16, v38
    v_and_b32 v189, 0xffff0000, v38
    v_lshlrev_b32 v190, 16, v39
    v_and_b32 v191, 0xffff0000, v39
    v_mul_f32 v184, v184, v111
    v_mul_f32 v185, v185, v111
    v_mul_f32 v186, v186, v111
    v_mul_f32 v187, v187, v111
    v_mul_f32 v188, v188, v111
    v_mul_f32 v189, v189, v111
    v_mul_f32 v190, v190, v111
    v_mul_f32 v191, v191, v111
    v_cvt_pk_bf16_f32 v36, v184, v185
    v_cvt_pk_bf16_f32 v37, v186, v187
    v_cvt_pk_bf16_f32 v38, v188, v189
    v_cvt_pk_bf16_f32 v39, v190, v191
    v_lshlrev_b32 v184, 16, v36
    v_and_b32 v185, 0xffff0000, v36
    v_lshlrev_b32 v186, 16, v37
    v_and_b32 v187, 0xffff0000, v37
    v_lshlrev_b32 v188, 16, v38
    v_and_b32 v189, 0xffff0000, v38
    v_lshlrev_b32 v190, 16, v39
    v_and_b32 v191, 0xffff0000, v39
    v_pk_mul_f32 v[184:185], v[184:185], v[28:29]
    v_pk_mul_f32 v[186:187], v[186:187], v[30:31]
    v_pk_mul_f32 v[188:189], v[188:189], v[32:33]
    v_pk_mul_f32 v[190:191], v[190:191], v[34:35]
    v_cvt_pk_bf16_f32 v36, v184, v185
    v_cvt_pk_bf16_f32 v37, v186, v187
    v_cvt_pk_bf16_f32 v38, v188, v189
    v_cvt_pk_bf16_f32 v39, v190, v191
    v_lshlrev_b32 v184, 16, v36
    v_and_b32 v185, 0xffff0000, v36
    v_lshlrev_b32 v186, 16, v37
    v_and_b32 v187, 0xffff0000, v37
    v_lshlrev_b32 v188, 16, v38
    v_and_b32 v189, 0xffff0000, v38
    v_lshlrev_b32 v190, 16, v39
    v_and_b32 v191, 0xffff0000, v39
    v_pk_add_f32 v[184:185], v[184:185], v[20:21]
    v_pk_add_f32 v[186:187], v[186:187], v[22:23]
    v_pk_add_f32 v[188:189], v[188:189], v[24:25]
    v_pk_add_f32 v[190:191], v[190:191], v[26:27]
    v_cvt_pk_bf16_f32 v52, v184, v185
    v_cvt_pk_bf16_f32 v53, v186, v187
    v_cvt_pk_bf16_f32 v54, v188, v189
    v_cvt_pk_bf16_f32 v55, v190, v191
    v_min_u32 v52, -2, v52
    v_min_u32 v53, -2, v53
    v_min_u32 v54, -2, v54
    v_min_u32 v55, -2, v55
    buffer_store_dwordx4 v[52:55], v1, s[4:7], s25 offen offset:3072 sc1
    s_waitcnt vmcnt(0)
    s_barrier
    s_cmp_lg_u32 s20, 0
    s_cbranch_scc1 L_ai_32
    s_and_b32 s23, s22, 2
    s_lshl_b32 s23, s23, 3
    s_add_u32 s23, s23, 176
    v_mov_b32 v16, s23
    v_mov_b32 v17, 1
    s_mov_b64 exec, 1
    buffer_atomic_add v17, v16, s[76:79], 0 offen offset:8
    s_mov_b64 exec, -1
L_ai_32:
    s_branch L_startup_done
L_not_ln1:
    s_cmp_lt_u32 s24, 96
    s_cbranch_scc1 L_modgo_34
    s_branch L_modx_33
L_modgo_34:
    s_mov_b32 s12, s54
    s_and_b32 s13, s55, 0xffff
    s_mov_b32 s14, 0x400
    s_mov_b32 s15, 0x20000
    s_mov_b32 s16, s56
    s_and_b32 s17, s57, 0xffff
    s_mov_b32 s18, 0x300000
    s_mov_b32 s19, 0x20000
    v_lshrrev_b32 v7, 3, v2
    v_lshlrev_b32 v8, 5, v7
    s_lshl_b32 s70, s20, 8
    buffer_load_dwordx4 v[56:59], v8, s[12:15], s70 offen
    buffer_load_dwordx4 v[60:63], v8, s[12:15], s70 offen offset:16
    v_mul_u32_u24 v7, 98304, v7
    v_and_b32 v8, 7, v2
    v_lshl_add_u32 v7, v8, 4, v7
    s_mul_i32 s70, s20, 786432
    s_mul_i32 s72, s24, 11
    s_lshr_b32 s72, s72, 1
    s_sub_u32 s72, s72, 5
    s_mul_hi_u32 s71, s72, 0x5555556
    s_mul_i32 s71, s71, 48
    s_sub_u32 s72, s72, s71
    s_lshl_b32 s71, s72, 7
    s_add_u32 s70, s70, s71
    buffer_load_dwordx4 v[128:131], v7, s[16:19], s70 offen
    s_add_u32 s70, s70, 6144
    buffer_load_dwordx4 v[132:135], v7, s[16:19], s70 offen
    s_add_u32 s70, s70, 6144
    buffer_load_dwordx4 v[136:139], v7, s[16:19], s70 offen
    s_add_u32 s70, s70, 6144
    buffer_load_dwordx4 v[140:143], v7, s[16:19], s70 offen
    s_add_u32 s70, s70, 6144
    buffer_load_dwordx4 v[144:147], v7, s[16:19], s70 offen
    s_add_u32 s70, s70, 6144
    buffer_load_dwordx4 v[148:151], v7, s[16:19], s70 offen
    s_add_u32 s70, s70, 6144
    buffer_load_dwordx4 v[152:155], v7, s[16:19], s70 offen
    s_add_u32 s70, s70, 6144
    buffer_load_dwordx4 v[156:159], v7, s[16:19], s70 offen
    s_add_u32 s70, s70, 6144
    buffer_load_dwordx4 v[160:163], v7, s[16:19], s70 offen
    s_add_u32 s70, s70, 6144
    buffer_load_dwordx4 v[164:167], v7, s[16:19], s70 offen
    s_add_u32 s70, s70, 6144
    buffer_load_dwordx4 v[168:171], v7, s[16:19], s70 offen
    s_add_u32 s70, s70, 6144
    buffer_load_dwordx4 v[172:175], v7, s[16:19], s70 offen
    s_add_u32 s70, s70, 6144
    buffer_load_dwordx4 v[176:179], v7, s[16:19], s70 offen
    s_add_u32 s70, s70, 6144
    buffer_load_dwordx4 v[180:183], v7, s[16:19], s70 offen
    s_add_u32 s70, s70, 6144
    buffer_load_dwordx4 v[184:187], v7, s[16:19], s70 offen
    s_add_u32 s70, s70, 6144
    buffer_load_dwordx4 v[188:191], v7, s[16:19], s70 offen
    s_add_u32 s70, s70, 6144
    s_waitcnt vmcnt(17)
    v_lshlrev_b32 v20, 16, v56
    v_and_b32 v21, 0xffff0000, v56
    v_lshlrev_b32 v22, 16, v57
    v_and_b32 v23, 0xffff0000, v57
    v_lshlrev_b32 v24, 16, v58
    v_and_b32 v25, 0xffff0000, v58
    v_lshlrev_b32 v26, 16, v59
    v_and_b32 v27, 0xffff0000, v59
    s_waitcnt vmcnt(16)
    v_lshlrev_b32 v28, 16, v60
    v_and_b32 v29, 0xffff0000, v60
    v_lshlrev_b32 v30, 16, v61
    v_and_b32 v31, 0xffff0000, v61
    v_lshlrev_b32 v32, 16, v62
    v_and_b32 v33, 0xffff0000, v62
    v_lshlrev_b32 v34, 16, v63
    v_and_b32 v35, 0xffff0000, v63
    v_mul_f32 v48, 0xbfb8aa3b, v20
    v_mul_f32 v49, 0xbfb8aa3b, v21
    v_mul_f32 v50, 0xbfb8aa3b, v22
    v_mul_f32 v51, 0xbfb8aa3b, v23
    v_mul_f32 v52, 0xbfb8aa3b, v24
    v_mul_f32 v53, 0xbfb8aa3b, v25
    v_mul_f32 v54, 0xbfb8aa3b, v26
    v_mul_f32 v55, 0xbfb8aa3b, v27
    v_exp_f32 v48, v48
    v_exp_f32 v49, v49
    v_exp_f32 v50, v50
    v_exp_f32 v51, v51
    v_exp_f32 v52, v52
    v_exp_f32 v53, v53
    v_exp_f32 v54, v54
    v_exp_f32 v55, v55
    v_add_f32 v48, 1.0, v48
    v_add_f32 v49, 1.0, v49
    v_add_f32 v50, 1.0, v50
    v_add_f32 v51, 1.0, v51
    v_add_f32 v52, 1.0, v52
    v_add_f32 v53, 1.0, v53
    v_add_f32 v54, 1.0, v54
    v_add_f32 v55, 1.0, v55
    v_rcp_f32 v48, v48
    v_rcp_f32 v49, v49
    v_rcp_f32 v50, v50
    v_rcp_f32 v51, v51
    v_rcp_f32 v52, v52
    v_rcp_f32 v53, v53
    v_rcp_f32 v54, v54
    v_rcp_f32 v55, v55
    v_mul_f32 v20, v20, v48
    v_mul_f32 v21, v21, v49
    v_mul_f32 v22, v22, v50
    v_mul_f32 v23, v23, v51
    v_mul_f32 v24, v24, v52
    v_mul_f32 v25, v25, v53
    v_mul_f32 v26, v26, v54
    v_mul_f32 v27, v27, v55
    v_mul_f32 v48, 0xbfb8aa3b, v28
    v_mul_f32 v49, 0xbfb8aa3b, v29
    v_mul_f32 v50, 0xbfb8aa3b, v30
    v_mul_f32 v51, 0xbfb8aa3b, v31
    v_mul_f32 v52, 0xbfb8aa3b, v32
    v_mul_f32 v53, 0xbfb8aa3b, v33
    v_mul_f32 v54, 0xbfb8aa3b, v34
    v_mul_f32 v55, 0xbfb8aa3b, v35
    v_exp_f32 v48, v48
    v_exp_f32 v49, v49
    v_exp_f32 v50, v50
    v_exp_f32 v51, v51
    v_exp_f32 v52, v52
    v_exp_f32 v53, v53
    v_exp_f32 v54, v54
    v_exp_f32 v55, v55
    v_add_f32 v48, 1.0, v48
    v_add_f32 v49, 1.0, v49
    v_add_f32 v50, 1.0, v50
    v_add_f32 v51, 1.0, v51
    v_add_f32 v52, 1.0, v52
    v_add_f32 v53, 1.0, v53
    v_add_f32 v54, 1.0, v54
    v_add_f32 v55, 1.0, v55
    v_rcp_f32 v48, v48
    v_rcp_f32 v49, v49
    v_rcp_f32 v50, v50
    v_rcp_f32 v51, v51
    v_rcp_f32 v52, v52
    v_rcp_f32 v53, v53
    v_rcp_f32 v54, v54
    v_rcp_f32 v55, v55
    v_mul_f32 v28, v28, v48
    v_mul_f32 v29, v29, v49
    v_mul_f32 v30, v30, v50
    v_mul_f32 v31, v31, v51
    v_mul_f32 v32, v32, v52
    v_mul_f32 v33, v33, v53
    v_mul_f32 v34, v34, v54
    v_mul_f32 v35, v35, v55
    v_cvt_pk_bf16_f32 v48, v20, v21
    v_cvt_pk_bf16_f32 v49, v22, v23
    v_cvt_pk_bf16_f32 v50, v24, v25
    v_cvt_pk_bf16_f32 v51, v26, v27
    v_cvt_pk_bf16_f32 v52, v28, v29
    v_cvt_pk_bf16_f32 v53, v30, v31
    v_cvt_pk_bf16_f32 v54, v32, v33
    v_cvt_pk_bf16_f32 v55, v34, v35
    v_lshlrev_b32 v20, 16, v48
    v_and_b32 v21, 0xffff0000, v48
    v_lshlrev_b32 v22, 16, v49
    v_and_b32 v23, 0xffff0000, v49
    v_lshlrev_b32 v24, 16, v50
    v_and_b32 v25, 0xffff0000, v50
    v_lshlrev_b32 v26, 16, v51
    v_and_b32 v27, 0xffff0000, v51
    v_lshlrev_b32 v28, 16, v52
    v_and_b32 v29, 0xffff0000, v52
    v_lshlrev_b32 v30, 16, v53
    v_and_b32 v31, 0xffff0000, v53
    v_lshlrev_b32 v32, 16, v54
    v_and_b32 v33, 0xffff0000, v54
    v_lshlrev_b32 v34, 16, v55
    v_and_b32 v35, 0xffff0000, v55
    s_waitcnt vmcnt(15)
    v_lshlrev_b32 v48, 16, v128
    v_and_b32 v49, 0xffff0000, v128
    v_lshlrev_b32 v50, 16, v129
    v_and_b32 v51, 0xffff0000, v129
    v_lshlrev_b32 v52, 16, v130
    v_and_b32 v53, 0xffff0000, v130
    v_lshlrev_b32 v54, 16, v131
    v_and_b32 v55, 0xffff0000, v131
    v_mul_f32 v40, v20, v48
    v_mul_f32 v41, v20, v49
    v_mul_f32 v42, v20, v50
    v_mul_f32 v43, v20, v51
    v_mul_f32 v44, v20, v52
    v_mul_f32 v45, v20, v53
    v_mul_f32 v46, v20, v54
    v_mul_f32 v47, v20, v55
    s_waitcnt vmcnt(14)
    v_lshlrev_b32 v48, 16, v132
    v_and_b32 v49, 0xffff0000, v132
    v_lshlrev_b32 v50, 16, v133
    v_and_b32 v51, 0xffff0000, v133
    v_lshlrev_b32 v52, 16, v134
    v_and_b32 v53, 0xffff0000, v134
    v_lshlrev_b32 v54, 16, v135
    v_and_b32 v55, 0xffff0000, v135
    v_fmac_f32 v40, v21, v48
    v_fmac_f32 v41, v21, v49
    v_fmac_f32 v42, v21, v50
    v_fmac_f32 v43, v21, v51
    v_fmac_f32 v44, v21, v52
    v_fmac_f32 v45, v21, v53
    v_fmac_f32 v46, v21, v54
    v_fmac_f32 v47, v21, v55
    s_waitcnt vmcnt(13)
    v_lshlrev_b32 v48, 16, v136
    v_and_b32 v49, 0xffff0000, v136
    v_lshlrev_b32 v50, 16, v137
    v_and_b32 v51, 0xffff0000, v137
    v_lshlrev_b32 v52, 16, v138
    v_and_b32 v53, 0xffff0000, v138
    v_lshlrev_b32 v54, 16, v139
    v_and_b32 v55, 0xffff0000, v139
    v_fmac_f32 v40, v22, v48
    v_fmac_f32 v41, v22, v49
    v_fmac_f32 v42, v22, v50
    v_fmac_f32 v43, v22, v51
    v_fmac_f32 v44, v22, v52
    v_fmac_f32 v45, v22, v53
    v_fmac_f32 v46, v22, v54
    v_fmac_f32 v47, v22, v55
    s_waitcnt vmcnt(12)
    v_lshlrev_b32 v48, 16, v140
    v_and_b32 v49, 0xffff0000, v140
    v_lshlrev_b32 v50, 16, v141
    v_and_b32 v51, 0xffff0000, v141
    v_lshlrev_b32 v52, 16, v142
    v_and_b32 v53, 0xffff0000, v142
    v_lshlrev_b32 v54, 16, v143
    v_and_b32 v55, 0xffff0000, v143
    v_fmac_f32 v40, v23, v48
    v_fmac_f32 v41, v23, v49
    v_fmac_f32 v42, v23, v50
    v_fmac_f32 v43, v23, v51
    v_fmac_f32 v44, v23, v52
    v_fmac_f32 v45, v23, v53
    v_fmac_f32 v46, v23, v54
    v_fmac_f32 v47, v23, v55
    s_waitcnt vmcnt(11)
    v_lshlrev_b32 v48, 16, v144
    v_and_b32 v49, 0xffff0000, v144
    v_lshlrev_b32 v50, 16, v145
    v_and_b32 v51, 0xffff0000, v145
    v_lshlrev_b32 v52, 16, v146
    v_and_b32 v53, 0xffff0000, v146
    v_lshlrev_b32 v54, 16, v147
    v_and_b32 v55, 0xffff0000, v147
    v_fmac_f32 v40, v24, v48
    v_fmac_f32 v41, v24, v49
    v_fmac_f32 v42, v24, v50
    v_fmac_f32 v43, v24, v51
    v_fmac_f32 v44, v24, v52
    v_fmac_f32 v45, v24, v53
    v_fmac_f32 v46, v24, v54
    v_fmac_f32 v47, v24, v55
    s_waitcnt vmcnt(10)
    v_lshlrev_b32 v48, 16, v148
    v_and_b32 v49, 0xffff0000, v148
    v_lshlrev_b32 v50, 16, v149
    v_and_b32 v51, 0xffff0000, v149
    v_lshlrev_b32 v52, 16, v150
    v_and_b32 v53, 0xffff0000, v150
    v_lshlrev_b32 v54, 16, v151
    v_and_b32 v55, 0xffff0000, v151
    v_fmac_f32 v40, v25, v48
    v_fmac_f32 v41, v25, v49
    v_fmac_f32 v42, v25, v50
    v_fmac_f32 v43, v25, v51
    v_fmac_f32 v44, v25, v52
    v_fmac_f32 v45, v25, v53
    v_fmac_f32 v46, v25, v54
    v_fmac_f32 v47, v25, v55
    s_waitcnt vmcnt(9)
    v_lshlrev_b32 v48, 16, v152
    v_and_b32 v49, 0xffff0000, v152
    v_lshlrev_b32 v50, 16, v153
    v_and_b32 v51, 0xffff0000, v153
    v_lshlrev_b32 v52, 16, v154
    v_and_b32 v53, 0xffff0000, v154
    v_lshlrev_b32 v54, 16, v155
    v_and_b32 v55, 0xffff0000, v155
    v_fmac_f32 v40, v26, v48
    v_fmac_f32 v41, v26, v49
    v_fmac_f32 v42, v26, v50
    v_fmac_f32 v43, v26, v51
    v_fmac_f32 v44, v26, v52
    v_fmac_f32 v45, v26, v53
    v_fmac_f32 v46, v26, v54
    v_fmac_f32 v47, v26, v55
    s_waitcnt vmcnt(8)
    v_lshlrev_b32 v48, 16, v156
    v_and_b32 v49, 0xffff0000, v156
    v_lshlrev_b32 v50, 16, v157
    v_and_b32 v51, 0xffff0000, v157
    v_lshlrev_b32 v52, 16, v158
    v_and_b32 v53, 0xffff0000, v158
    v_lshlrev_b32 v54, 16, v159
    v_and_b32 v55, 0xffff0000, v159
    v_fmac_f32 v40, v27, v48
    v_fmac_f32 v41, v27, v49
    v_fmac_f32 v42, v27, v50
    v_fmac_f32 v43, v27, v51
    v_fmac_f32 v44, v27, v52
    v_fmac_f32 v45, v27, v53
    v_fmac_f32 v46, v27, v54
    v_fmac_f32 v47, v27, v55
    s_waitcnt vmcnt(7)
    v_lshlrev_b32 v48, 16, v160
    v_and_b32 v49, 0xffff0000, v160
    v_lshlrev_b32 v50, 16, v161
    v_and_b32 v51, 0xffff0000, v161
    v_lshlrev_b32 v52, 16, v162
    v_and_b32 v53, 0xffff0000, v162
    v_lshlrev_b32 v54, 16, v163
    v_and_b32 v55, 0xffff0000, v163
    v_fmac_f32 v40, v28, v48
    v_fmac_f32 v41, v28, v49
    v_fmac_f32 v42, v28, v50
    v_fmac_f32 v43, v28, v51
    v_fmac_f32 v44, v28, v52
    v_fmac_f32 v45, v28, v53
    v_fmac_f32 v46, v28, v54
    v_fmac_f32 v47, v28, v55
    s_waitcnt vmcnt(6)
    v_lshlrev_b32 v48, 16, v164
    v_and_b32 v49, 0xffff0000, v164
    v_lshlrev_b32 v50, 16, v165
    v_and_b32 v51, 0xffff0000, v165
    v_lshlrev_b32 v52, 16, v166
    v_and_b32 v53, 0xffff0000, v166
    v_lshlrev_b32 v54, 16, v167
    v_and_b32 v55, 0xffff0000, v167
    v_fmac_f32 v40, v29, v48
    v_fmac_f32 v41, v29, v49
    v_fmac_f32 v42, v29, v50
    v_fmac_f32 v43, v29, v51
    v_fmac_f32 v44, v29, v52
    v_fmac_f32 v45, v29, v53
    v_fmac_f32 v46, v29, v54
    v_fmac_f32 v47, v29, v55
    s_waitcnt vmcnt(5)
    v_lshlrev_b32 v48, 16, v168
    v_and_b32 v49, 0xffff0000, v168
    v_lshlrev_b32 v50, 16, v169
    v_and_b32 v51, 0xffff0000, v169
    v_lshlrev_b32 v52, 16, v170
    v_and_b32 v53, 0xffff0000, v170
    v_lshlrev_b32 v54, 16, v171
    v_and_b32 v55, 0xffff0000, v171
    v_fmac_f32 v40, v30, v48
    v_fmac_f32 v41, v30, v49
    v_fmac_f32 v42, v30, v50
    v_fmac_f32 v43, v30, v51
    v_fmac_f32 v44, v30, v52
    v_fmac_f32 v45, v30, v53
    v_fmac_f32 v46, v30, v54
    v_fmac_f32 v47, v30, v55
    s_waitcnt vmcnt(4)
    v_lshlrev_b32 v48, 16, v172
    v_and_b32 v49, 0xffff0000, v172
    v_lshlrev_b32 v50, 16, v173
    v_and_b32 v51, 0xffff0000, v173
    v_lshlrev_b32 v52, 16, v174
    v_and_b32 v53, 0xffff0000, v174
    v_lshlrev_b32 v54, 16, v175
    v_and_b32 v55, 0xffff0000, v175
    v_fmac_f32 v40, v31, v48
    v_fmac_f32 v41, v31, v49
    v_fmac_f32 v42, v31, v50
    v_fmac_f32 v43, v31, v51
    v_fmac_f32 v44, v31, v52
    v_fmac_f32 v45, v31, v53
    v_fmac_f32 v46, v31, v54
    v_fmac_f32 v47, v31, v55
    s_waitcnt vmcnt(3)
    v_lshlrev_b32 v48, 16, v176
    v_and_b32 v49, 0xffff0000, v176
    v_lshlrev_b32 v50, 16, v177
    v_and_b32 v51, 0xffff0000, v177
    v_lshlrev_b32 v52, 16, v178
    v_and_b32 v53, 0xffff0000, v178
    v_lshlrev_b32 v54, 16, v179
    v_and_b32 v55, 0xffff0000, v179
    v_fmac_f32 v40, v32, v48
    v_fmac_f32 v41, v32, v49
    v_fmac_f32 v42, v32, v50
    v_fmac_f32 v43, v32, v51
    v_fmac_f32 v44, v32, v52
    v_fmac_f32 v45, v32, v53
    v_fmac_f32 v46, v32, v54
    v_fmac_f32 v47, v32, v55
    s_waitcnt vmcnt(2)
    v_lshlrev_b32 v48, 16, v180
    v_and_b32 v49, 0xffff0000, v180
    v_lshlrev_b32 v50, 16, v181
    v_and_b32 v51, 0xffff0000, v181
    v_lshlrev_b32 v52, 16, v182
    v_and_b32 v53, 0xffff0000, v182
    v_lshlrev_b32 v54, 16, v183
    v_and_b32 v55, 0xffff0000, v183
    v_fmac_f32 v40, v33, v48
    v_fmac_f32 v41, v33, v49
    v_fmac_f32 v42, v33, v50
    v_fmac_f32 v43, v33, v51
    v_fmac_f32 v44, v33, v52
    v_fmac_f32 v45, v33, v53
    v_fmac_f32 v46, v33, v54
    v_fmac_f32 v47, v33, v55
    s_waitcnt vmcnt(1)
    v_lshlrev_b32 v48, 16, v184
    v_and_b32 v49, 0xffff0000, v184
    v_lshlrev_b32 v50, 16, v185
    v_and_b32 v51, 0xffff0000, v185
    v_lshlrev_b32 v52, 16, v186
    v_and_b32 v53, 0xffff0000, v186
    v_lshlrev_b32 v54, 16, v187
    v_and_b32 v55, 0xffff0000, v187
    v_fmac_f32 v40, v34, v48
    v_fmac_f32 v41, v34, v49
    v_fmac_f32 v42, v34, v50
    v_fmac_f32 v43, v34, v51
    v_fmac_f32 v44, v34, v52
    v_fmac_f32 v45, v34, v53
    v_fmac_f32 v46, v34, v54
    v_fmac_f32 v47, v34, v55
    s_waitcnt vmcnt(0)
    v_lshlrev_b32 v48, 16, v188
    v_and_b32 v49, 0xffff0000, v188
    v_lshlrev_b32 v50, 16, v189
    v_and_b32 v51, 0xffff0000, v189
    v_lshlrev_b32 v52, 16, v190
    v_and_b32 v53, 0xffff0000, v190
    v_lshlrev_b32 v54, 16, v191
    v_and_b32 v55, 0xffff0000, v191
    v_fmac_f32 v40, v35, v48
    v_fmac_f32 v41, v35, v49
    v_fmac_f32 v42, v35, v50
    v_fmac_f32 v43, v35, v51
    v_fmac_f32 v44, v35, v52
    v_fmac_f32 v45, v35, v53
    v_fmac_f32 v46, v35, v54
    v_fmac_f32 v47, v35, v55
    s_lshl_b32 s70, s20, 11
    s_add_u32 s70, s70, 147456
    v_lshlrev_b32 v7, 5, v2
    v_add_u32 v7, s70, v7
    ds_write_b128 v7, v[40:43]
    ds_write_b128 v7, v[44:47] offset:16
    s_waitcnt lgkmcnt(0)
    s_barrier
    s_cmp_lg_u32 s20, 0
    s_cbranch_scc1 L_modx_33
    v_lshlrev_b32 v7, 2, v2
    v_add_u32 v8, 147456, v7
    ds_read_b32 v128, v8 offset:0
    ds_read_b32 v129, v8 offset:256
    ds_read_b32 v130, v8 offset:512
    ds_read_b32 v131, v8 offset:768
    ds_read_b32 v132, v8 offset:1024
    ds_read_b32 v133, v8 offset:1280
    ds_read_b32 v134, v8 offset:1536
    ds_read_b32 v135, v8 offset:1792
    ds_read_b32 v136, v8 offset:2048
    ds_read_b32 v137, v8 offset:2304
    ds_read_b32 v138, v8 offset:2560
    ds_read_b32 v139, v8 offset:2816
    ds_read_b32 v140, v8 offset:3072
    ds_read_b32 v141, v8 offset:3328
    ds_read_b32 v142, v8 offset:3584
    ds_read_b32 v143, v8 offset:3840
    ds_read_b32 v144, v8 offset:4096
    ds_read_b32 v145, v8 offset:4352
    ds_read_b32 v146, v8 offset:4608
    ds_read_b32 v147, v8 offset:4864
    ds_read_b32 v148, v8 offset:5120
    ds_read_b32 v149, v8 offset:5376
    ds_read_b32 v150, v8 offset:5632
    ds_read_b32 v151, v8 offset:5888
    ds_read_b32 v152, v8 offset:6144
    ds_read_b32 v153, v8 offset:6400
    ds_read_b32 v154, v8 offset:6656
    ds_read_b32 v155, v8 offset:6912
    ds_read_b32 v156, v8 offset:7168
    ds_read_b32 v157, v8 offset:7424
    ds_read_b32 v158, v8 offset:7680
    ds_read_b32 v159, v8 offset:7936
    s_waitcnt lgkmcnt(14)
    v_pk_add_f32 v[128:129], v[128:129], v[144:145]
    s_waitcnt lgkmcnt(12)
    v_pk_add_f32 v[130:131], v[130:131], v[146:147]
    s_waitcnt lgkmcnt(10)
    v_pk_add_f32 v[132:133], v[132:133], v[148:149]
    s_waitcnt lgkmcnt(8)
    v_pk_add_f32 v[134:135], v[134:135], v[150:151]
    s_waitcnt lgkmcnt(6)
    v_pk_add_f32 v[136:137], v[136:137], v[152:153]
    s_waitcnt lgkmcnt(4)
    v_pk_add_f32 v[138:139], v[138:139], v[154:155]
    s_waitcnt lgkmcnt(2)
    v_pk_add_f32 v[140:141], v[140:141], v[156:157]
    s_waitcnt lgkmcnt(0)
    v_pk_add_f32 v[142:143], v[142:143], v[158:159]
    v_pk_add_f32 v[128:129], v[128:129], v[136:137]
    v_pk_add_f32 v[130:131], v[130:131], v[138:139]
    v_pk_add_f32 v[132:133], v[132:133], v[140:141]
    v_pk_add_f32 v[134:135], v[134:135], v[142:143]
    v_pk_add_f32 v[128:129], v[128:129], v[132:133]
    v_pk_add_f32 v[130:131], v[130:131], v[134:135]
    v_pk_add_f32 v[128:129], v[128:129], v[130:131]
    v_add_f32 v128, v128, v129
    v_cvt_pk_bf16_f32 v128, v128, v128
    v_and_b32 v128, 0xffff0000, v128
    s_nop 0
    s_branch L_wf_37
L_wc_35:
    s_sleep 8
L_wf_37:
    buffer_load_dword v18, off, s[76:79], 0 offset:192 sc1
    buffer_load_dword v19, off, s[76:79], 0 offset:176 sc1
    s_add_u32 s31, s31, 1
    s_cmp_gt_u32 s31, 1048576
    s_cbranch_scc1 L_abort
    s_waitcnt vmcnt(0)
    v_add_u32 v18, v18, v19
    s_nop 0
    v_readfirstlane_b32 s70, v18
    s_cmp_lg_u32 s70, 64
    s_nop 2
    s_cbranch_scc1 L_wc_35
L_wd_36:
    s_lshl_b32 s70, s72, 8
    s_add_u32 s70, s70, 0x110000
    buffer_store_dword v128, v7, s[4:7], s70 offen sc1
L_modx_33:
L_startup_done:
    s_cmp_lt_u32 s24, 32
    s_cbranch_scc1 L_B_main
    s_cmp_lt_u32 s24, 75
    s_cbranch_scc1 L_C_main
    s_cmp_lt_u32 s24, 107
    s_cbranch_scc1 L_D_main
    s_cmp_lt_u32 s24, 123
    s_cbranch_scc1 L_R_main
    s_cmp_lg_u32 s20, 0
    s_cbranch_scc1 L_ai_38
    s_and_b32 s23, s22, 2
    s_lshl_b32 s23, s23, 3
    s_add_u32 s23, s23, 176
    v_mov_b32 v16, s23
    v_mov_b32 v17, 1
    s_mov_b64 exec, 1
    buffer_atomic_add v17, v16, s[76:79], 0 offen offset:4
    s_mov_b64 exec, -1
L_ai_38:
    s_endpgm
L_B_main:
    s_cmp_lg_u32 s20, 0
    s_cbranch_scc1 L_wd_40
    s_branch L_wf_41
L_wc_39:
    s_sleep 8
L_wf_41:
    buffer_load_dword v22, off, s[76:79], 0 offset:200 sc1
    buffer_load_dword v23, off, s[76:79], 0 offset:184 sc1
    s_add_u32 s31, s31, 1
    s_cmp_gt_u32 s31, 1048576
    s_cbranch_scc1 L_abort
    s_waitcnt vmcnt(0)
    v_add_u32 v22, v22, v23
    s_nop 0
    v_readfirstlane_b32 s70, v22
    s_cmp_lg_u32 s70, 64
    s_nop 2
    s_cbranch_scc1 L_wc_39
L_wd_40:
    s_barrier
    s_and_b32 s70, s24, 3
    s_lshl_b32 s70, s70, 2
    s_add_u32 s70, s70, s20
    s_lshl_b32 s70, s70, 7
    v_and_b32 v7, 7, v2
    v_lshlrev_b32 v7, 4, v7
    v_lshrrev_b32 v8, 3, v2
    v_lshl_add_u32 v7, v8, 11, v7
    v_add_u32 v10, s70, v7
    s_lshr_b32 s71, s24, 2
    s_lshl_b32 s29, s71, 16
    s_add_u32 s29, s29, 0x5000000
    s_add_u32 s70, s29, 0x0
    buffer_store_dwordx4 v[12:15], v10, s[4:7], s70 offen sc1
    s_add_u32 s70, s29, 0x4000
    buffer_store_dwordx4 v[12:15], v10, s[4:7], s70 offen sc1
    s_add_u32 s70, s29, 0x8000
    buffer_store_dwordx4 v[12:15], v10, s[4:7], s70 offen sc1
    s_add_u32 s70, s29, 0xc000
    buffer_store_dwordx4 v[12:15], v10, s[4:7], s70 offen sc1
    s_add_u32 s70, s29, 0x80000
    buffer_store_dwordx4 v[12:15], v10, s[4:7], s70 offen sc1
    s_add_u32 s70, s29, 0x84000
    buffer_store_dwordx4 v[12:15], v10, s[4:7], s70 offen sc1
    s_add_u32 s70, s29, 0x88000
    buffer_store_dwordx4 v[12:15], v10, s[4:7], s70 offen sc1
    s_add_u32 s70, s29, 0x8c000
    buffer_store_dwordx4 v[12:15], v10, s[4:7], s70 offen sc1
    s_add_u32 s70, s29, 0x100000
    buffer_store_dwordx4 v[12:15], v10, s[4:7], s70 offen sc1
    s_add_u32 s70, s29, 0x104000
    buffer_store_dwordx4 v[12:15], v10, s[4:7], s70 offen sc1
    s_add_u32 s70, s29, 0x108000
    buffer_store_dwordx4 v[12:15], v10, s[4:7], s70 offen sc1
    s_add_u32 s70, s29, 0x10c000
    buffer_store_dwordx4 v[12:15], v10, s[4:7], s70 offen sc1
    s_add_u32 s70, s29, 0x180000
    buffer_store_dwordx4 v[12:15], v10, s[4:7], s70 offen sc1
    s_add_u32 s70, s29, 0x184000
    buffer_store_dwordx4 v[12:15], v10, s[4:7], s70 offen sc1
    s_add_u32 s70, s29, 0x188000
    buffer_store_dwordx4 v[12:15], v10, s[4:7], s70 offen sc1
    s_add_u32 s70, s29, 0x18c000
    buffer_store_dwordx4 v[12:15], v10, s[4:7], s70 offen sc1
    s_and_b32 s70, s24, 3
    s_cmp_eq_u32 s70, 3
    s_cbranch_scc1 L_bo_42
    s_lshl_b32 s70, s70, 5
    s_and_b32 s71, s24, 28
    s_add_u32 s70, s70, s71
    s_add_u32 s70, s70, s20
    s_lshl_b32 s70, s70, 13
    s_add_u32 s70, s70, 0x4000000
    s_add_u32 s71, s70, 4096
    buffer_store_dwordx4 v[12:15], v1, s[4:7], s70 offen offset:0 sc1
    buffer_store_dwordx4 v[12:15], v1, s[4:7], s70 offen offset:1024 sc1
    buffer_store_dwordx4 v[12:15], v1, s[4:7], s70 offen offset:2048 sc1
    buffer_store_dwordx4 v[12:15], v1, s[4:7], s70 offen offset:3072 sc1
    buffer_store_dwordx4 v[12:15], v1, s[4:7], s71 offen offset:0 sc1
    buffer_store_dwordx4 v[12:15], v1, s[4:7], s71 offen offset:1024 sc1
    buffer_store_dwordx4 v[12:15], v1, s[4:7], s71 offen offset:2048 sc1
    buffer_store_dwordx4 v[12:15], v1, s[4:7], s71 offen offset:3072 sc1
L_bo_42:
    s_waitcnt vmcnt(0)
    s_barrier
    s_cmp_lg_u32 s20, 0
    s_cbranch_scc1 L_ai_43
    s_and_b32 s23, s22, 2
    s_lshl_b32 s23, s23, 3
    s_add_u32 s23, s23, 176
    v_mov_b32 v20, s23
    v_mov_b32 v21, 1
    s_mov_b64 exec, 1
    buffer_atomic_add v21, v20, s[76:79], 0 offen offset:4
    s_mov_b64 exec, -1
L_ai_43:
    s_mov_b32 s12, s42
    s_and_b32 s13, s43, 0xffff
    s_mov_b32 s14, 0x400000
    s_mov_b32 s15, 0x20000
    v_lshlrev_b32 v7, 5, v3
    v_lshlrev_b32 v8, 4, v4
    v_xor_b32 v7, v7, v8
    v_lshl_add_u32 v16, v3, 10, v7
    v_xor_b32 v17, 128, v16
    s_lshr_b32 s71, s24, 2
    s_lshl_b32 s71, s71, 19
    s_and_b32 s70, s24, 3
    s_lshl_b32 s70, s70, 8
    s_add_u32 s71, s71, s70
    s_lshl_b32 s70, s20, 15
    s_add_u32 s71, s71, s70
    s_lshl_b32 s72, s20, 13
    s_add_u32 m0, s72, 0
    s_add_u32 s70, s71, 0x0
    buffer_load_dwordx4 v16, s[12:15], s70 offen lds
    s_add_u32 m0, s72, 1024
    s_add_u32 s70, s71, 0x1000
    buffer_load_dwordx4 v17, s[12:15], s70 offen lds
    s_add_u32 m0, s72, 2048
    s_add_u32 s70, s71, 0x2000
    buffer_load_dwordx4 v16, s[12:15], s70 offen lds
    s_add_u32 m0, s72, 3072
    s_add_u32 s70, s71, 0x3000
    buffer_load_dwordx4 v17, s[12:15], s70 offen lds
    s_add_u32 m0, s72, 4096
    s_add_u32 s70, s71, 0x4000
    buffer_load_dwordx4 v16, s[12:15], s70 offen lds
    s_add_u32 m0, s72, 5120
    s_add_u32 s70, s71, 0x5000
    buffer_load_dwordx4 v17, s[12:15], s70 offen lds
    s_add_u32 m0, s72, 6144
    s_add_u32 s70, s71, 0x6000
    buffer_load_dwordx4 v16, s[12:15], s70 offen lds
    s_add_u32 m0, s72, 7168
    s_add_u32 s70, s71, 0x7000
    buffer_load_dwordx4 v17, s[12:15], s70 offen lds
    s_add_u32 m0, s72, 32768
    s_add_u32 s70, s71, 0x20000
    buffer_load_dwordx4 v16, s[12:15], s70 offen lds
    s_add_u32 m0, s72, 33792
    s_add_u32 s70, s71, 0x21000
    buffer_load_dwordx4 v17, s[12:15], s70 offen lds
    s_add_u32 m0, s72, 34816
    s_add_u32 s70, s71, 0x22000
    buffer_load_dwordx4 v16, s[12:15], s70 offen lds
    s_add_u32 m0, s72, 35840
    s_add_u32 s70, s71, 0x23000
    buffer_load_dwordx4 v17, s[12:15], s70 offen lds
    s_add_u32 m0, s72, 36864
    s_add_u32 s70, s71, 0x24000
    buffer_load_dwordx4 v16, s[12:15], s70 offen lds
    s_add_u32 m0, s72, 37888
    s_add_u32 s70, s71, 0x25000
    buffer_load_dwordx4 v17, s[12:15], s70 offen lds
    s_add_u32 m0, s72, 38912
    s_add_u32 s70, s71, 0x26000
    buffer_load_dwordx4 v16, s[12:15], s70 offen lds
    s_add_u32 m0, s72, 39936
    s_add_u32 s70, s71, 0x27000
    buffer_load_dwordx4 v17, s[12:15], s70 offen lds
    s_add_u32 m0, s72, 65536
    s_add_u32 s70, s71, 0x40000
    buffer_load_dwordx4 v16, s[12:15], s70 offen lds
    s_add_u32 m0, s72, 66560
    s_add_u32 s70, s71, 0x41000
    buffer_load_dwordx4 v17, s[12:15], s70 offen lds
    s_add_u32 m0, s72, 67584
    s_add_u32 s70, s71, 0x42000
    buffer_load_dwordx4 v16, s[12:15], s70 offen lds
    s_add_u32 m0, s72, 68608
    s_add_u32 s70, s71, 0x43000
    buffer_load_dwordx4 v17, s[12:15], s70 offen lds
    s_add_u32 m0, s72, 69632
    s_add_u32 s70, s71, 0x44000
    buffer_load_dwordx4 v16, s[12:15], s70 offen lds
    s_add_u32 m0, s72, 70656
    s_add_u32 s70, s71, 0x45000
    buffer_load_dwordx4 v17, s[12:15], s70 offen lds
    s_add_u32 m0, s72, 71680
    s_add_u32 s70, s71, 0x46000
    buffer_load_dwordx4 v16, s[12:15], s70 offen lds
    s_add_u32 m0, s72, 72704
    s_add_u32 s70, s71, 0x47000
    buffer_load_dwordx4 v17, s[12:15], s70 offen lds
    s_add_u32 m0, s72, 98304
    s_add_u32 s70, s71, 0x60000
    buffer_load_dwordx4 v16, s[12:15], s70 offen lds
    s_add_u32 m0, s72, 99328
    s_add_u32 s70, s71, 0x61000
    buffer_load_dwordx4 v17, s[12:15], s70 offen lds
    s_add_u32 m0, s72, 100352
    s_add_u32 s70, s71, 0x62000
    buffer_load_dwordx4 v16, s[12:15], s70 offen lds
    s_add_u32 m0, s72, 101376
    s_add_u32 s70, s71, 0x63000
    buffer_load_dwordx4 v17, s[12:15], s70 offen lds
    s_add_u32 m0, s72, 102400
    s_add_u32 s70, s71, 0x64000
    buffer_load_dwordx4 v16, s[12:15], s70 offen lds
    s_add_u32 m0, s72, 103424
    s_add_u32 s70, s71, 0x65000
    buffer_load_dwordx4 v17, s[12:15], s70 offen lds
    s_add_u32 m0, s72, 104448
    s_add_u32 s70, s71, 0x66000
    buffer_load_dwordx4 v16, s[12:15], s70 offen lds
    s_add_u32 m0, s72, 105472
    s_add_u32 s70, s71, 0x67000
    buffer_load_dwordx4 v17, s[12:15], s70 offen lds
    v_lshl_add_u32 v7, v3, 2, v5
    v_and_b32 v8, 7, v7
    v_lshlrev_b32 v8, 5, v8
    v_lshl_or_b32 v8, v6, 3, v8
    s_lshl_b32 s70, s20, 6
    v_xor_b32 v8, s70, v8
    v_lshl_add_u32 v16, v7, 8, v8
    v_add_u32 v17, 0x10000, v16
    v_xor_b32 v22, 32, v16
    v_xor_b32 v23, 32, v17
    s_lshl_b32 s70, s20, 13
    s_add_u32 s70, s70, 0x10000
    v_mul_u32_u24 v7, 144, v4
    v_lshl_add_u32 v7, v3, 4, v7
    v_add_u32 v100, s70, v7
    v_lshrrev_b32 v7, 3, v2
    v_mul_u32_u24 v7, 144, v7
    v_and_b32 v8, 7, v2
    v_lshl_add_u32 v7, v8, 4, v7
    v_add_u32 v101, s70, v7
    s_waitcnt vmcnt(0)
    s_barrier
    ds_read_b64_tr_b16 a[0:1], v16 offset:0
    ds_read_b64_tr_b16 a[2:3], v16 offset:4096
    ds_read_b64_tr_b16 a[64:65], v22 offset:0
    ds_read_b64_tr_b16 a[66:67], v22 offset:4096
    ds_read_b64_tr_b16 a[4:5], v16 offset:8192
    ds_read_b64_tr_b16 a[6:7], v16 offset:12288
    ds_read_b64_tr_b16 a[68:69], v22 offset:8192
    ds_read_b64_tr_b16 a[70:71], v22 offset:12288
    ds_read_b64_tr_b16 a[8:9], v16 offset:16384
    ds_read_b64_tr_b16 a[10:11], v16 offset:20480
    ds_read_b64_tr_b16 a[72:73], v22 offset:16384
    ds_read_b64_tr_b16 a[74:75], v22 offset:20480
    ds_read_b64_tr_b16 a[12:13], v16 offset:24576
    ds_read_b64_tr_b16 a[14:15], v16 offset:28672
    ds_read_b64_tr_b16 a[76:77], v22 offset:24576
    ds_read_b64_tr_b16 a[78:79], v22 offset:28672
    ds_read_b64_tr_b16 a[16:17], v16 offset:32768
    ds_read_b64_tr_b16 a[18:19], v16 offset:36864
    ds_read_b64_tr_b16 a[80:81], v22 offset:32768
    ds_read_b64_tr_b16 a[82:83], v22 offset:36864
    ds_read_b64_tr_b16 a[20:21], v16 offset:40960
    ds_read_b64_tr_b16 a[22:23], v16 offset:45056
    ds_read_b64_tr_b16 a[84:85], v22 offset:40960
    ds_read_b64_tr_b16 a[86:87], v22 offset:45056
    ds_read_b64_tr_b16 a[24:25], v16 offset:49152
    ds_read_b64_tr_b16 a[26:27], v16 offset:53248
    ds_read_b64_tr_b16 a[88:89], v22 offset:49152
    ds_read_b64_tr_b16 a[90:91], v22 offset:53248
    ds_read_b64_tr_b16 a[28:29], v16 offset:57344
    ds_read_b64_tr_b16 a[30:31], v16 offset:61440
    ds_read_b64_tr_b16 a[92:93], v22 offset:57344
    ds_read_b64_tr_b16 a[94:95], v22 offset:61440
    ds_read_b64_tr_b16 a[32:33], v17 offset:0
    ds_read_b64_tr_b16 a[34:35], v17 offset:4096
    ds_read_b64_tr_b16 a[96:97], v23 offset:0
    ds_read_b64_tr_b16 a[98:99], v23 offset:4096
    ds_read_b64_tr_b16 a[36:37], v17 offset:8192
    ds_read_b64_tr_b16 a[38:39], v17 offset:12288
    ds_read_b64_tr_b16 a[100:101], v23 offset:8192
    ds_read_b64_tr_b16 a[102:103], v23 offset:12288
    ds_read_b64_tr_b16 a[40:41], v17 offset:16384
    ds_read_b64_tr_b16 a[42:43], v17 offset:20480
    ds_read_b64_tr_b16 a[104:105], v23 offset:16384
    ds_read_b64_tr_b16 a[106:107], v23 offset:20480
    ds_read_b64_tr_b16 a[44:45], v17 offset:24576
    ds_read_b64_tr_b16 a[46:47], v17 offset:28672
    ds_read_b64_tr_b16 a[108:109], v23 offset:24576
    ds_read_b64_tr_b16 a[110:111], v23 offset:28672
    ds_read_b64_tr_b16 a[48:49], v17 offset:32768
    ds_read_b64_tr_b16 a[50:51], v17 offset:36864
    ds_read_b64_tr_b16 a[112:113], v23 offset:32768
    ds_read_b64_tr_b16 a[114:115], v23 offset:36864
    ds_read_b64_tr_b16 a[52:53], v17 offset:40960
    ds_read_b64_tr_b16 a[54:55], v17 offset:45056
    ds_read_b64_tr_b16 a[116:117], v23 offset:40960
    ds_read_b64_tr_b16 a[118:119], v23 offset:45056
    ds_read_b64_tr_b16 a[56:57], v17 offset:49152
    ds_read_b64_tr_b16 a[58:59], v17 offset:53248
    ds_read_b64_tr_b16 a[120:121], v23 offset:49152
    ds_read_b64_tr_b16 a[122:123], v23 offset:53248
    ds_read_b64_tr_b16 a[60:61], v17 offset:57344
    ds_read_b64_tr_b16 a[62:63], v17 offset:61440
    ds_read_b64_tr_b16 a[124:125], v23 offset:57344
    ds_read_b64_tr_b16 a[126:127], v23 offset:61440
    s_lshr_b32 s70, s24, 2
    s_lshl_b32 s70, s70, 2
    s_add_u32 s70, s70, s20
    s_lshl_b32 s28, s70, 13
    s_add_u32 s28, s28, 0x4000000
    s_mov_b32 s27, 0
    s_lshl_b32 s70, s20, 13
    v_add_u32 v18, s70, v1
    v_mov_b32 v19, v1
    s_waitcnt lgkmcnt(0)
    s_barrier
    v_mov_b64 v[12:13], -1
    v_mov_b64 v[14:15], -1
    s_cmp_lg_u32 s20, 0
    s_cbranch_scc1 L_wd_45
    s_branch L_wf_46
L_wc_44:
    s_sleep 8
L_wf_46:
    buffer_load_dword v22, off, s[76:79], 0 offset:196 sc1
    buffer_load_dword v23, off, s[76:79], 0 offset:180 sc1
    s_add_u32 s31, s31, 1
    s_cmp_gt_u32 s31, 1048576
    s_cbranch_scc1 L_abort
    s_waitcnt vmcnt(0)
    v_add_u32 v22, v22, v23
    s_nop 0
    v_readfirstlane_b32 s70, v22
    s_cmp_lg_u32 s70, 128
    s_nop 2
    s_cbranch_scc1 L_wc_44
L_wd_45:
    s_barrier
    s_add_u32 s64, s28, 4096
    s_lshl_b32 s65, s20, 13
    s_add_u32 m0, s65, 0
    s_nop 0
    buffer_load_dwordx4 v1, s[4:7], s28 offen offset:0 sc1 lds
    buffer_load_dwordx4 v1, s[4:7], s28 offen offset:1024 sc1 lds
    buffer_load_dwordx4 v1, s[4:7], s28 offen offset:2048 sc1 lds
    buffer_load_dwordx4 v1, s[4:7], s28 offen offset:3072 sc1 lds
    s_add_u32 m0, s65, 4096
    s_nop 0
    buffer_load_dwordx4 v1, s[4:7], s64 offen offset:0 sc1 lds
    buffer_load_dwordx4 v1, s[4:7], s64 offen offset:1024 sc1 lds
    buffer_load_dwordx4 v1, s[4:7], s64 offen offset:2048 sc1 lds
    buffer_load_dwordx4 v1, s[4:7], s64 offen offset:3072 sc1 lds
    s_waitcnt vmcnt(0)
L_B_loop:
    s_waitcnt vmcnt(8)
    s_branch L_dc_50
L_da_47:
    s_add_u32 m0, s65, 0
    s_nop 0
    buffer_load_dwordx4 v1, s[4:7], s28 offen offset:0 sc1 lds
    buffer_load_dwordx4 v1, s[4:7], s28 offen offset:1024 sc1 lds
    buffer_load_dwordx4 v1, s[4:7], s28 offen offset:2048 sc1 lds
    buffer_load_dwordx4 v1, s[4:7], s28 offen offset:3072 sc1 lds
    s_add_u32 m0, s65, 4096
    s_nop 0
    buffer_load_dwordx4 v1, s[4:7], s64 offen offset:0 sc1 lds
    buffer_load_dwordx4 v1, s[4:7], s64 offen offset:1024 sc1 lds
    buffer_load_dwordx4 v1, s[4:7], s64 offen offset:2048 sc1 lds
    buffer_load_dwordx4 v1, s[4:7], s64 offen offset:3072 sc1 lds
    buffer_load_dwordx4 v[104:107], v1, s[4:7], s64 offen offset:3072 sc1
    s_add_u32 s31, s31, 1
    s_cmp_gt_u32 s31, 1048576
    s_cbranch_scc1 L_abort
    s_waitcnt vmcnt(0)
    v_max3_u32 v52, v104, v105, v106
    v_max_u32 v53, v52, v107
    v_cmp_eq_u32 vcc, -1, v53
    s_nop 0
    s_cbranch_vccnz L_da_47
L_dc_50:
    ds_read_b128 v[20:23], v18 offset:0
    ds_read_b128 v[24:27], v18 offset:1024
    ds_read_b128 v[28:31], v18 offset:2048
    ds_read_b128 v[32:35], v18 offset:3072
    ds_read_b128 v[36:39], v18 offset:4096
    ds_read_b128 v[40:43], v18 offset:5120
    ds_read_b128 v[44:47], v18 offset:6144
    ds_read_b128 v[48:51], v18 offset:7168
    s_waitcnt lgkmcnt(7)
    v_max3_u32 v52, v20, v21, v22
    s_waitcnt lgkmcnt(6)
    v_max3_u32 v53, v23, v24, v25
    s_waitcnt lgkmcnt(5)
    v_max3_u32 v54, v26, v27, v28
    v_max3_u32 v55, v29, v30, v31
    s_waitcnt lgkmcnt(4)
    v_max3_u32 v56, v32, v33, v34
    s_waitcnt lgkmcnt(3)
    v_max3_u32 v57, v35, v36, v37
    s_waitcnt lgkmcnt(2)
    v_max3_u32 v58, v38, v39, v40
    v_max3_u32 v59, v41, v42, v43
    s_waitcnt lgkmcnt(1)
    v_max3_u32 v60, v44, v45, v46
    s_waitcnt lgkmcnt(0)
    v_max3_u32 v61, v47, v48, v49
    v_max3_u32 v62, v52, v53, v54
    v_max3_u32 v63, v55, v56, v57
    v_max3_u32 v64, v58, v59, v60
    v_max3_u32 v65, v61, v50, v51
    v_max3_u32 v66, v62, v63, v64
    v_max_u32 v67, v66, v65
    v_cmp_eq_u32 vcc, -1, v67
    s_nop 0
    s_cbranch_vccz L_dk_48
    s_add_u32 s31, s31, 1
    s_cmp_gt_u32 s31, 1048576
    s_cbranch_scc1 L_abort
    s_cmp_ge_u32 s27, 54
    s_cbranch_scc1 L_da_47
L_di_49:
    s_sleep 6
    buffer_load_dwordx4 v[104:107], v1, s[4:7], s64 offen offset:3072 sc1
    s_add_u32 s31, s31, 1
    s_cmp_gt_u32 s31, 1048576
    s_cbranch_scc1 L_abort
    s_waitcnt vmcnt(0)
    v_max3_u32 v52, v104, v105, v106
    v_max_u32 v53, v52, v107
    v_cmp_eq_u32 vcc, -1, v53
    s_nop 0
    s_cbranch_vccnz L_di_49
    s_branch L_da_47
L_dk_48:
    s_barrier
    ds_read_b128 v[52:55], v19 offset:0
    ds_read_b128 v[56:59], v19 offset:4096
    s_add_u32 s28, s28, 0x40000
    s_add_u32 s64, s64, 0x40000
    s_xor_b32 s65, s65, 0x8000
    ds_read_b128 v[60:63], v19 offset:1024
    ds_read_b128 v[64:67], v19 offset:5120
    s_waitcnt lgkmcnt(3)
    v_mfma_f32_16x16x32_bf16 v[68:71], a[0:3], v[52:55], 0
    v_mfma_f32_16x16x32_bf16 v[72:75], a[64:67], v[52:55], 0
    s_waitcnt lgkmcnt(2)
    v_mfma_f32_16x16x32_bf16 v[76:79], a[0:3], v[56:59], 0
    v_mfma_f32_16x16x32_bf16 v[80:83], a[64:67], v[56:59], 0
    s_add_u32 m0, s65, 0
    s_nop 0
    buffer_load_dwordx4 v1, s[4:7], s28 offen offset:0 sc1 lds
    ds_read_b128 v[52:55], v19 offset:2048
    ds_read_b128 v[56:59], v19 offset:6144
    s_waitcnt lgkmcnt(3)
    v_mfma_f32_16x16x32_bf16 v[68:71], a[4:7], v[60:63], v[68:71]
    v_mfma_f32_16x16x32_bf16 v[72:75], a[68:71], v[60:63], v[72:75]
    s_waitcnt lgkmcnt(2)
    v_mfma_f32_16x16x32_bf16 v[76:79], a[4:7], v[64:67], v[76:79]
    v_mfma_f32_16x16x32_bf16 v[80:83], a[68:71], v[64:67], v[80:83]
    buffer_load_dwordx4 v1, s[4:7], s28 offen offset:1024 sc1 lds
    ds_read_b128 v[60:63], v19 offset:3072
    ds_read_b128 v[64:67], v19 offset:7168
    s_waitcnt lgkmcnt(3)
    v_mfma_f32_16x16x32_bf16 v[68:71], a[8:11], v[52:55], v[68:71]
    v_mfma_f32_16x16x32_bf16 v[72:75], a[72:75], v[52:55], v[72:75]
    s_waitcnt lgkmcnt(2)
    v_mfma_f32_16x16x32_bf16 v[76:79], a[8:11], v[56:59], v[76:79]
    v_mfma_f32_16x16x32_bf16 v[80:83], a[72:75], v[56:59], v[80:83]
    buffer_load_dwordx4 v1, s[4:7], s28 offen offset:2048 sc1 lds
    ds_read_b128 v[52:55], v19 offset:8192
    ds_read_b128 v[56:59], v19 offset:12288
    s_waitcnt lgkmcnt(3)
    v_mfma_f32_16x16x32_bf16 v[68:71], a[12:15], v[60:63], v[68:71]
    v_mfma_f32_16x16x32_bf16 v[72:75], a[76:79], v[60:63], v[72:75]
    s_waitcnt lgkmcnt(2)
    v_mfma_f32_16x16x32_bf16 v[76:79], a[12:15], v[64:67], v[76:79]
    v_mfma_f32_16x16x32_bf16 v[80:83], a[76:79], v[64:67], v[80:83]
    buffer_load_dwordx4 v1, s[4:7], s28 offen offset:3072 sc1 lds
    ds_read_b128 v[60:63], v19 offset:9216
    ds_read_b128 v[64:67], v19 offset:13312
    s_waitcnt lgkmcnt(3)
    v_mfma_f32_16x16x32_bf16 v[68:71], a[16:19], v[52:55], v[68:71]
    v_mfma_f32_16x16x32_bf16 v[72:75], a[80:83], v[52:55], v[72:75]
    s_waitcnt lgkmcnt(2)
    v_mfma_f32_16x16x32_bf16 v[76:79], a[16:19], v[56:59], v[76:79]
    v_mfma_f32_16x16x32_bf16 v[80:83], a[80:83], v[56:59], v[80:83]
    s_add_u32 m0, s65, 4096
    s_nop 0
    buffer_load_dwordx4 v1, s[4:7], s64 offen offset:0 sc1 lds
    ds_read_b128 v[52:55], v19 offset:10240
    ds_read_b128 v[56:59], v19 offset:14336
    s_waitcnt lgkmcnt(3)
    v_mfma_f32_16x16x32_bf16 v[68:71], a[20:23], v[60:63], v[68:71]
    v_mfma_f32_16x16x32_bf16 v[72:75], a[84:87], v[60:63], v[72:75]
    s_waitcnt lgkmcnt(2)
    v_mfma_f32_16x16x32_bf16 v[76:79], a[20:23], v[64:67], v[76:79]
    v_mfma_f32_16x16x32_bf16 v[80:83], a[84:87], v[64:67], v[80:83]
    buffer_load_dwordx4 v1, s[4:7], s64 offen offset:1024 sc1 lds
    ds_read_b128 v[60:63], v19 offset:11264
    ds_read_b128 v[64:67], v19 offset:15360
    s_waitcnt lgkmcnt(3)
    v_mfma_f32_16x16x32_bf16 v[68:71], a[24:27], v[52:55], v[68:71]
    v_mfma_f32_16x16x32_bf16 v[72:75], a[88:91], v[52:55], v[72:75]
    s_waitcnt lgkmcnt(2)
    v_mfma_f32_16x16x32_bf16 v[76:79], a[24:27], v[56:59], v[76:79]
    v_mfma_f32_16x16x32_bf16 v[80:83], a[88:91], v[56:59], v[80:83]
    buffer_load_dwordx4 v1, s[4:7], s64 offen offset:2048 sc1 lds
    ds_read_b128 v[52:55], v19 offset:16384
    ds_read_b128 v[56:59], v19 offset:20480
    s_waitcnt lgkmcnt(3)
    v_mfma_f32_16x16x32_bf16 v[68:71], a[28:31], v[60:63], v[68:71]
    v_mfma_f32_16x16x32_bf16 v[72:75], a[92:95], v[60:63], v[72:75]
    s_waitcnt lgkmcnt(2)
    v_mfma_f32_16x16x32_bf16 v[76:79], a[28:31], v[64:67], v[76:79]
    v_mfma_f32_16x16x32_bf16 v[80:83], a[92:95], v[64:67], v[80:83]
    buffer_load_dwordx4 v1, s[4:7], s64 offen offset:3072 sc1 lds
    ds_read_b128 v[60:63], v19 offset:17408
    ds_read_b128 v[64:67], v19 offset:21504
    s_waitcnt lgkmcnt(3)
    v_mfma_f32_16x16x32_bf16 v[68:71], a[32:35], v[52:55], v[68:71]
    v_mfma_f32_16x16x32_bf16 v[72:75], a[96:99], v[52:55], v[72:75]
    s_waitcnt lgkmcnt(2)
    v_mfma_f32_16x16x32_bf16 v[76:79], a[32:35], v[56:59], v[76:79]
    v_mfma_f32_16x16x32_bf16 v[80:83], a[96:99], v[56:59], v[80:83]
    s_add_u32 s71, s29, 0x200000
    buffer_store_dwordx4 v[12:15], v10, s[4:7], s71 offen sc1
    ds_read_b128 v[52:55], v19 offset:18432
    ds_read_b128 v[56:59], v19 offset:22528
    s_waitcnt lgkmcnt(3)
    v_mfma_f32_16x16x32_bf16 v[68:71], a[36:39], v[60:63], v[68:71]
    v_mfma_f32_16x16x32_bf16 v[72:75], a[100:103], v[60:63], v[72:75]
    s_waitcnt lgkmcnt(2)
    v_mfma_f32_16x16x32_bf16 v[76:79], a[36:39], v[64:67], v[76:79]
    v_mfma_f32_16x16x32_bf16 v[80:83], a[100:103], v[64:67], v[80:83]
    s_add_u32 s71, s29, 0x204000
    buffer_store_dwordx4 v[12:15], v10, s[4:7], s71 offen sc1
    ds_read_b128 v[60:63], v19 offset:19456
    ds_read_b128 v[64:67], v19 offset:23552
    s_waitcnt lgkmcnt(3)
    v_mfma_f32_16x16x32_bf16 v[68:71], a[40:43], v[52:55], v[68:71]
    v_mfma_f32_16x16x32_bf16 v[72:75], a[104:107], v[52:55], v[72:75]
    s_waitcnt lgkmcnt(2)
    v_mfma_f32_16x16x32_bf16 v[76:79], a[40:43], v[56:59], v[76:79]
    v_mfma_f32_16x16x32_bf16 v[80:83], a[104:107], v[56:59], v[80:83]
    s_add_u32 s71, s29, 0x208000
    buffer_store_dwordx4 v[12:15], v10, s[4:7], s71 offen sc1
    ds_read_b128 v[52:55], v19 offset:24576
    ds_read_b128 v[56:59], v19 offset:28672
    s_waitcnt lgkmcnt(3)
    v_mfma_f32_16x16x32_bf16 v[68:71], a[44:47], v[60:63], v[68:71]
    v_mfma_f32_16x16x32_bf16 v[72:75], a[108:111], v[60:63], v[72:75]
    s_waitcnt lgkmcnt(2)
    v_mfma_f32_16x16x32_bf16 v[76:79], a[44:47], v[64:67], v[76:79]
    v_mfma_f32_16x16x32_bf16 v[80:83], a[108:111], v[64:67], v[80:83]
    s_add_u32 s71, s29, 0x20c000
    buffer_store_dwordx4 v[12:15], v10, s[4:7], s71 offen sc1
    ds_read_b128 v[60:63], v19 offset:25600
    ds_read_b128 v[64:67], v19 offset:29696
    s_waitcnt lgkmcnt(3)
    v_mfma_f32_16x16x32_bf16 v[68:71], a[48:51], v[52:55], v[68:71]
    v_mfma_f32_16x16x32_bf16 v[72:75], a[112:115], v[52:55], v[72:75]
    s_waitcnt lgkmcnt(2)
    v_mfma_f32_16x16x32_bf16 v[76:79], a[48:51], v[56:59], v[76:79]
    v_mfma_f32_16x16x32_bf16 v[80:83], a[112:115], v[56:59], v[80:83]
    ds_read_b128 v[52:55], v19 offset:26624
    ds_read_b128 v[56:59], v19 offset:30720
    s_waitcnt lgkmcnt(3)
    v_mfma_f32_16x16x32_bf16 v[68:71], a[52:55], v[60:63], v[68:71]
    v_mfma_f32_16x16x32_bf16 v[72:75], a[116:119], v[60:63], v[72:75]
    s_waitcnt lgkmcnt(2)
    v_mfma_f32_16x16x32_bf16 v[76:79], a[52:55], v[64:67], v[76:79]
    v_mfma_f32_16x16x32_bf16 v[80:83], a[116:119], v[64:67], v[80:83]
    ds_read_b128 v[60:63], v19 offset:27648
    ds_read_b128 v[64:67], v19 offset:31744
    s_waitcnt lgkmcnt(3)
    v_mfma_f32_16x16x32_bf16 v[68:71], a[56:59], v[52:55], v[68:71]
    v_mfma_f32_16x16x32_bf16 v[72:75], a[120:123], v[52:55], v[72:75]
    s_waitcnt lgkmcnt(2)
    v_mfma_f32_16x16x32_bf16 v[76:79], a[56:59], v[56:59], v[76:79]
    v_mfma_f32_16x16x32_bf16 v[80:83], a[120:123], v[56:59], v[80:83]
    s_waitcnt lgkmcnt(1)
    v_mfma_f32_16x16x32_bf16 v[68:71], a[60:63], v[60:63], v[68:71]
    v_mfma_f32_16x16x32_bf16 v[72:75], a[124:127], v[60:63], v[72:75]
    s_waitcnt lgkmcnt(0)
    v_mfma_f32_16x16x32_bf16 v[76:79], a[60:63], v[64:67], v[76:79]
    v_mfma_f32_16x16x32_bf16 v[80:83], a[124:127], v[64:67], v[80:83]
    s_nop 3
    ds_write_b128 v100, v[68:71] offset:0
    ds_write_b128 v100, v[72:75] offset:64
    s_nop 0
    ds_write_b128 v100, v[76:79] offset:2304
    ds_write_b128 v100, v[80:83] offset:2368
    ds_read_b128 v[20:23], v101 offset:0
    ds_read_b128 v[24:27], v101 offset:1152
    ds_read_b128 v[28:31], v101 offset:2304
    ds_read_b128 v[32:35], v101 offset:3456
    s_add_u32 s70, s29, 0x0
    s_waitcnt lgkmcnt(3)
    buffer_store_dwordx4 v[20:23], v10, s[4:7], s70 offen sc1
    s_add_u32 s70, s29, 0x4000
    s_waitcnt lgkmcnt(2)
    buffer_store_dwordx4 v[24:27], v10, s[4:7], s70 offen sc1
    s_add_u32 s70, s29, 0x8000
    s_waitcnt lgkmcnt(1)
    buffer_store_dwordx4 v[28:31], v10, s[4:7], s70 offen sc1
    s_add_u32 s70, s29, 0xc000
    s_waitcnt lgkmcnt(0)
    buffer_store_dwordx4 v[32:35], v10, s[4:7], s70 offen sc1
    v_xor_b32 v18, 0x8000, v18
    v_xor_b32 v19, 0x8000, v19
    s_add_u32 s29, s29, 0x80000
    s_add_u32 s27, s27, 1
    s_cmp_lt_u32 s27, 64
    s_cbranch_scc1 L_B_loop
    s_endpgm
L_C_main:
    s_cmp_lg_u32 s20, 0
    s_cbranch_scc1 L_wd_52
    s_branch L_wf_53
L_wc_51:
    s_sleep 8
L_wf_53:
    buffer_load_dword v22, off, s[76:79], 0 offset:200 sc1
    buffer_load_dword v23, off, s[76:79], 0 offset:184 sc1
    s_add_u32 s31, s31, 1
    s_cmp_gt_u32 s31, 1048576
    s_cbranch_scc1 L_abort
    s_waitcnt vmcnt(0)
    v_add_u32 v22, v22, v23
    s_nop 0
    v_readfirstlane_b32 s70, v22
    s_cmp_lg_u32 s70, 64
    s_nop 2
    s_cbranch_scc1 L_wc_51
L_wd_52:
    s_barrier
    s_and_b32 s71, s20, 1
    s_lshl_b32 s71, s71, 3
    v_add_u32 v10, s71, v1
    s_sub_u32 s70, s24, 32
    s_lshr_b32 s71, s20, 1
    s_mul_i32 s71, s71, 43
    s_add_u32 s70, s70, s71
    s_lshl_b32 s29, s70, 10
    s_add_u32 s29, s29, 0x800000
    buffer_store_dwordx2 v[12:13], v10, s[4:7], s29 offen sc1
    s_add_u32 s70, s29, 88064
    buffer_store_dwordx2 v[12:13], v10, s[4:7], s70 offen sc1
    s_add_u32 s70, s70, 88064
    buffer_store_dwordx2 v[12:13], v10, s[4:7], s70 offen sc1
    s_waitcnt vmcnt(0)
    s_barrier
    s_cmp_lg_u32 s20, 0
    s_cbranch_scc1 L_ai_54
    s_and_b32 s23, s22, 2
    s_lshl_b32 s23, s23, 3
    s_add_u32 s23, s23, 176
    v_mov_b32 v20, s23
    v_mov_b32 v21, 1
    s_mov_b64 exec, 1
    buffer_atomic_add v21, v20, s[76:79], 0 offen offset:4
    s_mov_b64 exec, -1
L_ai_54:
    s_mov_b32 s12, s48
    s_and_b32 s13, s49, 0xffff
    s_mov_b32 s14, 0x158000
    s_mov_b32 s15, 0x20000
    s_mov_b32 s16, s50
    s_and_b32 s17, s51, 0xffff
    s_mov_b32 s18, 0x158000
    s_mov_b32 s19, 0x20000
    s_sub_u32 s72, s24, 32
    v_lshrrev_b32 v7, 2, v2
    v_mul_u32_u24 v7, 2752, v7
    v_lshrrev_b32 v8, 5, v2
    v_lshlrev_b32 v8, 1, v8
    v_xor_b32 v8, v8, v6
    v_lshl_add_u32 v16, v8, 4, v7
    s_lshl_b32 s72, s72, 6
    s_mul_i32 s70, s20, 352256
    s_add_u32 s72, s72, s70
    s_lshl_b32 s71, s20, 13
    s_add_u32 m0, s71, 0
    s_add_u32 s70, s72, 0x0
    buffer_load_dwordx4 v16, s[12:15], s70 offen lds
    s_add_u32 m0, s71, 1024
    s_add_u32 s70, s72, 0xac00
    buffer_load_dwordx4 v16, s[12:15], s70 offen lds
    s_add_u32 m0, s71, 2048
    s_add_u32 s70, s72, 0x15800
    buffer_load_dwordx4 v16, s[12:15], s70 offen lds
    s_add_u32 m0, s71, 3072
    s_add_u32 s70, s72, 0x20400
    buffer_load_dwordx4 v16, s[12:15], s70 offen lds
    s_add_u32 m0, s71, 4096
    s_add_u32 s70, s72, 0x2b000
    buffer_load_dwordx4 v16, s[12:15], s70 offen lds
    s_add_u32 m0, s71, 5120
    s_add_u32 s70, s72, 0x35c00
    buffer_load_dwordx4 v16, s[12:15], s70 offen lds
    s_add_u32 m0, s71, 6144
    s_add_u32 s70, s72, 0x40800
    buffer_load_dwordx4 v16, s[12:15], s70 offen lds
    s_add_u32 m0, s71, 7168
    s_add_u32 s70, s72, 0x4b400
    buffer_load_dwordx4 v16, s[12:15], s70 offen lds
    s_add_u32 m0, s71, 32768
    s_add_u32 s70, s72, 0x0
    buffer_load_dwordx4 v16, s[16:19], s70 offen lds
    s_add_u32 m0, s71, 33792
    s_add_u32 s70, s72, 0xac00
    buffer_load_dwordx4 v16, s[16:19], s70 offen lds
    s_add_u32 m0, s71, 34816
    s_add_u32 s70, s72, 0x15800
    buffer_load_dwordx4 v16, s[16:19], s70 offen lds
    s_add_u32 m0, s71, 35840
    s_add_u32 s70, s72, 0x20400
    buffer_load_dwordx4 v16, s[16:19], s70 offen lds
    s_add_u32 m0, s71, 36864
    s_add_u32 s70, s72, 0x2b000
    buffer_load_dwordx4 v16, s[16:19], s70 offen lds
    s_add_u32 m0, s71, 37888
    s_add_u32 s70, s72, 0x35c00
    buffer_load_dwordx4 v16, s[16:19], s70 offen lds
    s_add_u32 m0, s71, 38912
    s_add_u32 s70, s72, 0x40800
    buffer_load_dwordx4 v16, s[16:19], s70 offen lds
    s_add_u32 m0, s71, 39936
    s_add_u32 s70, s72, 0x4b400
    buffer_load_dwordx4 v16, s[16:19], s70 offen lds
    v_lshl_add_u32 v7, v3, 3, v5
    v_and_b32 v8, 1, v3
    s_and_b32 s70, s20, 1
    v_xor_b32 v8, s70, v8
    v_lshlrev_b32 v8, 5, v8
    v_lshl_or_b32 v8, v6, 3, v8
    v_lshl_add_u32 v16, v7, 6, v8
    s_lshr_b32 s70, s20, 1
    s_lshl_b32 s70, s70, 14
    s_add_u32 s70, s70, 0x10000
    v_xor_b32 v7, v3, v4
    v_lshlrev_b32 v7, 4, v7
    v_lshl_add_u32 v7, v4, 10, v7
    v_add_u32 v120, s70, v7
    v_xor_b32 v121, 64, v120
    v_xor_b32 v122, 128, v120
    v_xor_b32 v123, 192, v120
    s_lshl_b32 s70, s20, 13
    s_add_u32 s28, s70, 0x600000
    s_add_u32 s65, s70, 0x10000
    v_add_u32 v18, s65, v1
    s_and_b32 s70, s20, 1
    s_lshl_b32 s70, s70, 7
    v_xor_b32 v17, s70, v1
    s_mov_b32 s27, 0
    s_waitcnt vmcnt(0)
    s_barrier
    ds_read_b64_tr_b16 a[0:1], v16 offset:0
    ds_read_b64_tr_b16 a[2:3], v16 offset:256
    ds_read_b64_tr_b16 a[4:5], v16 offset:2048
    ds_read_b64_tr_b16 a[6:7], v16 offset:2304
    ds_read_b64_tr_b16 a[8:9], v16 offset:4096
    ds_read_b64_tr_b16 a[10:11], v16 offset:4352
    ds_read_b64_tr_b16 a[12:13], v16 offset:6144
    ds_read_b64_tr_b16 a[14:15], v16 offset:6400
    ds_read_b64_tr_b16 a[16:17], v16 offset:8192
    ds_read_b64_tr_b16 a[18:19], v16 offset:8448
    ds_read_b64_tr_b16 a[20:21], v16 offset:10240
    ds_read_b64_tr_b16 a[22:23], v16 offset:10496
    ds_read_b64_tr_b16 a[24:25], v16 offset:12288
    ds_read_b64_tr_b16 a[26:27], v16 offset:12544
    ds_read_b64_tr_b16 a[28:29], v16 offset:14336
    ds_read_b64_tr_b16 a[30:31], v16 offset:14592
    ds_read_b64_tr_b16 a[32:33], v16 offset:16384
    ds_read_b64_tr_b16 a[34:35], v16 offset:16640
    ds_read_b64_tr_b16 a[36:37], v16 offset:18432
    ds_read_b64_tr_b16 a[38:39], v16 offset:18688
    ds_read_b64_tr_b16 a[40:41], v16 offset:20480
    ds_read_b64_tr_b16 a[42:43], v16 offset:20736
    ds_read_b64_tr_b16 a[44:45], v16 offset:22528
    ds_read_b64_tr_b16 a[46:47], v16 offset:22784
    ds_read_b64_tr_b16 a[48:49], v16 offset:24576
    ds_read_b64_tr_b16 a[50:51], v16 offset:24832
    ds_read_b64_tr_b16 a[52:53], v16 offset:26624
    ds_read_b64_tr_b16 a[54:55], v16 offset:26880
    ds_read_b64_tr_b16 a[56:57], v16 offset:28672
    ds_read_b64_tr_b16 a[58:59], v16 offset:28928
    ds_read_b64_tr_b16 a[60:61], v16 offset:30720
    ds_read_b64_tr_b16 a[62:63], v16 offset:30976
    ds_read_b64_tr_b16 a[64:65], v16 offset:32768
    ds_read_b64_tr_b16 a[66:67], v16 offset:33024
    ds_read_b64_tr_b16 a[68:69], v16 offset:34816
    ds_read_b64_tr_b16 a[70:71], v16 offset:35072
    ds_read_b64_tr_b16 a[72:73], v16 offset:36864
    ds_read_b64_tr_b16 a[74:75], v16 offset:37120
    ds_read_b64_tr_b16 a[76:77], v16 offset:38912
    ds_read_b64_tr_b16 a[78:79], v16 offset:39168
    ds_read_b64_tr_b16 a[80:81], v16 offset:40960
    ds_read_b64_tr_b16 a[82:83], v16 offset:41216
    ds_read_b64_tr_b16 a[84:85], v16 offset:43008
    ds_read_b64_tr_b16 a[86:87], v16 offset:43264
    ds_read_b64_tr_b16 a[88:89], v16 offset:45056
    ds_read_b64_tr_b16 a[90:91], v16 offset:45312
    ds_read_b64_tr_b16 a[92:93], v16 offset:47104
    ds_read_b64_tr_b16 a[94:95], v16 offset:47360
    ds_read_b64_tr_b16 a[96:97], v16 offset:49152
    ds_read_b64_tr_b16 a[98:99], v16 offset:49408
    ds_read_b64_tr_b16 a[100:101], v16 offset:51200
    ds_read_b64_tr_b16 a[102:103], v16 offset:51456
    ds_read_b64_tr_b16 a[104:105], v16 offset:53248
    ds_read_b64_tr_b16 a[106:107], v16 offset:53504
    ds_read_b64_tr_b16 a[108:109], v16 offset:55296
    ds_read_b64_tr_b16 a[110:111], v16 offset:55552
    ds_read_b64_tr_b16 a[112:113], v16 offset:57344
    ds_read_b64_tr_b16 a[114:115], v16 offset:57600
    ds_read_b64_tr_b16 a[116:117], v16 offset:59392
    ds_read_b64_tr_b16 a[118:119], v16 offset:59648
    ds_read_b64_tr_b16 a[120:121], v16 offset:61440
    ds_read_b64_tr_b16 a[122:123], v16 offset:61696
    ds_read_b64_tr_b16 a[124:125], v16 offset:63488
    ds_read_b64_tr_b16 a[126:127], v16 offset:63744
    v_mov_b64 v[12:13], -1
    s_cmp_lg_u32 s20, 0
    s_cbranch_scc1 L_wd_56
    s_branch L_wf_57
L_wc_55:
    s_sleep 8
L_wf_57:
    buffer_load_dword v22, off, s[76:79], 0 offset:196 sc1
    buffer_load_dword v23, off, s[76:79], 0 offset:180 sc1
    s_add_u32 s31, s31, 1
    s_cmp_gt_u32 s31, 1048576
    s_cbranch_scc1 L_abort
    s_waitcnt vmcnt(0)
    v_add_u32 v22, v22, v23
    s_nop 0
    v_readfirstlane_b32 s70, v22
    s_cmp_lg_u32 s70, 128
    s_nop 2
    s_cbranch_scc1 L_wc_55
L_wd_56:
    s_barrier
    v_xor_b32 v124, 0, v17
    v_xor_b32 v125, 16, v17
    v_xor_b32 v126, 32, v17
    v_xor_b32 v127, 48, v17
    v_xor_b32 v128, 64, v17
    v_xor_b32 v129, 80, v17
    v_xor_b32 v130, 96, v17
    v_xor_b32 v131, 112, v17
    s_add_u32 s64, s28, 4096
    s_add_u32 m0, s65, 0
    s_nop 0
    buffer_load_dwordx4 v124, s[4:7], s28 offen offset:0 sc1 lds
    buffer_load_dwordx4 v125, s[4:7], s28 offen offset:1024 sc1 lds
    buffer_load_dwordx4 v126, s[4:7], s28 offen offset:2048 sc1 lds
    buffer_load_dwordx4 v127, s[4:7], s28 offen offset:3072 sc1 lds
    s_add_u32 m0, s65, 4096
    s_nop 0
    buffer_load_dwordx4 v128, s[4:7], s64 offen offset:0 sc1 lds
    buffer_load_dwordx4 v129, s[4:7], s64 offen offset:1024 sc1 lds
    buffer_load_dwordx4 v130, s[4:7], s64 offen offset:2048 sc1 lds
    buffer_load_dwordx4 v131, s[4:7], s64 offen offset:3072 sc1 lds
    s_waitcnt vmcnt(0) lgkmcnt(0)
L_C_loop:
    s_waitcnt vmcnt(2)
    s_branch L_dc_61
L_da_58:
    s_add_u32 m0, s65, 0
    s_nop 0
    buffer_load_dwordx4 v124, s[4:7], s28 offen offset:0 sc1 lds
    buffer_load_dwordx4 v125, s[4:7], s28 offen offset:1024 sc1 lds
    buffer_load_dwordx4 v126, s[4:7], s28 offen offset:2048 sc1 lds
    buffer_load_dwordx4 v127, s[4:7], s28 offen offset:3072 sc1 lds
    s_add_u32 m0, s65, 4096
    s_nop 0
    buffer_load_dwordx4 v128, s[4:7], s64 offen offset:0 sc1 lds
    buffer_load_dwordx4 v129, s[4:7], s64 offen offset:1024 sc1 lds
    buffer_load_dwordx4 v130, s[4:7], s64 offen offset:2048 sc1 lds
    buffer_load_dwordx4 v131, s[4:7], s64 offen offset:3072 sc1 lds
    buffer_load_dwordx4 v[104:107], v1, s[4:7], s64 offen offset:3072 sc1
    s_add_u32 s31, s31, 1
    s_cmp_gt_u32 s31, 1048576
    s_cbranch_scc1 L_abort
    s_waitcnt vmcnt(0)
    v_max3_u32 v52, v104, v105, v106
    v_max_u32 v53, v52, v107
    v_cmp_eq_u32 vcc, -1, v53
    s_nop 0
    s_cbranch_vccnz L_da_58
L_dc_61:
    ds_read_b128 v[20:23], v18 offset:0
    ds_read_b128 v[24:27], v18 offset:1024
    ds_read_b128 v[28:31], v18 offset:2048
    ds_read_b128 v[32:35], v18 offset:3072
    ds_read_b128 v[36:39], v18 offset:4096
    ds_read_b128 v[40:43], v18 offset:5120
    ds_read_b128 v[44:47], v18 offset:6144
    ds_read_b128 v[48:51], v18 offset:7168
    s_waitcnt lgkmcnt(7)
    v_max3_u32 v52, v20, v21, v22
    s_waitcnt lgkmcnt(6)
    v_max3_u32 v53, v23, v24, v25
    s_waitcnt lgkmcnt(5)
    v_max3_u32 v54, v26, v27, v28
    v_max3_u32 v55, v29, v30, v31
    s_waitcnt lgkmcnt(4)
    v_max3_u32 v56, v32, v33, v34
    s_waitcnt lgkmcnt(3)
    v_max3_u32 v57, v35, v36, v37
    s_waitcnt lgkmcnt(2)
    v_max3_u32 v58, v38, v39, v40
    v_max3_u32 v59, v41, v42, v43
    s_waitcnt lgkmcnt(1)
    v_max3_u32 v60, v44, v45, v46
    s_waitcnt lgkmcnt(0)
    v_max3_u32 v61, v47, v48, v49
    v_max3_u32 v62, v52, v53, v54
    v_max3_u32 v63, v55, v56, v57
    v_max3_u32 v64, v58, v59, v60
    v_max3_u32 v65, v61, v50, v51
    v_max3_u32 v66, v62, v63, v64
    v_max_u32 v67, v66, v65
    v_cmp_eq_u32 vcc, -1, v67
    s_nop 0
    s_cbranch_vccz L_dk_59
    s_add_u32 s31, s31, 1
    s_cmp_gt_u32 s31, 1048576
    s_cbranch_scc1 L_abort
    s_cmp_ge_u32 s27, 54
    s_cbranch_scc1 L_da_58
L_di_60:
    s_sleep 6
    buffer_load_dwordx4 v[104:107], v1, s[4:7], s64 offen offset:3072 sc1
    s_add_u32 s31, s31, 1
    s_cmp_gt_u32 s31, 1048576
    s_cbranch_scc1 L_abort
    s_waitcnt vmcnt(0)
    v_max3_u32 v52, v104, v105, v106
    v_max_u32 v53, v52, v107
    v_cmp_eq_u32 vcc, -1, v53
    s_nop 0
    s_cbranch_vccnz L_di_60
    s_branch L_da_58
L_dk_59:
    s_barrier
    ds_read_b128 v[20:23], v120 offset:0
    ds_read_b128 v[24:27], v121 offset:0
    ds_read_b128 v[28:31], v122 offset:0
    ds_read_b128 v[32:35], v123 offset:0
    ds_read_b128 v[36:39], v120 offset:256
    ds_read_b128 v[40:43], v121 offset:256
    s_add_u32 s28, s28, 32768
    s_add_u32 s64, s64, 32768
    s_xor_b32 s65, s65, 0x8000
    s_add_u32 s70, s29, 264192
    s_waitcnt lgkmcnt(5)
    v_mfma_f32_16x16x32_bf16 v[84:87], a[0:3], v[20:23], 0
    v_mfma_f32_16x16x32_bf16 v[88:91], a[64:67], v[20:23], 0
    ds_read_b128 v[44:47], v122 offset:256
    s_waitcnt lgkmcnt(5)
    v_mfma_f32_16x16x32_bf16 v[84:87], a[4:7], v[24:27], v[84:87]
    v_mfma_f32_16x16x32_bf16 v[88:91], a[68:71], v[24:27], v[88:91]
    ds_read_b128 v[48:51], v123 offset:256
    s_add_u32 m0, s65, 0
    s_nop 0
    buffer_load_dwordx4 v124, s[4:7], s28 offen offset:0 sc1 lds
    s_waitcnt lgkmcnt(5)
    v_mfma_f32_16x16x32_bf16 v[84:87], a[8:11], v[28:31], v[84:87]
    v_mfma_f32_16x16x32_bf16 v[88:91], a[72:75], v[28:31], v[88:91]
    ds_read_b128 v[20:23], v120 offset:512
    s_waitcnt lgkmcnt(5)
    v_mfma_f32_16x16x32_bf16 v[84:87], a[12:15], v[32:35], v[84:87]
    v_mfma_f32_16x16x32_bf16 v[88:91], a[76:79], v[32:35], v[88:91]
    ds_read_b128 v[24:27], v121 offset:512
    buffer_load_dwordx4 v125, s[4:7], s28 offen offset:1024 sc1 lds
    s_waitcnt lgkmcnt(5)
    v_mfma_f32_16x16x32_bf16 v[84:87], a[16:19], v[36:39], v[84:87]
    v_mfma_f32_16x16x32_bf16 v[88:91], a[80:83], v[36:39], v[88:91]
    ds_read_b128 v[28:31], v122 offset:512
    s_waitcnt lgkmcnt(5)
    v_mfma_f32_16x16x32_bf16 v[84:87], a[20:23], v[40:43], v[84:87]
    v_mfma_f32_16x16x32_bf16 v[88:91], a[84:87], v[40:43], v[88:91]
    ds_read_b128 v[32:35], v123 offset:512
    buffer_load_dwordx4 v126, s[4:7], s28 offen offset:2048 sc1 lds
    s_waitcnt lgkmcnt(5)
    v_mfma_f32_16x16x32_bf16 v[84:87], a[24:27], v[44:47], v[84:87]
    v_mfma_f32_16x16x32_bf16 v[88:91], a[88:91], v[44:47], v[88:91]
    ds_read_b128 v[36:39], v120 offset:768
    s_waitcnt lgkmcnt(5)
    v_mfma_f32_16x16x32_bf16 v[84:87], a[28:31], v[48:51], v[84:87]
    v_mfma_f32_16x16x32_bf16 v[88:91], a[92:95], v[48:51], v[88:91]
    ds_read_b128 v[40:43], v121 offset:768
    buffer_load_dwordx4 v127, s[4:7], s28 offen offset:3072 sc1 lds
    s_waitcnt lgkmcnt(5)
    v_mfma_f32_16x16x32_bf16 v[84:87], a[32:35], v[20:23], v[84:87]
    v_mfma_f32_16x16x32_bf16 v[88:91], a[96:99], v[20:23], v[88:91]
    ds_read_b128 v[44:47], v122 offset:768
    s_waitcnt lgkmcnt(5)
    v_mfma_f32_16x16x32_bf16 v[84:87], a[36:39], v[24:27], v[84:87]
    v_mfma_f32_16x16x32_bf16 v[88:91], a[100:103], v[24:27], v[88:91]
    ds_read_b128 v[48:51], v123 offset:768
    s_add_u32 m0, s65, 4096
    s_nop 0
    buffer_load_dwordx4 v128, s[4:7], s64 offen offset:0 sc1 lds
    s_waitcnt lgkmcnt(5)
    v_mfma_f32_16x16x32_bf16 v[84:87], a[40:43], v[28:31], v[84:87]
    v_mfma_f32_16x16x32_bf16 v[88:91], a[104:107], v[28:31], v[88:91]
    s_waitcnt lgkmcnt(4)
    v_mfma_f32_16x16x32_bf16 v[84:87], a[44:47], v[32:35], v[84:87]
    v_mfma_f32_16x16x32_bf16 v[88:91], a[108:111], v[32:35], v[88:91]
    buffer_load_dwordx4 v129, s[4:7], s64 offen offset:1024 sc1 lds
    s_waitcnt lgkmcnt(3)
    v_mfma_f32_16x16x32_bf16 v[84:87], a[48:51], v[36:39], v[84:87]
    v_mfma_f32_16x16x32_bf16 v[88:91], a[112:115], v[36:39], v[88:91]
    s_waitcnt lgkmcnt(2)
    v_mfma_f32_16x16x32_bf16 v[84:87], a[52:55], v[40:43], v[84:87]
    v_mfma_f32_16x16x32_bf16 v[88:91], a[116:119], v[40:43], v[88:91]
    buffer_load_dwordx4 v130, s[4:7], s64 offen offset:2048 sc1 lds
    s_waitcnt lgkmcnt(1)
    v_mfma_f32_16x16x32_bf16 v[84:87], a[56:59], v[44:47], v[84:87]
    v_mfma_f32_16x16x32_bf16 v[88:91], a[120:123], v[44:47], v[88:91]
    s_waitcnt lgkmcnt(0)
    v_mfma_f32_16x16x32_bf16 v[84:87], a[60:63], v[48:51], v[84:87]
    v_mfma_f32_16x16x32_bf16 v[88:91], a[124:127], v[48:51], v[88:91]
    buffer_load_dwordx4 v131, s[4:7], s64 offen offset:3072 sc1 lds
    buffer_store_dwordx2 v[12:13], v10, s[4:7], s70 offen sc1
    v_xor_b32 v18, 0x8000, v18
    v_xor_b32 v120, 0x8000, v120
    v_xor_b32 v121, 0x8000, v121
    v_xor_b32 v122, 0x8000, v122
    v_xor_b32 v123, 0x8000, v123
    s_add_u32 s27, s27, 1
    v_cvt_pk_bf16_f32 v92, v84, v85
    v_cvt_pk_bf16_f32 v93, v86, v87
    v_cvt_pk_bf16_f32 v94, v88, v89
    v_cvt_pk_bf16_f32 v95, v90, v91
    v_lshlrev_b32 v84, 16, v92
    v_and_b32 v85, 0xffff0000, v92
    v_lshlrev_b32 v86, 16, v93
    v_and_b32 v87, 0xffff0000, v93
    v_lshlrev_b32 v88, 16, v94
    v_and_b32 v89, 0xffff0000, v94
    v_lshlrev_b32 v90, 16, v95
    v_and_b32 v91, 0xffff0000, v95
    v_mul_f32 v92, v84, v84
    v_mul_f32 v93, v85, v85
    v_mul_f32 v94, v86, v86
    v_mul_f32 v95, v87, v87
    v_mov_b32 v96, 0xc0135761
    s_mov_b32 s71, 0xbdd2d3e8
    v_fma_f32 v92, v92, s71, v96
    v_fma_f32 v93, v93, s71, v96
    v_fma_f32 v94, v94, s71, v96
    v_fma_f32 v95, v95, s71, v96
    v_mul_f32 v92, v92, v84
    v_mul_f32 v93, v93, v85
    v_mul_f32 v94, v94, v86
    v_mul_f32 v95, v95, v87
    v_exp_f32 v92, v92
    v_exp_f32 v93, v93
    v_exp_f32 v94, v94
    v_exp_f32 v95, v95
    v_add_f32 v92, 1.0, v92
    v_add_f32 v93, 1.0, v93
    v_add_f32 v94, 1.0, v94
    v_add_f32 v95, 1.0, v95
    v_rcp_f32 v92, v92
    v_rcp_f32 v93, v93
    v_rcp_f32 v94, v94
    v_rcp_f32 v95, v95
    v_mul_f32 v84, v84, v92
    v_mul_f32 v85, v85, v93
    v_mul_f32 v86, v86, v94
    v_mul_f32 v87, v87, v95
    v_cvt_pk_bf16_f32 v92, v84, v85
    v_cvt_pk_bf16_f32 v93, v86, v87
    v_lshlrev_b32 v84, 16, v92
    v_and_b32 v85, 0xffff0000, v92
    v_lshlrev_b32 v86, 16, v93
    v_and_b32 v87, 0xffff0000, v93
    v_mul_f32 v84, v84, v88
    v_mul_f32 v85, v85, v89
    v_mul_f32 v86, v86, v90
    v_mul_f32 v87, v87, v91
    v_cvt_pk_bf16_f32 v92, v84, v85
    v_cvt_pk_bf16_f32 v93, v86, v87
    v_min_u32 v92, -2, v92
    v_min_u32 v93, -2, v93
    buffer_store_dwordx2 v[92:93], v10, s[4:7], s29 offen sc1
    s_add_u32 s29, s29, 88064
    s_cmp_lt_u32 s27, 64
    s_cbranch_scc1 L_C_loop
    s_endpgm
L_D_main:
    s_cmp_lg_u32 s20, 0
    s_cbranch_scc1 L_wd_63
    s_branch L_wf_64
L_wc_62:
    s_sleep 8
L_wf_64:
    buffer_load_dword v22, off, s[76:79], 0 offset:200 sc1
    buffer_load_dword v23, off, s[76:79], 0 offset:184 sc1
    s_add_u32 s31, s31, 1
    s_cmp_gt_u32 s31, 1048576
    s_cbranch_scc1 L_abort
    s_waitcnt vmcnt(0)
    v_add_u32 v22, v22, v23
    s_nop 0
    v_readfirstlane_b32 s70, v22
    s_cmp_lg_u32 s70, 64
    s_nop 2
    s_cbranch_scc1 L_wc_62
L_wd_63:
    s_barrier
    s_waitcnt vmcnt(0)
    s_barrier
    s_cmp_lg_u32 s20, 0
    s_cbranch_scc1 L_ai_65
    s_and_b32 s23, s22, 2
    s_lshl_b32 s23, s23, 3
    s_add_u32 s23, s23, 176
    v_mov_b32 v20, s23
    v_mov_b32 v21, 1
    s_mov_b64 exec, 1
    buffer_atomic_add v21, v20, s[76:79], 0 offen offset:4
    s_mov_b64 exec, -1
L_ai_65:
    s_mov_b32 s12, s52
    s_and_b32 s13, s53, 0xffff
    s_mov_b32 s14, 0x158000
    s_mov_b32 s15, 0x20000
    v_lshrrev_b32 v7, 2, v2
    v_lshlrev_b32 v8, 4, v6
    v_lshl_add_u32 v16, v7, 10, v8
    s_sub_u32 s72, s24, 75
    s_lshr_b32 s72, s72, 1
    s_lshl_b32 s72, s72, 6
    s_lshl_b32 s70, s20, 14
    s_add_u32 s72, s72, s70
    s_lshl_b32 s71, s20, 10
    s_add_u32 m0, s71, 0
    s_add_u32 s70, s72, 0x0
    buffer_load_dwordx4 v16, s[12:15], s70 offen lds
    s_add_u32 m0, s71, 4096
    s_add_u32 s70, s72, 0x10000
    buffer_load_dwordx4 v16, s[12:15], s70 offen lds
    s_add_u32 m0, s71, 8192
    s_add_u32 s70, s72, 0x20000
    buffer_load_dwordx4 v16, s[12:15], s70 offen lds
    s_add_u32 m0, s71, 12288
    s_add_u32 s70, s72, 0x30000
    buffer_load_dwordx4 v16, s[12:15], s70 offen lds
    s_add_u32 m0, s71, 16384
    s_add_u32 s70, s72, 0x40000
    buffer_load_dwordx4 v16, s[12:15], s70 offen lds
    s_add_u32 m0, s71, 20480
    s_add_u32 s70, s72, 0x50000
    buffer_load_dwordx4 v16, s[12:15], s70 offen lds
    s_add_u32 m0, s71, 24576
    s_add_u32 s70, s72, 0x60000
    buffer_load_dwordx4 v16, s[12:15], s70 offen lds
    s_add_u32 m0, s71, 28672
    s_add_u32 s70, s72, 0x70000
    buffer_load_dwordx4 v16, s[12:15], s70 offen lds
    s_add_u32 m0, s71, 32768
    s_add_u32 s70, s72, 0x80000
    buffer_load_dwordx4 v16, s[12:15], s70 offen lds
    s_add_u32 m0, s71, 36864
    s_add_u32 s70, s72, 0x90000
    buffer_load_dwordx4 v16, s[12:15], s70 offen lds
    s_add_u32 m0, s71, 40960
    s_add_u32 s70, s72, 0xa0000
    buffer_load_dwordx4 v16, s[12:15], s70 offen lds
    s_add_u32 m0, s71, 45056
    s_add_u32 s70, s72, 0xb0000
    buffer_load_dwordx4 v16, s[12:15], s70 offen lds
    s_add_u32 m0, s71, 49152
    s_add_u32 s70, s72, 0xc0000
    buffer_load_dwordx4 v16, s[12:15], s70 offen lds
    s_add_u32 m0, s71, 53248
    s_add_u32 s70, s72, 0xd0000
    buffer_load_dwordx4 v16, s[12:15], s70 offen lds
    s_add_u32 m0, s71, 57344
    s_add_u32 s70, s72, 0xe0000
    buffer_load_dwordx4 v16, s[12:15], s70 offen lds
    s_add_u32 m0, s71, 61440
    s_add_u32 s70, s72, 0xf0000
    buffer_load_dwordx4 v16, s[12:15], s70 offen lds
    s_add_u32 m0, s71, 65536
    s_add_u32 s70, s72, 0x100000
    buffer_load_dwordx4 v16, s[12:15], s70 offen lds
    s_add_u32 m0, s71, 69632
    s_add_u32 s70, s72, 0x110000
    buffer_load_dwordx4 v16, s[12:15], s70 offen lds
    s_add_u32 m0, s71, 73728
    s_add_u32 s70, s72, 0x120000
    buffer_load_dwordx4 v16, s[12:15], s70 offen lds
    s_add_u32 m0, s71, 77824
    s_add_u32 s70, s72, 0x130000
    buffer_load_dwordx4 v16, s[12:15], s70 offen lds
    s_add_u32 m0, s71, 81920
    s_add_u32 s70, s72, 0x140000
    buffer_load_dwordx4 v16, s[12:15], s70 offen lds
    s_add_u32 m0, s71, 86016
    s_add_u32 s70, s72, 0x150000
    buffer_load_dwordx4 v16, s[12:15], s70 offen lds
    s_mov_b32 s12, s58
    s_and_b32 s13, s59, 0xffff
    s_mov_b32 s14, 0x200000
    s_mov_b32 s15, 0x20000
    v_lshl_add_u32 v7, v3, 2, v5
    v_lshlrev_b32 v8, 4, v6
    v_lshl_add_u32 v7, v7, 6, v8
    s_mul_i32 s70, s20, 22528
    v_add_u32 v16, s70, v7
    s_sub_u32 s72, s24, 75
    s_and_b32 s70, s72, 1
    s_lshr_b32 s72, s72, 1
    s_mul_i32 s71, s70, 43
    s_mul_i32 s28, s20, 11
    s_add_u32 s28, s28, s71
    s_lshl_b32 s28, s28, 10
    s_add_u32 s28, s28, 0x800000
    s_lshl_b32 s29, s70, 14
    s_lshl_b32 s71, s72, 6
    s_add_u32 s29, s29, s71
    v_lshlrev_b32 v7, 4, v3
    v_lshl_add_u32 v17, v4, 10, v7
    v_lshlrev_b32 v7, 5, v3
    s_lshl_b32 s71, s72, 7
    v_add_u32 v7, s71, v7
    s_lshl_b32 s70, s20, 11
    s_add_u32 s70, s70, 98304
    v_add_u32 v18, s70, v1
    v_add_u32 v19, 98304, v1
    s_mov_b32 s27, 0
    s_cmp_lg_u32 s20, 0
    s_cbranch_scc1 L_wd_67
    s_branch L_wf_68
L_wc_66:
    s_sleep 8
L_wf_68:
    buffer_load_dword v22, off, s[76:79], 0 offset:196 sc1
    buffer_load_dword v23, off, s[76:79], 0 offset:180 sc1
    s_add_u32 s31, s31, 1
    s_cmp_gt_u32 s31, 1048576
    s_cbranch_scc1 L_abort
    s_waitcnt vmcnt(0)
    v_add_u32 v22, v22, v23
    s_nop 0
    v_readfirstlane_b32 s70, v22
    s_cmp_lg_u32 s70, 128
    s_nop 2
    s_cbranch_scc1 L_wc_66
L_wd_67:
    s_barrier
    s_mov_b32 s70, 0x112800
L_pa_69:
    buffer_load_dwordx4 v[128:131], v7, s[4:7], s70 offen offset:0 sc1
    buffer_load_dwordx4 v[132:135], v7, s[4:7], s70 offen offset:16 sc1
    s_waitcnt vmcnt(0)
L_pc_72:
    v_max3_u32 v120, v128, v129, v130
    v_max3_u32 v121, v131, v132, v133
    v_max3_u32 v122, v120, v121, v134
    v_max_u32 v123, v122, v135
    v_cmp_eq_u32 vcc, -1, v123
    s_nop 0
    s_cbranch_vccz L_pk_70
    s_add_u32 s31, s31, 1
    s_cmp_gt_u32 s31, 1048576
    s_cbranch_scc1 L_abort
L_pi_71:
    s_sleep 2
    buffer_load_dwordx4 v[132:135], v7, s[4:7], s70 offen offset:16 sc1
    s_add_u32 s31, s31, 1
    s_cmp_gt_u32 s31, 1048576
    s_cbranch_scc1 L_abort
    s_waitcnt vmcnt(0)
    v_max3_u32 v120, v132, v133, v134
    v_max_u32 v121, v120, v135
    v_cmp_eq_u32 vcc, -1, v121
    s_nop 0
    s_cbranch_vccnz L_pi_71
    s_branch L_pa_69
L_pk_70:
    s_barrier
    ds_read_b64_tr_b16 a[0:1], v16 offset:0
    ds_read_b64_tr_b16 a[2:3], v16 offset:1024
    ds_read_b64_tr_b16 a[44:45], v16 offset:8
    ds_read_b64_tr_b16 a[46:47], v16 offset:1032
    ds_read_b64_tr_b16 a[4:5], v16 offset:2048
    ds_read_b64_tr_b16 a[6:7], v16 offset:3072
    ds_read_b64_tr_b16 a[48:49], v16 offset:2056
    ds_read_b64_tr_b16 a[50:51], v16 offset:3080
    ds_read_b64_tr_b16 a[8:9], v16 offset:4096
    ds_read_b64_tr_b16 a[10:11], v16 offset:5120
    ds_read_b64_tr_b16 a[52:53], v16 offset:4104
    ds_read_b64_tr_b16 a[54:55], v16 offset:5128
    ds_read_b64_tr_b16 a[12:13], v16 offset:6144
    ds_read_b64_tr_b16 a[14:15], v16 offset:7168
    ds_read_b64_tr_b16 a[56:57], v16 offset:6152
    ds_read_b64_tr_b16 a[58:59], v16 offset:7176
    ds_read_b64_tr_b16 a[16:17], v16 offset:8192
    ds_read_b64_tr_b16 a[18:19], v16 offset:9216
    ds_read_b64_tr_b16 a[60:61], v16 offset:8200
    ds_read_b64_tr_b16 a[62:63], v16 offset:9224
    ds_read_b64_tr_b16 a[20:21], v16 offset:10240
    ds_read_b64_tr_b16 a[22:23], v16 offset:11264
    ds_read_b64_tr_b16 a[64:65], v16 offset:10248
    ds_read_b64_tr_b16 a[66:67], v16 offset:11272
    ds_read_b64_tr_b16 a[24:25], v16 offset:12288
    ds_read_b64_tr_b16 a[26:27], v16 offset:13312
    ds_read_b64_tr_b16 a[68:69], v16 offset:12296
    ds_read_b64_tr_b16 a[70:71], v16 offset:13320
    ds_read_b64_tr_b16 a[28:29], v16 offset:14336
    ds_read_b64_tr_b16 a[30:31], v16 offset:15360
    ds_read_b64_tr_b16 a[72:73], v16 offset:14344
    ds_read_b64_tr_b16 a[74:75], v16 offset:15368
    ds_read_b64_tr_b16 a[32:33], v16 offset:16384
    ds_read_b64_tr_b16 a[34:35], v16 offset:17408
    ds_read_b64_tr_b16 a[76:77], v16 offset:16392
    ds_read_b64_tr_b16 a[78:79], v16 offset:17416
    ds_read_b64_tr_b16 a[36:37], v16 offset:18432
    ds_read_b64_tr_b16 a[38:39], v16 offset:19456
    ds_read_b64_tr_b16 a[80:81], v16 offset:18440
    ds_read_b64_tr_b16 a[82:83], v16 offset:19464
    ds_read_b64_tr_b16 a[40:41], v16 offset:20480
    ds_read_b64_tr_b16 a[42:43], v16 offset:21504
    ds_read_b64_tr_b16 a[84:85], v16 offset:20488
    ds_read_b64_tr_b16 a[86:87], v16 offset:21512
    s_add_u32 s65, s29, 0x400000
    v_mov_b64 v[60:61], 0
    v_mov_b64 v[62:63], 0
    v_mov_b64 v[176:177], 0
    v_mov_b64 v[178:179], 0
    s_add_u32 s30, s28, 4096
    s_add_u32 s64, s28, 8192
    s_cmp_eq_u32 s20, 3
    s_cbranch_scc1 L_dw3_73
    buffer_load_dwordx4 v[60:63], v1, s[4:7], s64 offen offset:2048 sc1
L_dw3_73:
    buffer_load_dwordx4 v[124:127], v17, s[4:7], s65 offen sc1
    buffer_load_dwordx4 v[20:23], v1, s[4:7], s28 offen offset:0 sc1
    buffer_load_dwordx4 v[24:27], v1, s[4:7], s28 offen offset:1024 sc1
    buffer_load_dwordx4 v[28:31], v1, s[4:7], s28 offen offset:2048 sc1
    buffer_load_dwordx4 v[32:35], v1, s[4:7], s28 offen offset:3072 sc1
    buffer_load_dwordx4 v[36:39], v1, s[4:7], s30 offen offset:0 sc1
    buffer_load_dwordx4 v[40:43], v1, s[4:7], s30 offen offset:1024 sc1
    buffer_load_dwordx4 v[44:47], v1, s[4:7], s30 offen offset:2048 sc1
    buffer_load_dwordx4 v[48:51], v1, s[4:7], s30 offen offset:3072 sc1
    buffer_load_dwordx4 v[52:55], v1, s[4:7], s64 offen offset:0 sc1
    buffer_load_dwordx4 v[56:59], v1, s[4:7], s64 offen offset:1024 sc1
    s_waitcnt vmcnt(0) lgkmcnt(0)
L_D_loop:
    s_cmp_eq_u32 s20, 3
    s_cbranch_scc1 L_D_w3_74
    s_waitcnt vmcnt(0)
    s_branch L_pc_81
L_pa_78:
    buffer_load_dwordx4 v[124:127], v17, s[4:7], s65 offen sc1
    buffer_load_dwordx4 v[60:63], v1, s[4:7], s64 offen offset:2048 sc1
    buffer_load_dwordx4 v[20:23], v1, s[4:7], s28 offen offset:0 sc1
    buffer_load_dwordx4 v[24:27], v1, s[4:7], s28 offen offset:1024 sc1
    buffer_load_dwordx4 v[28:31], v1, s[4:7], s28 offen offset:2048 sc1
    buffer_load_dwordx4 v[32:35], v1, s[4:7], s28 offen offset:3072 sc1
    buffer_load_dwordx4 v[36:39], v1, s[4:7], s30 offen offset:0 sc1
    buffer_load_dwordx4 v[40:43], v1, s[4:7], s30 offen offset:1024 sc1
    buffer_load_dwordx4 v[44:47], v1, s[4:7], s30 offen offset:2048 sc1
    buffer_load_dwordx4 v[48:51], v1, s[4:7], s30 offen offset:3072 sc1
    buffer_load_dwordx4 v[52:55], v1, s[4:7], s64 offen offset:0 sc1
    buffer_load_dwordx4 v[56:59], v1, s[4:7], s64 offen offset:1024 sc1
    s_waitcnt vmcnt(0)
L_pc_81:
    v_max3_u32 v72, v20, v21, v22
    v_max3_u32 v73, v23, v24, v25
    v_max3_u32 v74, v26, v27, v28
    v_max3_u32 v75, v29, v30, v31
    v_max3_u32 v76, v32, v33, v34
    v_max3_u32 v77, v35, v36, v37
    v_max3_u32 v78, v38, v39, v40
    v_max3_u32 v79, v41, v42, v43
    v_max3_u32 v80, v44, v45, v46
    v_max3_u32 v81, v47, v48, v49
    v_max3_u32 v82, v50, v51, v52
    v_max3_u32 v83, v53, v54, v55
    v_max3_u32 v84, v56, v57, v58
    v_max3_u32 v85, v59, v60, v61
    v_max3_u32 v86, v72, v73, v74
    v_max3_u32 v87, v75, v76, v77
    v_max3_u32 v88, v78, v79, v80
    v_max3_u32 v89, v81, v82, v83
    v_max3_u32 v90, v84, v85, v62
    v_max3_u32 v91, v86, v87, v88
    v_max3_u32 v92, v89, v90, v63
    v_max_u32 v93, v91, v92
    v_cmp_eq_u32 vcc, -1, v93
    s_nop 0
    s_cbranch_vccz L_pk_79
    s_add_u32 s31, s31, 1
    s_cmp_gt_u32 s31, 1048576
    s_cbranch_scc1 L_abort
    s_cmp_ge_u32 s27, 54
    s_cbranch_scc1 L_pa_78
L_pi_80:
    s_sleep 6
    buffer_load_dwordx4 v[56:59], v1, s[4:7], s64 offen offset:1024 sc1
    s_add_u32 s31, s31, 1
    s_cmp_gt_u32 s31, 1048576
    s_cbranch_scc1 L_abort
    s_waitcnt vmcnt(0)
    v_max3_u32 v72, v56, v57, v58
    v_max_u32 v73, v72, v59
    v_cmp_eq_u32 vcc, -1, v73
    s_nop 0
    s_cbranch_vccnz L_pi_80
    s_branch L_pa_78
L_pk_79:
    s_branch L_D_mm_75
L_D_w3_74:
    s_waitcnt vmcnt(0)
    s_branch L_pc_85
L_pa_82:
    buffer_load_dwordx4 v[124:127], v17, s[4:7], s65 offen sc1
    buffer_load_dwordx4 v[20:23], v1, s[4:7], s28 offen offset:0 sc1
    buffer_load_dwordx4 v[24:27], v1, s[4:7], s28 offen offset:1024 sc1
    buffer_load_dwordx4 v[28:31], v1, s[4:7], s28 offen offset:2048 sc1
    buffer_load_dwordx4 v[32:35], v1, s[4:7], s28 offen offset:3072 sc1
    buffer_load_dwordx4 v[36:39], v1, s[4:7], s30 offen offset:0 sc1
    buffer_load_dwordx4 v[40:43], v1, s[4:7], s30 offen offset:1024 sc1
    buffer_load_dwordx4 v[44:47], v1, s[4:7], s30 offen offset:2048 sc1
    buffer_load_dwordx4 v[48:51], v1, s[4:7], s30 offen offset:3072 sc1
    buffer_load_dwordx4 v[52:55], v1, s[4:7], s64 offen offset:0 sc1
    buffer_load_dwordx4 v[56:59], v1, s[4:7], s64 offen offset:1024 sc1
    s_waitcnt vmcnt(0)
L_pc_85:
    v_max3_u32 v72, v20, v21, v22
    v_max3_u32 v73, v23, v24, v25
    v_max3_u32 v74, v26, v27, v28
    v_max3_u32 v75, v29, v30, v31
    v_max3_u32 v76, v32, v33, v34
    v_max3_u32 v77, v35, v36, v37
    v_max3_u32 v78, v38, v39, v40
    v_max3_u32 v79, v41, v42, v43
    v_max3_u32 v80, v44, v45, v46
    v_max3_u32 v81, v47, v48, v49
    v_max3_u32 v82, v50, v51, v52
    v_max3_u32 v83, v53, v54, v55
    v_max3_u32 v84, v56, v57, v58
    v_max3_u32 v85, v72, v73, v74
    v_max3_u32 v86, v75, v76, v77
    v_max3_u32 v87, v78, v79, v80
    v_max3_u32 v88, v81, v82, v83
    v_max3_u32 v89, v85, v86, v87
    v_max3_u32 v90, v88, v84, v59
    v_max_u32 v91, v89, v90
    v_cmp_eq_u32 vcc, -1, v91
    s_nop 0
    s_cbranch_vccz L_pk_83
    s_add_u32 s31, s31, 1
    s_cmp_gt_u32 s31, 1048576
    s_cbranch_scc1 L_abort
    s_cmp_ge_u32 s27, 54
    s_cbranch_scc1 L_pa_82
L_pi_84:
    s_sleep 6
    buffer_load_dwordx4 v[56:59], v1, s[4:7], s64 offen offset:1024 sc1
    s_add_u32 s31, s31, 1
    s_cmp_gt_u32 s31, 1048576
    s_cbranch_scc1 L_abort
    s_waitcnt vmcnt(0)
    v_max3_u32 v72, v56, v57, v58
    v_max_u32 v73, v72, v59
    v_cmp_eq_u32 vcc, -1, v73
    s_nop 0
    s_cbranch_vccnz L_pi_84
    s_branch L_pa_82
L_pk_83:
L_D_mm_75:
    v_mfma_f32_16x16x32_bf16 v[64:67], a[0:3], v[20:23], 0
    v_mfma_f32_16x16x32_bf16 v[68:71], a[44:47], v[20:23], 0
    v_mfma_f32_16x16x32_bf16 v[64:67], a[4:7], v[24:27], v[64:67]
    v_mfma_f32_16x16x32_bf16 v[68:71], a[48:51], v[24:27], v[68:71]
    v_mfma_f32_16x16x32_bf16 v[64:67], a[8:11], v[28:31], v[64:67]
    v_mfma_f32_16x16x32_bf16 v[68:71], a[52:55], v[28:31], v[68:71]
    v_mfma_f32_16x16x32_bf16 v[64:67], a[12:15], v[32:35], v[64:67]
    v_mfma_f32_16x16x32_bf16 v[68:71], a[56:59], v[32:35], v[68:71]
    v_mfma_f32_16x16x32_bf16 v[64:67], a[16:19], v[36:39], v[64:67]
    v_mfma_f32_16x16x32_bf16 v[68:71], a[60:63], v[36:39], v[68:71]
    v_mfma_f32_16x16x32_bf16 v[64:67], a[20:23], v[40:43], v[64:67]
    v_mfma_f32_16x16x32_bf16 v[68:71], a[64:67], v[40:43], v[68:71]
    v_mfma_f32_16x16x32_bf16 v[64:67], a[24:27], v[44:47], v[64:67]
    v_mfma_f32_16x16x32_bf16 v[68:71], a[68:71], v[44:47], v[68:71]
    v_mfma_f32_16x16x32_bf16 v[64:67], a[28:31], v[48:51], v[64:67]
    v_mfma_f32_16x16x32_bf16 v[68:71], a[72:75], v[48:51], v[68:71]
    v_mfma_f32_16x16x32_bf16 v[64:67], a[32:35], v[52:55], v[64:67]
    v_mfma_f32_16x16x32_bf16 v[68:71], a[76:79], v[52:55], v[68:71]
    v_mfma_f32_16x16x32_bf16 v[64:67], a[36:39], v[56:59], v[64:67]
    v_mfma_f32_16x16x32_bf16 v[68:71], a[80:83], v[56:59], v[68:71]
    v_mfma_f32_16x16x32_bf16 v[64:67], a[40:43], v[60:63], v[64:67]
    v_mfma_f32_16x16x32_bf16 v[68:71], a[84:87], v[60:63], v[68:71]
    s_add_u32 s28, s28, 88064
    s_add_u32 s30, s30, 88064
    s_add_u32 s64, s64, 88064
    s_and_b32 s72, s27, 3
    s_nop 2
    ds_write_b128 v18, v[64:67] offset:0
    ds_write_b128 v18, v[68:71] offset:1024
    s_cmp_lg_u32 s72, s20
    s_cbranch_scc1 L_D_nofin_76
    s_add_u32 s71, s29, 0x400000
    s_waitcnt vmcnt(0)
    s_branch L_pc_89
L_pa_86:
    buffer_load_dwordx4 v[124:127], v17, s[4:7], s71 offen sc1
    s_waitcnt vmcnt(0)
L_pc_89:
    v_max3_u32 v76, v124, v125, v126
    v_max_u32 v77, v76, v127
    v_cmp_eq_u32 vcc, -1, v77
    s_nop 0
    s_cbranch_vccz L_pk_87
    s_add_u32 s31, s31, 1
    s_cmp_gt_u32 s31, 1048576
    s_cbranch_scc1 L_abort
    s_cmp_eq_u32 0, 0
    s_cbranch_scc1 L_pa_86
L_pi_88:
    s_sleep 6
    buffer_load_dwordx4 v[124:127], v17, s[4:7], s71 offen sc1
    s_add_u32 s31, s31, 1
    s_cmp_gt_u32 s31, 1048576
    s_cbranch_scc1 L_abort
    s_waitcnt vmcnt(0)
    v_max3_u32 v76, v124, v125, v126
    v_max_u32 v77, v76, v127
    v_cmp_eq_u32 vcc, -1, v77
    s_nop 0
    s_cbranch_vccnz L_pi_88
    s_branch L_pa_86
L_pk_87:
    v_lshlrev_b32 v80, 16, v124
    v_and_b32 v81, 0xffff0000, v124
    v_lshlrev_b32 v82, 16, v125
    v_and_b32 v83, 0xffff0000, v125
    v_lshlrev_b32 v84, 16, v126
    v_and_b32 v85, 0xffff0000, v126
    v_lshlrev_b32 v86, 16, v127
    v_and_b32 v87, 0xffff0000, v127
    s_waitcnt lgkmcnt(0)
    s_barrier
    ds_read_b128 v[88:91], v19 offset:0
    ds_read_b128 v[92:95], v19 offset:1024
    ds_read_b128 v[96:99], v19 offset:2048
    ds_read_b128 v[100:103], v19 offset:3072
    ds_read_b128 v[104:107], v19 offset:4096
    ds_read_b128 v[108:111], v19 offset:5120
    ds_read_b128 v[112:115], v19 offset:6144
    ds_read_b128 v[116:119], v19 offset:7168
    s_waitcnt lgkmcnt(5)
    v_pk_add_f32 v[88:89], v[88:89], v[96:97]
    v_pk_add_f32 v[90:91], v[90:91], v[98:99]
    s_waitcnt lgkmcnt(4)
    v_pk_add_f32 v[92:93], v[92:93], v[100:101]
    v_pk_add_f32 v[94:95], v[94:95], v[102:103]
    s_waitcnt lgkmcnt(1)
    v_pk_add_f32 v[104:105], v[104:105], v[112:113]
    v_pk_add_f32 v[106:107], v[106:107], v[114:115]
    s_waitcnt lgkmcnt(0)
    v_pk_add_f32 v[108:109], v[108:109], v[116:117]
    v_pk_add_f32 v[110:111], v[110:111], v[118:119]
    v_pk_add_f32 v[88:89], v[88:89], v[104:105]
    v_pk_add_f32 v[90:91], v[90:91], v[106:107]
    v_pk_add_f32 v[92:93], v[92:93], v[108:109]
    v_pk_add_f32 v[94:95], v[94:95], v[110:111]
    v_cvt_pk_bf16_f32 v72, v88, v89
    v_cvt_pk_bf16_f32 v73, v90, v91
    v_cvt_pk_bf16_f32 v74, v92, v93
    v_cvt_pk_bf16_f32 v75, v94, v95
    v_lshlrev_b32 v88, 16, v72
    v_and_b32 v89, 0xffff0000, v72
    v_lshlrev_b32 v90, 16, v73
    v_and_b32 v91, 0xffff0000, v73
    v_lshlrev_b32 v92, 16, v74
    v_and_b32 v93, 0xffff0000, v74
    v_lshlrev_b32 v94, 16, v75
    v_and_b32 v95, 0xffff0000, v75
    v_pk_mul_f32 v[88:89], v[88:89], v[128:129]
    v_pk_mul_f32 v[90:91], v[90:91], v[130:131]
    v_pk_mul_f32 v[92:93], v[92:93], v[132:133]
    v_pk_mul_f32 v[94:95], v[94:95], v[134:135]
    v_cvt_pk_bf16_f32 v72, v88, v89
    v_cvt_pk_bf16_f32 v73, v90, v91
    v_cvt_pk_bf16_f32 v74, v92, v93
    v_cvt_pk_bf16_f32 v75, v94, v95
    v_lshlrev_b32 v88, 16, v72
    v_and_b32 v89, 0xffff0000, v72
    v_lshlrev_b32 v90, 16, v73
    v_and_b32 v91, 0xffff0000, v73
    v_lshlrev_b32 v92, 16, v74
    v_and_b32 v93, 0xffff0000, v74
    v_lshlrev_b32 v94, 16, v75
    v_and_b32 v95, 0xffff0000, v75
    v_pk_add_f32 v[88:89], v[88:89], v[80:81]
    v_pk_add_f32 v[90:91], v[90:91], v[82:83]
    v_pk_add_f32 v[92:93], v[92:93], v[84:85]
    v_pk_add_f32 v[94:95], v[94:95], v[86:87]
    v_cvt_pk_bf16_f32 v72, v88, v89
    v_cvt_pk_bf16_f32 v73, v90, v91
    v_cvt_pk_bf16_f32 v74, v92, v93
    v_cvt_pk_bf16_f32 v75, v94, v95
    buffer_store_dwordx4 v[72:75], v17, s[12:15], s29 offen
    s_nop 0
    s_branch L_D_next_77
L_D_nofin_76:
    s_waitcnt lgkmcnt(0)
    s_barrier
L_D_next_77:
    s_add_u32 s65, s65, 32768
    s_cmp_eq_u32 s20, 3
    s_cbranch_scc1 L_dw3_90
    buffer_load_dwordx4 v[176:179], v1, s[4:7], s64 offen offset:2048 sc1
L_dw3_90:
    buffer_load_dwordx4 v[124:127], v17, s[4:7], s65 offen sc1
    buffer_load_dwordx4 v[136:139], v1, s[4:7], s28 offen offset:0 sc1
    buffer_load_dwordx4 v[140:143], v1, s[4:7], s28 offen offset:1024 sc1
    buffer_load_dwordx4 v[144:147], v1, s[4:7], s28 offen offset:2048 sc1
    buffer_load_dwordx4 v[148:151], v1, s[4:7], s28 offen offset:3072 sc1
    buffer_load_dwordx4 v[152:155], v1, s[4:7], s30 offen offset:0 sc1
    buffer_load_dwordx4 v[156:159], v1, s[4:7], s30 offen offset:1024 sc1
    buffer_load_dwordx4 v[160:163], v1, s[4:7], s30 offen offset:2048 sc1
    buffer_load_dwordx4 v[164:167], v1, s[4:7], s30 offen offset:3072 sc1
    buffer_load_dwordx4 v[168:171], v1, s[4:7], s64 offen offset:0 sc1
    buffer_load_dwordx4 v[172:175], v1, s[4:7], s64 offen offset:1024 sc1
    s_add_u32 s29, s29, 32768
    s_add_u32 s27, s27, 1
    s_cmp_eq_u32 s20, 3
    s_cbranch_scc1 L_D_w3_91
    s_waitcnt vmcnt(0)
    s_branch L_pc_98
L_pa_95:
    buffer_load_dwordx4 v[124:127], v17, s[4:7], s65 offen sc1
    buffer_load_dwordx4 v[176:179], v1, s[4:7], s64 offen offset:2048 sc1
    buffer_load_dwordx4 v[136:139], v1, s[4:7], s28 offen offset:0 sc1
    buffer_load_dwordx4 v[140:143], v1, s[4:7], s28 offen offset:1024 sc1
    buffer_load_dwordx4 v[144:147], v1, s[4:7], s28 offen offset:2048 sc1
    buffer_load_dwordx4 v[148:151], v1, s[4:7], s28 offen offset:3072 sc1
    buffer_load_dwordx4 v[152:155], v1, s[4:7], s30 offen offset:0 sc1
    buffer_load_dwordx4 v[156:159], v1, s[4:7], s30 offen offset:1024 sc1
    buffer_load_dwordx4 v[160:163], v1, s[4:7], s30 offen offset:2048 sc1
    buffer_load_dwordx4 v[164:167], v1, s[4:7], s30 offen offset:3072 sc1
    buffer_load_dwordx4 v[168:171], v1, s[4:7], s64 offen offset:0 sc1
    buffer_load_dwordx4 v[172:175], v1, s[4:7], s64 offen offset:1024 sc1
    s_waitcnt vmcnt(0)
L_pc_98:
    v_max3_u32 v72, v136, v137, v138
    v_max3_u32 v73, v139, v140, v141
    v_max3_u32 v74, v142, v143, v144
    v_max3_u32 v75, v145, v146, v147
    v_max3_u32 v76, v148, v149, v150
    v_max3_u32 v77, v151, v152, v153
    v_max3_u32 v78, v154, v155, v156
    v_max3_u32 v79, v157, v158, v159
    v_max3_u32 v80, v160, v161, v162
    v_max3_u32 v81, v163, v164, v165
    v_max3_u32 v82, v166, v167, v168
    v_max3_u32 v83, v169, v170, v171
    v_max3_u32 v84, v172, v173, v174
    v_max3_u32 v85, v175, v176, v177
    v_max3_u32 v86, v72, v73, v74
    v_max3_u32 v87, v75, v76, v77
    v_max3_u32 v88, v78, v79, v80
    v_max3_u32 v89, v81, v82, v83
    v_max3_u32 v90, v84, v85, v178
    v_max3_u32 v91, v86, v87, v88
    v_max3_u32 v92, v89, v90, v179
    v_max_u32 v93, v91, v92
    v_cmp_eq_u32 vcc, -1, v93
    s_nop 0
    s_cbranch_vccz L_pk_96
    s_add_u32 s31, s31, 1
    s_cmp_gt_u32 s31, 1048576
    s_cbranch_scc1 L_abort
    s_cmp_ge_u32 s27, 54
    s_cbranch_scc1 L_pa_95
L_pi_97:
    s_sleep 6
    buffer_load_dwordx4 v[172:175], v1, s[4:7], s64 offen offset:1024 sc1
    s_add_u32 s31, s31, 1
    s_cmp_gt_u32 s31, 1048576
    s_cbranch_scc1 L_abort
    s_waitcnt vmcnt(0)
    v_max3_u32 v72, v172, v173, v174
    v_max_u32 v73, v72, v175
    v_cmp_eq_u32 vcc, -1, v73
    s_nop 0
    s_cbranch_vccnz L_pi_97
    s_branch L_pa_95
L_pk_96:
    s_branch L_D_mm_92
L_D_w3_91:
    s_waitcnt vmcnt(0)
    s_branch L_pc_102
L_pa_99:
    buffer_load_dwordx4 v[124:127], v17, s[4:7], s65 offen sc1
    buffer_load_dwordx4 v[136:139], v1, s[4:7], s28 offen offset:0 sc1
    buffer_load_dwordx4 v[140:143], v1, s[4:7], s28 offen offset:1024 sc1
    buffer_load_dwordx4 v[144:147], v1, s[4:7], s28 offen offset:2048 sc1
    buffer_load_dwordx4 v[148:151], v1, s[4:7], s28 offen offset:3072 sc1
    buffer_load_dwordx4 v[152:155], v1, s[4:7], s30 offen offset:0 sc1
    buffer_load_dwordx4 v[156:159], v1, s[4:7], s30 offen offset:1024 sc1
    buffer_load_dwordx4 v[160:163], v1, s[4:7], s30 offen offset:2048 sc1
    buffer_load_dwordx4 v[164:167], v1, s[4:7], s30 offen offset:3072 sc1
    buffer_load_dwordx4 v[168:171], v1, s[4:7], s64 offen offset:0 sc1
    buffer_load_dwordx4 v[172:175], v1, s[4:7], s64 offen offset:1024 sc1
    s_waitcnt vmcnt(0)
L_pc_102:
    v_max3_u32 v72, v136, v137, v138
    v_max3_u32 v73, v139, v140, v141
    v_max3_u32 v74, v142, v143, v144
    v_max3_u32 v75, v145, v146, v147
    v_max3_u32 v76, v148, v149, v150
    v_max3_u32 v77, v151, v152, v153
    v_max3_u32 v78, v154, v155, v156
    v_max3_u32 v79, v157, v158, v159
    v_max3_u32 v80, v160, v161, v162
    v_max3_u32 v81, v163, v164, v165
    v_max3_u32 v82, v166, v167, v168
    v_max3_u32 v83, v169, v170, v171
    v_max3_u32 v84, v172, v173, v174
    v_max3_u32 v85, v72, v73, v74
    v_max3_u32 v86, v75, v76, v77
    v_max3_u32 v87, v78, v79, v80
    v_max3_u32 v88, v81, v82, v83
    v_max3_u32 v89, v85, v86, v87
    v_max3_u32 v90, v88, v84, v175
    v_max_u32 v91, v89, v90
    v_cmp_eq_u32 vcc, -1, v91
    s_nop 0
    s_cbranch_vccz L_pk_100
    s_add_u32 s31, s31, 1
    s_cmp_gt_u32 s31, 1048576
    s_cbranch_scc1 L_abort
    s_cmp_ge_u32 s27, 54
    s_cbranch_scc1 L_pa_99
L_pi_101:
    s_sleep 6
    buffer_load_dwordx4 v[172:175], v1, s[4:7], s64 offen offset:1024 sc1
    s_add_u32 s31, s31, 1
    s_cmp_gt_u32 s31, 1048576
    s_cbranch_scc1 L_abort
    s_waitcnt vmcnt(0)
    v_max3_u32 v72, v172, v173, v174
    v_max_u32 v73, v72, v175
    v_cmp_eq_u32 vcc, -1, v73
    s_nop 0
    s_cbranch_vccnz L_pi_101
    s_branch L_pa_99
L_pk_100:
L_D_mm_92:
    v_mfma_f32_16x16x32_bf16 v[64:67], a[0:3], v[136:139], 0
    v_mfma_f32_16x16x32_bf16 v[68:71], a[44:47], v[136:139], 0
    v_mfma_f32_16x16x32_bf16 v[64:67], a[4:7], v[140:143], v[64:67]
    v_mfma_f32_16x16x32_bf16 v[68:71], a[48:51], v[140:143], v[68:71]
    v_mfma_f32_16x16x32_bf16 v[64:67], a[8:11], v[144:147], v[64:67]
    v_mfma_f32_16x16x32_bf16 v[68:71], a[52:55], v[144:147], v[68:71]
    v_mfma_f32_16x16x32_bf16 v[64:67], a[12:15], v[148:151], v[64:67]
    v_mfma_f32_16x16x32_bf16 v[68:71], a[56:59], v[148:151], v[68:71]
    v_mfma_f32_16x16x32_bf16 v[64:67], a[16:19], v[152:155], v[64:67]
    v_mfma_f32_16x16x32_bf16 v[68:71], a[60:63], v[152:155], v[68:71]
    v_mfma_f32_16x16x32_bf16 v[64:67], a[20:23], v[156:159], v[64:67]
    v_mfma_f32_16x16x32_bf16 v[68:71], a[64:67], v[156:159], v[68:71]
    v_mfma_f32_16x16x32_bf16 v[64:67], a[24:27], v[160:163], v[64:67]
    v_mfma_f32_16x16x32_bf16 v[68:71], a[68:71], v[160:163], v[68:71]
    v_mfma_f32_16x16x32_bf16 v[64:67], a[28:31], v[164:167], v[64:67]
    v_mfma_f32_16x16x32_bf16 v[68:71], a[72:75], v[164:167], v[68:71]
    v_mfma_f32_16x16x32_bf16 v[64:67], a[32:35], v[168:171], v[64:67]
    v_mfma_f32_16x16x32_bf16 v[68:71], a[76:79], v[168:171], v[68:71]
    v_mfma_f32_16x16x32_bf16 v[64:67], a[36:39], v[172:175], v[64:67]
    v_mfma_f32_16x16x32_bf16 v[68:71], a[80:83], v[172:175], v[68:71]
    v_mfma_f32_16x16x32_bf16 v[64:67], a[40:43], v[176:179], v[64:67]
    v_mfma_f32_16x16x32_bf16 v[68:71], a[84:87], v[176:179], v[68:71]
    s_add_u32 s28, s28, 88064
    s_add_u32 s30, s30, 88064
    s_add_u32 s64, s64, 88064
    s_and_b32 s72, s27, 3
    s_nop 2
    ds_write_b128 v18, v[64:67] offset:8192
    ds_write_b128 v18, v[68:71] offset:9216
    s_cmp_lg_u32 s72, s20
    s_cbranch_scc1 L_D_nofin_93
    s_add_u32 s71, s29, 0x400000
    s_waitcnt vmcnt(0)
    s_branch L_pc_106
L_pa_103:
    buffer_load_dwordx4 v[124:127], v17, s[4:7], s71 offen sc1
    s_waitcnt vmcnt(0)
L_pc_106:
    v_max3_u32 v76, v124, v125, v126
    v_max_u32 v77, v76, v127
    v_cmp_eq_u32 vcc, -1, v77
    s_nop 0
    s_cbranch_vccz L_pk_104
    s_add_u32 s31, s31, 1
    s_cmp_gt_u32 s31, 1048576
    s_cbranch_scc1 L_abort
    s_cmp_eq_u32 0, 0
    s_cbranch_scc1 L_pa_103
L_pi_105:
    s_sleep 6
    buffer_load_dwordx4 v[124:127], v17, s[4:7], s71 offen sc1
    s_add_u32 s31, s31, 1
    s_cmp_gt_u32 s31, 1048576
    s_cbranch_scc1 L_abort
    s_waitcnt vmcnt(0)
    v_max3_u32 v76, v124, v125, v126
    v_max_u32 v77, v76, v127
    v_cmp_eq_u32 vcc, -1, v77
    s_nop 0
    s_cbranch_vccnz L_pi_105
    s_branch L_pa_103
L_pk_104:
    v_lshlrev_b32 v80, 16, v124
    v_and_b32 v81, 0xffff0000, v124
    v_lshlrev_b32 v82, 16, v125
    v_and_b32 v83, 0xffff0000, v125
    v_lshlrev_b32 v84, 16, v126
    v_and_b32 v85, 0xffff0000, v126
    v_lshlrev_b32 v86, 16, v127
    v_and_b32 v87, 0xffff0000, v127
    s_waitcnt lgkmcnt(0)
    s_barrier
    ds_read_b128 v[88:91], v19 offset:8192
    ds_read_b128 v[92:95], v19 offset:9216
    ds_read_b128 v[96:99], v19 offset:10240
    ds_read_b128 v[100:103], v19 offset:11264
    ds_read_b128 v[104:107], v19 offset:12288
    ds_read_b128 v[108:111], v19 offset:13312
    ds_read_b128 v[112:115], v19 offset:14336
    ds_read_b128 v[116:119], v19 offset:15360
    s_waitcnt lgkmcnt(5)
    v_pk_add_f32 v[88:89], v[88:89], v[96:97]
    v_pk_add_f32 v[90:91], v[90:91], v[98:99]
    s_waitcnt lgkmcnt(4)
    v_pk_add_f32 v[92:93], v[92:93], v[100:101]
    v_pk_add_f32 v[94:95], v[94:95], v[102:103]
    s_waitcnt lgkmcnt(1)
    v_pk_add_f32 v[104:105], v[104:105], v[112:113]
    v_pk_add_f32 v[106:107], v[106:107], v[114:115]
    s_waitcnt lgkmcnt(0)
    v_pk_add_f32 v[108:109], v[108:109], v[116:117]
    v_pk_add_f32 v[110:111], v[110:111], v[118:119]
    v_pk_add_f32 v[88:89], v[88:89], v[104:105]
    v_pk_add_f32 v[90:91], v[90:91], v[106:107]
    v_pk_add_f32 v[92:93], v[92:93], v[108:109]
    v_pk_add_f32 v[94:95], v[94:95], v[110:111]
    v_cvt_pk_bf16_f32 v72, v88, v89
    v_cvt_pk_bf16_f32 v73, v90, v91
    v_cvt_pk_bf16_f32 v74, v92, v93
    v_cvt_pk_bf16_f32 v75, v94, v95
    v_lshlrev_b32 v88, 16, v72
    v_and_b32 v89, 0xffff0000, v72
    v_lshlrev_b32 v90, 16, v73
    v_and_b32 v91, 0xffff0000, v73
    v_lshlrev_b32 v92, 16, v74
    v_and_b32 v93, 0xffff0000, v74
    v_lshlrev_b32 v94, 16, v75
    v_and_b32 v95, 0xffff0000, v75
    v_pk_mul_f32 v[88:89], v[88:89], v[128:129]
    v_pk_mul_f32 v[90:91], v[90:91], v[130:131]
    v_pk_mul_f32 v[92:93], v[92:93], v[132:133]
    v_pk_mul_f32 v[94:95], v[94:95], v[134:135]
    v_cvt_pk_bf16_f32 v72, v88, v89
    v_cvt_pk_bf16_f32 v73, v90, v91
    v_cvt_pk_bf16_f32 v74, v92, v93
    v_cvt_pk_bf16_f32 v75, v94, v95
    v_lshlrev_b32 v88, 16, v72
    v_and_b32 v89, 0xffff0000, v72
    v_lshlrev_b32 v90, 16, v73
    v_and_b32 v91, 0xffff0000, v73
    v_lshlrev_b32 v92, 16, v74
    v_and_b32 v93, 0xffff0000, v74
    v_lshlrev_b32 v94, 16, v75
    v_and_b32 v95, 0xffff0000, v75
    v_pk_add_f32 v[88:89], v[88:89], v[80:81]
    v_pk_add_f32 v[90:91], v[90:91], v[82:83]
    v_pk_add_f32 v[92:93], v[92:93], v[84:85]
    v_pk_add_f32 v[94:95], v[94:95], v[86:87]
    v_cvt_pk_bf16_f32 v72, v88, v89
    v_cvt_pk_bf16_f32 v73, v90, v91
    v_cvt_pk_bf16_f32 v74, v92, v93
    v_cvt_pk_bf16_f32 v75, v94, v95
    buffer_store_dwordx4 v[72:75], v17, s[12:15], s29 offen
    s_nop 0
    s_branch L_D_next_94
L_D_nofin_93:
    s_waitcnt lgkmcnt(0)
    s_barrier
L_D_next_94:
    s_add_u32 s65, s65, 32768
    s_cmp_eq_u32 s20, 3
    s_cbranch_scc1 L_dw3_107
    buffer_load_dwordx4 v[60:63], v1, s[4:7], s64 offen offset:2048 sc1
L_dw3_107:
    buffer_load_dwordx4 v[124:127], v17, s[4:7], s65 offen sc1
    buffer_load_dwordx4 v[20:23], v1, s[4:7], s28 offen offset:0 sc1
    buffer_load_dwordx4 v[24:27], v1, s[4:7], s28 offen offset:1024 sc1
    buffer_load_dwordx4 v[28:31], v1, s[4:7], s28 offen offset:2048 sc1
    buffer_load_dwordx4 v[32:35], v1, s[4:7], s28 offen offset:3072 sc1
    buffer_load_dwordx4 v[36:39], v1, s[4:7], s30 offen offset:0 sc1
    buffer_load_dwordx4 v[40:43], v1, s[4:7], s30 offen offset:1024 sc1
    buffer_load_dwordx4 v[44:47], v1, s[4:7], s30 offen offset:2048 sc1
    buffer_load_dwordx4 v[48:51], v1, s[4:7], s30 offen offset:3072 sc1
    buffer_load_dwordx4 v[52:55], v1, s[4:7], s64 offen offset:0 sc1
    buffer_load_dwordx4 v[56:59], v1, s[4:7], s64 offen offset:1024 sc1
    s_add_u32 s29, s29, 32768
    s_add_u32 s27, s27, 1
    s_cmp_lt_u32 s27, 64
    s_cbranch_scc1 L_D_loop
    s_endpgm
L_R_main:
    s_cmp_lg_u32 s20, 0
    s_cbranch_scc1 L_wd_109
    s_branch L_wf_110
L_wc_108:
    s_sleep 8
L_wf_110:
    buffer_load_dword v22, off, s[76:79], 0 offset:200 sc1
    buffer_load_dword v23, off, s[76:79], 0 offset:184 sc1
    s_add_u32 s31, s31, 1
    s_cmp_gt_u32 s31, 1048576
    s_cbranch_scc1 L_abort
    s_waitcnt vmcnt(0)
    v_add_u32 v22, v22, v23
    s_nop 0
    v_readfirstlane_b32 s70, v22
    s_cmp_lg_u32 s70, 64
    s_nop 2
    s_cbranch_scc1 L_wc_108
L_wd_109:
    s_barrier
    s_sub_u32 s70, s24, 107
    s_lshl_b32 s70, s70, 2
    s_add_u32 s70, s70, s20
    s_lshr_b32 s27, s70, 5
    s_lshl_b32 s28, s70, 10
    s_lshl_b32 s29, s27, 19
    s_and_b32 s70, s70, 31
    s_lshl_b32 s70, s70, 11
    s_add_u32 s29, s29, s70
    s_add_u32 s29, s29, 0x5000000
    s_add_u32 s70, s28, 0x400000
    buffer_store_dwordx4 v[12:15], v1, s[4:7], s70 offen sc1
    s_add_u32 s70, s28, 0x600000
    buffer_store_dwordx4 v[12:15], v1, s[4:7], s70 offen sc1
    s_add_u32 s70, s28, 0x410000
    buffer_store_dwordx4 v[12:15], v1, s[4:7], s70 offen sc1
    s_add_u32 s70, s28, 0x610000
    buffer_store_dwordx4 v[12:15], v1, s[4:7], s70 offen sc1
    s_waitcnt vmcnt(0)
    s_barrier
    s_cmp_lg_u32 s20, 0
    s_cbranch_scc1 L_ai_111
    s_and_b32 s23, s22, 2
    s_lshl_b32 s23, s23, 3
    s_add_u32 s23, s23, 176
    v_mov_b32 v20, s23
    v_mov_b32 v21, 1
    s_mov_b64 exec, 1
    buffer_atomic_add v21, v20, s[76:79], 0 offen offset:4
    s_mov_b64 exec, -1
L_ai_111:
    s_mov_b32 s8, s32
    s_and_b32 s9, s33, 0xffff
    s_mov_b32 s10, 0x200000
    s_mov_b32 s11, 0x20000
    v_lshlrev_b32 v10, 3, v2
    s_cmp_lg_u32 s20, 0
    s_cbranch_scc1 L_wd_113
    s_branch L_wf_114
L_wc_112:
    s_sleep 8
L_wf_114:
    buffer_load_dword v22, off, s[76:79], 0 offset:196 sc1
    buffer_load_dword v23, off, s[76:79], 0 offset:180 sc1
    s_add_u32 s31, s31, 1
    s_cmp_gt_u32 s31, 1048576
    s_cbranch_scc1 L_abort
    s_waitcnt vmcnt(0)
    v_add_u32 v22, v22, v23
    s_nop 0
    v_readfirstlane_b32 s70, v22
    s_cmp_lg_u32 s70, 128
    s_nop 2
    s_cbranch_scc1 L_wc_112
L_wd_113:
    s_barrier
    s_mov_b32 s70, 0x111000
L_pa_115:
    buffer_load_dwordx4 v[96:99], v1, s[4:7], s70 offen offset:0 sc1
    buffer_load_dwordx4 v[100:103], v1, s[4:7], s70 offen offset:1024 sc1
    s_waitcnt vmcnt(0)
L_pc_118:
    v_max3_u32 v120, v96, v97, v98
    v_max3_u32 v121, v99, v100, v101
    v_max3_u32 v122, v120, v121, v102
    v_max_u32 v123, v122, v103
    v_cmp_eq_u32 vcc, -1, v123
    s_nop 0
    s_cbranch_vccz L_pk_116
    s_add_u32 s31, s31, 1
    s_cmp_gt_u32 s31, 1048576
    s_cbranch_scc1 L_abort
L_pi_117:
    s_sleep 2
    buffer_load_dwordx4 v[100:103], v1, s[4:7], s70 offen offset:1024 sc1
    s_add_u32 s31, s31, 1
    s_cmp_gt_u32 s31, 1048576
    s_cbranch_scc1 L_abort
    s_waitcnt vmcnt(0)
    v_max3_u32 v120, v100, v101, v102
    v_max_u32 v121, v120, v103
    v_cmp_eq_u32 vcc, -1, v121
    s_nop 0
    s_cbranch_vccnz L_pi_117
    s_branch L_pa_115
L_pk_116:
    s_mov_b32 s70, 0x111800
L_pa_119:
    buffer_load_dwordx4 v[104:107], v1, s[4:7], s70 offen offset:0 sc1
    buffer_load_dwordx4 v[108:111], v1, s[4:7], s70 offen offset:1024 sc1
    s_waitcnt vmcnt(0)
L_pc_122:
    v_max3_u32 v120, v104, v105, v106
    v_max3_u32 v121, v107, v108, v109
    v_max3_u32 v122, v120, v121, v110
    v_max_u32 v123, v122, v111
    v_cmp_eq_u32 vcc, -1, v123
    s_nop 0
    s_cbranch_vccz L_pk_120
    s_add_u32 s31, s31, 1
    s_cmp_gt_u32 s31, 1048576
    s_cbranch_scc1 L_abort
L_pi_121:
    s_sleep 2
    buffer_load_dwordx4 v[108:111], v1, s[4:7], s70 offen offset:1024 sc1
    s_add_u32 s31, s31, 1
    s_cmp_gt_u32 s31, 1048576
    s_cbranch_scc1 L_abort
    s_waitcnt vmcnt(0)
    v_max3_u32 v120, v108, v109, v110
    v_max_u32 v121, v120, v111
    v_cmp_eq_u32 vcc, -1, v121
    s_nop 0
    s_cbranch_vccnz L_pi_121
    s_branch L_pa_119
L_pk_120:
    s_mov_b32 s70, 0x112000
L_pa_123:
    buffer_load_dwordx4 v[112:115], v1, s[4:7], s70 offen offset:0 sc1
    buffer_load_dwordx4 v[116:119], v1, s[4:7], s70 offen offset:1024 sc1
    s_waitcnt vmcnt(0)
L_pc_126:
    v_max3_u32 v120, v112, v113, v114
    v_max3_u32 v121, v115, v116, v117
    v_max3_u32 v122, v120, v121, v118
    v_max_u32 v123, v122, v119
    v_cmp_eq_u32 vcc, -1, v123
    s_nop 0
    s_cbranch_vccz L_pk_124
    s_add_u32 s31, s31, 1
    s_cmp_gt_u32 s31, 1048576
    s_cbranch_scc1 L_abort
L_pi_125:
    s_sleep 2
    buffer_load_dwordx4 v[116:119], v1, s[4:7], s70 offen offset:1024 sc1
    s_add_u32 s31, s31, 1
    s_cmp_gt_u32 s31, 1048576
    s_cbranch_scc1 L_abort
    s_waitcnt vmcnt(0)
    v_max3_u32 v120, v116, v117, v118
    v_max_u32 v121, v120, v119
    v_cmp_eq_u32 vcc, -1, v121
    s_nop 0
    s_cbranch_vccnz L_pi_125
    s_branch L_pa_123
L_pk_124:
    v_add_f32 v112, 1.0, v112
    v_add_f32 v113, 1.0, v113
    v_add_f32 v114, 1.0, v114
    v_add_f32 v115, 1.0, v115
    v_add_f32 v116, 1.0, v116
    v_add_f32 v117, 1.0, v117
    v_add_f32 v118, 1.0, v118
    v_add_f32 v119, 1.0, v119
    v_cvt_pk_bf16_f32 v120, v112, v113
    v_cvt_pk_bf16_f32 v121, v114, v115
    v_cvt_pk_bf16_f32 v122, v116, v117
    v_cvt_pk_bf16_f32 v123, v118, v119
    v_lshlrev_b32 v112, 16, v120
    v_and_b32 v113, 0xffff0000, v120
    v_lshlrev_b32 v114, 16, v121
    v_and_b32 v115, 0xffff0000, v121
    v_lshlrev_b32 v116, 16, v122
    v_and_b32 v117, 0xffff0000, v122
    v_lshlrev_b32 v118, 16, v123
    v_and_b32 v119, 0xffff0000, v123
    v_mov_b64 v[12:13], -1
    v_mov_b64 v[14:15], -1
L_R_loop:
    buffer_load_dwordx2 v[28:29], v10, s[8:11], s28 offen offset:0
    buffer_load_dwordx2 v[30:31], v10, s[8:11], s28 offen offset:512
    s_add_u32 s81, s29, 0x10000
    s_add_u32 s82, s29, 0x20000
    s_add_u32 s83, s29, 0x30000
    s_add_u32 s84, s29, 0x40000
    s_add_u32 s85, s29, 0x50000
    s_add_u32 s86, s29, 0x60000
    s_add_u32 s87, s29, 0x70000
    s_waitcnt vmcnt(1)
    v_lshlrev_b32 v20, 16, v28
    v_and_b32 v21, 0xffff0000, v28
    v_lshlrev_b32 v22, 16, v29
    v_and_b32 v23, 0xffff0000, v29
    s_waitcnt vmcnt(0)
    v_lshlrev_b32 v24, 16, v30
    v_and_b32 v25, 0xffff0000, v30
    v_lshlrev_b32 v26, 16, v31
    v_and_b32 v27, 0xffff0000, v31
L_pa_127:
    buffer_load_dwordx4 v[128:131], v1, s[4:7], s29 offen offset:0 sc1
    buffer_load_dwordx4 v[132:135], v1, s[4:7], s29 offen offset:1024 sc1
    buffer_load_dwordx4 v[136:139], v1, s[4:7], s81 offen offset:0 sc1
    buffer_load_dwordx4 v[140:143], v1, s[4:7], s81 offen offset:1024 sc1
    buffer_load_dwordx4 v[144:147], v1, s[4:7], s82 offen offset:0 sc1
    buffer_load_dwordx4 v[148:151], v1, s[4:7], s82 offen offset:1024 sc1
    buffer_load_dwordx4 v[152:155], v1, s[4:7], s83 offen offset:0 sc1
    buffer_load_dwordx4 v[156:159], v1, s[4:7], s83 offen offset:1024 sc1
    buffer_load_dwordx4 v[160:163], v1, s[4:7], s84 offen offset:0 sc1
    buffer_load_dwordx4 v[164:167], v1, s[4:7], s84 offen offset:1024 sc1
    buffer_load_dwordx4 v[168:171], v1, s[4:7], s85 offen offset:0 sc1
    buffer_load_dwordx4 v[172:175], v1, s[4:7], s85 offen offset:1024 sc1
    buffer_load_dwordx4 v[176:179], v1, s[4:7], s86 offen offset:0 sc1
    buffer_load_dwordx4 v[180:183], v1, s[4:7], s86 offen offset:1024 sc1
    buffer_load_dwordx4 v[184:187], v1, s[4:7], s87 offen offset:0 sc1
    buffer_load_dwordx4 v[188:191], v1, s[4:7], s87 offen offset:1024 sc1
    s_waitcnt vmcnt(0)
L_pc_130:
    v_max3_u32 v40, v128, v129, v130
    v_max3_u32 v41, v131, v132, v133
    v_max3_u32 v42, v134, v135, v136
    v_max3_u32 v43, v137, v138, v139
    v_max3_u32 v44, v140, v141, v142
    v_max3_u32 v45, v143, v144, v145
    v_max3_u32 v46, v146, v147, v148
    v_max3_u32 v47, v149, v150, v151
    v_max3_u32 v48, v152, v153, v154
    v_max3_u32 v49, v155, v156, v157
    v_max3_u32 v50, v158, v159, v160
    v_max3_u32 v51, v161, v162, v163
    v_max3_u32 v52, v164, v165, v166
    v_max3_u32 v53, v167, v168, v169
    v_max3_u32 v54, v170, v171, v172
    v_max3_u32 v55, v173, v174, v175
    v_max3_u32 v56, v176, v177, v178
    v_max3_u32 v57, v179, v180, v181
    v_max3_u32 v58, v182, v183, v184
    v_max3_u32 v59, v185, v186, v187
    v_max3_u32 v60, v188, v189, v190
    v_max3_u32 v61, v40, v41, v42
    v_max3_u32 v62, v43, v44, v45
    v_max3_u32 v63, v46, v47, v48
    v_max3_u32 v64, v49, v50, v51
    v_max3_u32 v65, v52, v53, v54
    v_max3_u32 v66, v55, v56, v57
    v_max3_u32 v67, v58, v59, v60
    v_max3_u32 v68, v61, v62, v63
    v_max3_u32 v69, v64, v65, v66
    v_max3_u32 v70, v68, v69, v67
    v_max_u32 v71, v70, v191
    v_cmp_eq_u32 vcc, -1, v71
    s_nop 0
    s_cbranch_vccz L_pk_128
    s_add_u32 s31, s31, 1
    s_cmp_gt_u32 s31, 1048576
    s_cbranch_scc1 L_abort
    s_cmp_ge_u32 s27, 54
    s_cbranch_scc1 L_pa_127
L_pi_129:
    s_sleep 6
    buffer_load_dwordx4 v[188:191], v1, s[4:7], s87 offen offset:1024 sc1
    s_add_u32 s31, s31, 1
    s_cmp_gt_u32 s31, 1048576
    s_cbranch_scc1 L_abort
    s_waitcnt vmcnt(0)
    v_max3_u32 v40, v188, v189, v190
    v_max_u32 v41, v40, v191
    v_cmp_eq_u32 vcc, -1, v41
    s_nop 0
    s_cbranch_vccnz L_pi_129
    s_branch L_pa_127
L_pk_128:
    s_cmp_ge_u32 s27, 60
    s_cbranch_scc1 L_rnp_131
    s_add_u32 s70, s28, 0x420000
    buffer_store_dwordx4 v[12:15], v1, s[4:7], s70 offen sc1
    s_add_u32 s70, s28, 0x620000
    buffer_store_dwordx4 v[12:15], v1, s[4:7], s70 offen sc1
L_rnp_131:
    v_pk_add_f32 v[128:129], v[128:129], v[160:161]
    v_pk_add_f32 v[130:131], v[130:131], v[162:163]
    v_pk_add_f32 v[132:133], v[132:133], v[164:165]
    v_pk_add_f32 v[134:135], v[134:135], v[166:167]
    v_pk_add_f32 v[136:137], v[136:137], v[168:169]
    v_pk_add_f32 v[138:139], v[138:139], v[170:171]
    v_pk_add_f32 v[140:141], v[140:141], v[172:173]
    v_pk_add_f32 v[142:143], v[142:143], v[174:175]
    v_pk_add_f32 v[144:145], v[144:145], v[176:177]
    v_pk_add_f32 v[146:147], v[146:147], v[178:179]
    v_pk_add_f32 v[148:149], v[148:149], v[180:181]
    v_pk_add_f32 v[150:151], v[150:151], v[182:183]
    v_pk_add_f32 v[152:153], v[152:153], v[184:185]
    v_pk_add_f32 v[154:155], v[154:155], v[186:187]
    v_pk_add_f32 v[156:157], v[156:157], v[188:189]
    v_pk_add_f32 v[158:159], v[158:159], v[190:191]
    v_pk_add_f32 v[128:129], v[128:129], v[144:145]
    v_pk_add_f32 v[130:131], v[130:131], v[146:147]
    v_pk_add_f32 v[132:133], v[132:133], v[148:149]
    v_pk_add_f32 v[134:135], v[134:135], v[150:151]
    v_pk_add_f32 v[136:137], v[136:137], v[152:153]
    v_pk_add_f32 v[138:139], v[138:139], v[154:155]
    v_pk_add_f32 v[140:141], v[140:141], v[156:157]
    v_pk_add_f32 v[142:143], v[142:143], v[158:159]
    v_pk_add_f32 v[128:129], v[128:129], v[136:137]
    v_pk_add_f32 v[130:131], v[130:131], v[138:139]
    v_pk_add_f32 v[132:133], v[132:133], v[140:141]
    v_pk_add_f32 v[134:135], v[134:135], v[142:143]
    v_cvt_pk_bf16_f32 v28, v128, v129
    v_cvt_pk_bf16_f32 v29, v130, v131
    v_cvt_pk_bf16_f32 v30, v132, v133
    v_cvt_pk_bf16_f32 v31, v134, v135
    v_lshlrev_b32 v128, 16, v28
    v_and_b32 v129, 0xffff0000, v28
    v_lshlrev_b32 v130, 16, v29
    v_and_b32 v131, 0xffff0000, v29
    v_lshlrev_b32 v132, 16, v30
    v_and_b32 v133, 0xffff0000, v30
    v_lshlrev_b32 v134, 16, v31
    v_and_b32 v135, 0xffff0000, v31
    v_pk_mul_f32 v[128:129], v[128:129], v[96:97]
    v_pk_mul_f32 v[130:131], v[130:131], v[98:99]
    v_pk_mul_f32 v[132:133], v[132:133], v[100:101]
    v_pk_mul_f32 v[134:135], v[134:135], v[102:103]
    v_cvt_pk_bf16_f32 v28, v128, v129
    v_cvt_pk_bf16_f32 v29, v130, v131
    v_cvt_pk_bf16_f32 v30, v132, v133
    v_cvt_pk_bf16_f32 v31, v134, v135
    v_lshlrev_b32 v128, 16, v28
    v_and_b32 v129, 0xffff0000, v28
    v_lshlrev_b32 v130, 16, v29
    v_and_b32 v131, 0xffff0000, v29
    v_lshlrev_b32 v132, 16, v30
    v_and_b32 v133, 0xffff0000, v30
    v_lshlrev_b32 v134, 16, v31
    v_and_b32 v135, 0xffff0000, v31
    v_pk_add_f32 v[20:21], v[20:21], v[128:129]
    v_pk_add_f32 v[22:23], v[22:23], v[130:131]
    v_pk_add_f32 v[24:25], v[24:25], v[132:133]
    v_pk_add_f32 v[26:27], v[26:27], v[134:135]
    v_cvt_pk_bf16_f32 v28, v20, v21
    v_cvt_pk_bf16_f32 v29, v22, v23
    v_cvt_pk_bf16_f32 v30, v24, v25
    v_cvt_pk_bf16_f32 v31, v26, v27
    v_lshlrev_b32 v20, 16, v28
    v_and_b32 v21, 0xffff0000, v28
    v_lshlrev_b32 v22, 16, v29
    v_and_b32 v23, 0xffff0000, v29
    v_lshlrev_b32 v24, 16, v30
    v_and_b32 v25, 0xffff0000, v30
    v_lshlrev_b32 v26, 16, v31
    v_and_b32 v27, 0xffff0000, v31
    v_min_u32 v40, -2, v28
    v_min_u32 v41, -2, v29
    v_min_u32 v42, -2, v30
    v_min_u32 v43, -2, v31
    s_add_u32 s70, s28, 0x400000
    buffer_store_dwordx2 v[40:41], v10, s[4:7], s70 offen offset:0 sc1
    buffer_store_dwordx2 v[42:43], v10, s[4:7], s70 offen offset:512 sc1
    v_pk_add_f32 v[48:49], v[20:21], v[24:25]
    v_pk_add_f32 v[50:51], v[22:23], v[26:27]
    v_pk_add_f32 v[48:49], v[48:49], v[50:51]
    v_add_f32 v44, v48, v49
    s_nop 1
    v_add_f32_dpp v44, v44, v44 quad_perm:[1,0,3,2] row_mask:0xf bank_mask:0xf
    s_nop 1
    v_add_f32_dpp v44, v44, v44 quad_perm:[2,3,0,1] row_mask:0xf bank_mask:0xf
    s_nop 1
    v_add_f32_dpp v44, v44, v44 row_half_mirror row_mask:0xf bank_mask:0xf
    s_nop 1
    v_add_f32_dpp v44, v44, v44 row_mirror row_mask:0xf bank_mask:0xf
    v_mov_b32 v48, v44
    s_nop 1
    v_permlane16_swap_b32 v44, v48
    v_add_f32 v44, v44, v48
    v_mov_b32 v48, v44
    s_nop 1
    v_permlane32_swap_b32 v44, v48
    v_add_f32 v44, v44, v48
    v_mul_f32 v44, 0x3b000000, v44
    v_sub_f32 v48, v20, v44
    v_sub_f32 v49, v21, v44
    v_sub_f32 v50, v22, v44
    v_sub_f32 v51, v23, v44
    v_sub_f32 v52, v24, v44
    v_sub_f32 v53, v25, v44
    v_sub_f32 v54, v26, v44
    v_sub_f32 v55, v27, v44
    v_mul_f32 v45, v48, v48
    v_mul_f32 v48, v49, v49
    v_fmac_f32 v45, v50, v50
    v_fmac_f32 v48, v51, v51
    v_fmac_f32 v45, v52, v52
    v_fmac_f32 v48, v53, v53
    v_fmac_f32 v45, v54, v54
    v_fmac_f32 v48, v55, v55
    v_add_f32 v45, v45, v48
    s_nop 1
    v_add_f32_dpp v45, v45, v45 quad_perm:[1,0,3,2] row_mask:0xf bank_mask:0xf
    s_nop 1
    v_add_f32_dpp v45, v45, v45 quad_perm:[2,3,0,1] row_mask:0xf bank_mask:0xf
    s_nop 1
    v_add_f32_dpp v45, v45, v45 row_half_mirror row_mask:0xf bank_mask:0xf
    s_nop 1
    v_add_f32_dpp v45, v45, v45 row_mirror row_mask:0xf bank_mask:0xf
    v_mov_b32 v48, v45
    s_nop 1
    v_permlane16_swap_b32 v45, v48
    v_add_f32 v45, v45, v48
    v_mov_b32 v48, v45
    s_nop 1
    v_permlane32_swap_b32 v45, v48
    v_add_f32 v45, v45, v48
    v_mul_f32 v45, 0x3b000000, v45
    v_cvt_pk_bf16_f32 v48, v44, v45
    v_lshlrev_b32 v44, 16, v48
    v_and_b32 v45, 0xffff0000, v48
    v_add_f32 v45, 0x3727c5ac, v45
    v_cvt_pk_bf16_f32 v45, v45, v45
    v_and_b32 v45, 0xffff0000, v45
    v_sqrt_f32 v45, v45
    s_nop 0
    v_cvt_pk_bf16_f32 v45, v45, v45
    v_and_b32 v45, 0xffff0000, v45
    v_rcp_f32 v45, v45
    v_sub_f32 v20, v20, v44
    v_sub_f32 v21, v21, v44
    v_sub_f32 v22, v22, v44
    v_sub_f32 v23, v23, v44
    v_sub_f32 v24, v24, v44
    v_sub_f32 v25, v25, v44
    v_sub_f32 v26, v26, v44
    v_sub_f32 v27, v27, v44
    v_cvt_pk_bf16_f32 v28, v20, v21
    v_cvt_pk_bf16_f32 v29, v22, v23
    v_cvt_pk_bf16_f32 v30, v24, v25
    v_cvt_pk_bf16_f32 v31, v26, v27
    v_lshlrev_b32 v20, 16, v28
    v_and_b32 v21, 0xffff0000, v28
    v_lshlrev_b32 v22, 16, v29
    v_and_b32 v23, 0xffff0000, v29
    v_lshlrev_b32 v24, 16, v30
    v_and_b32 v25, 0xffff0000, v30
    v_lshlrev_b32 v26, 16, v31
    v_and_b32 v27, 0xffff0000, v31
    v_mul_f32 v20, v20, v45
    v_mul_f32 v21, v21, v45
    v_mul_f32 v22, v22, v45
    v_mul_f32 v23, v23, v45
    v_mul_f32 v24, v24, v45
    v_mul_f32 v25, v25, v45
    v_mul_f32 v26, v26, v45
    v_mul_f32 v27, v27, v45
    v_cvt_pk_bf16_f32 v28, v20, v21
    v_cvt_pk_bf16_f32 v29, v22, v23
    v_cvt_pk_bf16_f32 v30, v24, v25
    v_cvt_pk_bf16_f32 v31, v26, v27
    v_lshlrev_b32 v20, 16, v28
    v_and_b32 v21, 0xffff0000, v28
    v_lshlrev_b32 v22, 16, v29
    v_and_b32 v23, 0xffff0000, v29
    v_lshlrev_b32 v24, 16, v30
    v_and_b32 v25, 0xffff0000, v30
    v_lshlrev_b32 v26, 16, v31
    v_and_b32 v27, 0xffff0000, v31
    v_pk_mul_f32 v[20:21], v[20:21], v[112:113]
    v_pk_mul_f32 v[22:23], v[22:23], v[114:115]
    v_pk_mul_f32 v[24:25], v[24:25], v[116:117]
    v_pk_mul_f32 v[26:27], v[26:27], v[118:119]
    v_cvt_pk_bf16_f32 v28, v20, v21
    v_cvt_pk_bf16_f32 v29, v22, v23
    v_cvt_pk_bf16_f32 v30, v24, v25
    v_cvt_pk_bf16_f32 v31, v26, v27
    v_lshlrev_b32 v20, 16, v28
    v_and_b32 v21, 0xffff0000, v28
    v_lshlrev_b32 v22, 16, v29
    v_and_b32 v23, 0xffff0000, v29
    v_lshlrev_b32 v24, 16, v30
    v_and_b32 v25, 0xffff0000, v30
    v_lshlrev_b32 v26, 16, v31
    v_and_b32 v27, 0xffff0000, v31
    v_pk_add_f32 v[20:21], v[20:21], v[104:105]
    v_pk_add_f32 v[22:23], v[22:23], v[106:107]
    v_pk_add_f32 v[24:25], v[24:25], v[108:109]
    v_pk_add_f32 v[26:27], v[26:27], v[110:111]
    v_cvt_pk_bf16_f32 v60, v20, v21
    v_cvt_pk_bf16_f32 v61, v22, v23
    v_cvt_pk_bf16_f32 v62, v24, v25
    v_cvt_pk_bf16_f32 v63, v26, v27
    v_min_u32 v60, -2, v60
    v_min_u32 v61, -2, v61
    v_min_u32 v62, -2, v62
    v_min_u32 v63, -2, v63
    s_add_u32 s70, s28, 0x600000
    buffer_store_dwordx2 v[60:61], v10, s[4:7], s70 offen offset:0 sc1
    buffer_store_dwordx2 v[62:63], v10, s[4:7], s70 offen offset:512 sc1
    s_add_u32 s28, s28, 65536
    s_add_u32 s29, s29, 0x100000
    s_add_u32 s27, s27, 2
    s_cmp_lt_u32 s27, 64
    s_cbranch_scc1 L_R_loop
    s_endpgm
L_team:
    s_mov_b32 s8, s36
    s_and_b32 s9, s37, 0xffff
    s_mov_b32 s10, 0x400000
    s_mov_b32 s11, 0x20000
    s_mov_b32 s12, s38
    s_and_b32 s13, s39, 0xffff
    s_mov_b32 s14, 0x400000
    s_mov_b32 s15, 0x20000
    s_mov_b32 s16, s40
    s_and_b32 s17, s41, 0xffff
    s_mov_b32 s18, 0x400000
    s_mov_b32 s19, 0x20000
    s_mov_b32 s72, s42
    s_and_b32 s73, s43, 0xffff
    s_mov_b32 s74, 0x400000
    s_mov_b32 s75, 0x20000
    v_and_b32 v60, 63, v0
    v_lshrrev_b32 v61, 4, v60
    v_and_b32 v62, 15, v60
    v_bfe_u32 v66, v60, 2, 2
    v_and_b32 v67, 3, v60
    v_lshlrev_b32 v1, 4, v60
    s_lshl_b32 s70, s20, 11
    v_add_u32 v15, s70, v1
    v_add_u32 v14, 131072, v1
    v_lshlrev_b32 v7, 3, v60
    v_add_u32 v2, 153856, v1
    v_lshrrev_b32 v63, 2, v62
    v_and_b32 v64, 1, v61
    v_xor_b32 v63, v63, v64
    v_lshlrev_b32 v63, 3, v63
    v_lshl_add_u32 v63, v62, 5, v63
    v_lshrrev_b32 v64, 5, v60
    v_lshl_add_u32 v63, v64, 9, v63
    s_lshl_b32 s70, s20, 10
    s_add_u32 s71, s70, 147456
    v_add_u32 v3, s71, v63
    v_lshl_add_u32 v63, v61, 2, v66
    v_xor_b32 v64, v67, v61
    v_lshlrev_b32 v64, 3, v64
    v_lshl_add_u32 v63, v63, 5, v64
    v_add_u32 v4, 147456, v63
    v_mul_u32_u24 v63, 288, v62
    v_lshl_add_u32 v63, v61, 4, v63
    s_lshl_b32 s70, s20, 6
    s_add_u32 s70, s70, 151552
    v_add_u32 v5, s70, v63
    v_and_b32 v63, 7, v60
    v_mul_u32_u24 v63, 288, v63
    v_lshl_add_u32 v63, v61, 4, v63
    v_add_u32 v6, 151552, v63
    v_lshrrev_b32 v63, 3, v60
    v_mul_u32_u24 v63, 8576, v63
    v_and_b32 v64, 7, v60
    v_lshl_add_u32 v8, v64, 4, v63
    s_lshr_b32 s70, s22, 3
    s_lshl_b32 s70, s70, 1
    s_lshr_b32 s71, s20, 1
    s_add_u32 s70, s70, s71
    s_and_b32 s71, s22, 7
    s_lshl_b32 s27, s70, 10
    s_lshl_b32 s28, s71, 7
    s_add_u32 s25, s27, s28
    s_add_u32 s25, s25, 0x0
    s_add_u32 s26, s25, 68608
    s_add_u32 s2, s25, 137216
    s_add_u32 s3, s25, 205824
    s_lshr_b32 s71, s71, 1
    s_and_b32 s28, s22, 1
    s_lshl_b32 s28, s28, 2
    v_and_b32 v64, 1, v61
    v_bfe_u32 v63, v60, 3, 1
    v_lshl_add_u32 v63, v64, 1, v63
    v_add_u32 v63, s28, v63
    v_bfe_u32 v64, v60, 2, 1
    v_lshlrev_b32 v64, 7, v64
    v_lshl_add_u32 v65, v67, 2, v64
    v_lshl_add_u32 v65, v63, 4, v65
    s_lshl_b32 s28, s71, 8
    s_add_u32 s27, s27, s28
    v_add_u32 v9, s27, v65
    s_lshl_b32 s27, s70, 7
    s_lshl_b32 s28, s71, 5
    s_add_u32 s27, s27, s28
    v_and_b32 v64, 7, v60
    v_lshlrev_b32 v64, 2, v64
    v_lshl_add_u32 v58, v63, 10, v64
    v_mov_b32 v63, 0x4444
    v_mov_b32 v64, 0xeeee
    v_and_b32 v65, 8, v60
    v_cmp_eq_u32 vcc, 0, v65
    s_nop 1
    v_cndmask_b32 v10, v64, v63, vcc
    v_mov_b32 v63, 0xf149f2ca
    v_cmp_gt_u32 vcc, 32, v60
    s_nop 1
    v_cndmask_b32 v11, 0, v63, vcc
    s_lshl_b32 s70, s20, 13
    v_add_u32 v12, s70, v1
    v_add_u32 v13, 0x10000, v12
    s_lshl_b32 s70, s22, 2
    s_add_u32 s70, s70, s20
    s_mul_i32 s29, s22, 8576
    s_lshl_b32 s71, s20, 11
    s_add_u32 s29, s29, s71
    s_add_u32 s29, s29, 0x0
    s_lshl_b32 s64, s22, 13
    s_add_u32 s66, s64, 0x3000000
    s_add_u32 s64, s64, 0x2000000
    s_and_b32 s70, s70, -2
    s_lshl_b32 s67, s70, 10
    s_add_u32 s67, s67, 0xfe0000
    s_lshl_b32 s68, s70, 9
    s_add_u32 s68, s68, 0x1830000
    s_mov_b32 s69, 0x3e0293ee
    s_mov_b32 s24, 0x100000
    s_mov_b32 s30, 0x102000
    v_and_b32 v63, 1, v60
    v_lshlrev_b32 v63, 4, v63
    v_mov_b32 v64, 0x3f80
    v_lshlrev_b32 v63, v63, v64
    v_bfe_u32 v64, v60, 1, 2
    v_cmp_eq_u32 vcc, 0, v64
    s_nop 1
    v_cndmask_b32 v16, 0, v63, vcc
    v_cmp_eq_u32 vcc, 1, v64
    s_nop 1
    v_cndmask_b32 v17, 0, v63, vcc
    v_cmp_eq_u32 vcc, 2, v64
    s_nop 1
    v_cndmask_b32 v18, 0, v63, vcc
    v_cmp_eq_u32 vcc, 3, v64
    s_nop 1
    v_cndmask_b32 v19, 0, v63, vcc
    v_mov_b32 v22, 0x3f803f80
    v_mov_b32 v23, 0x3f803f80
    v_mov_b32 v20, 0
    v_mov_b32 v21, 0
    s_mov_b32 s84, s34
    s_and_b32 s85, s35, 0xffff
    s_mov_b32 s86, 0x2000
    s_mov_b32 s87, 0x20000
    buffer_load_dword v56, v58, s[84:87], s27 offen
    v_mov_b32 v68, -1
    v_mov_b32 v69, -1
    v_mov_b32 v70, -1
    v_mov_b32 v71, -1
    v_mov_b32 v52, 0
    v_mov_b32 v53, 0
    v_mov_b32 v54, 0
    v_mov_b32 v55, 0
    buffer_store_dwordx4 v[52:55], v8, s[4:7], s25 offen
    buffer_store_dwordx4 v[52:55], v8, s[4:7], s26 offen
    buffer_store_dwordx4 v[52:55], v8, s[4:7], s2 offen
    buffer_store_dwordx4 v[52:55], v8, s[4:7], s3 offen
    s_mov_b32 s70, 0x102000
    buffer_store_dword v68, v9, s[4:7], s70 offen
    s_mov_b32 s70, 0x104000
    buffer_store_dword v68, v9, s[4:7], s70 offen
    s_waitcnt vmcnt(6)
    v_min_u32 v56, -2, v56
    buffer_store_dword v56, v9, s[4:7], s24 offen
    v_and_b32 v63, 1, v61
    v_lshlrev_b32 v63, 5, v63
    v_lshlrev_b32 v64, 4, v62
    v_xor_b32 v63, v63, v64
    v_lshl_add_u32 v72, v61, 13, v63
    v_xor_b32 v73, 64, v72
    v_xor_b32 v74, 128, v72
    v_xor_b32 v75, 192, v72
    v_lshrrev_b32 v63, 1, v61
    v_lshlrev_b32 v63, 4, v63
    v_and_b32 v64, 1, v61
    v_lshl_add_u32 v63, v64, 2, v63
    v_and_b32 v65, 1, v66
    v_add_u32 v63, v63, v65
    v_lshl_or_b32 v65, v64, 1, v65
    v_lshrrev_b32 v64, 1, v66
    v_lshl_add_u32 v63, v64, 3, v63
    v_lshl_or_b32 v65, v64, 2, v65
    v_lshlrev_b32 v65, 5, v65
    v_lshl_or_b32 v65, v67, 3, v65
    s_lshl_b32 s70, s20, 6
    v_xor_b32 v64, s70, v65
    v_lshl_add_u32 v77, v63, 8, v64
    v_xor_b32 v78, 32, v77
    v_lshrrev_b32 v63, 1, v61
    v_lshlrev_b32 v63, 2, v63
    v_and_b32 v64, 1, v61
    v_lshl_add_u32 v63, v64, 4, v63
    v_and_b32 v65, 1, v66
    v_add_u32 v63, v63, v65
    v_lshlrev_b32 v63, 10, v63
    v_lshl_or_b32 v63, v64, 7, v63
    v_lshl_or_b32 v63, v65, 6, v63
    s_and_b32 s70, s20, 2
    s_lshl_b32 s70, s70, 6
    v_xor_b32 v76, s70, v1
    v_lshrrev_b32 v64, 1, v66
    v_lshl_or_b32 v63, v64, 5, v63
    v_lshl_or_b32 v63, v67, 3, v63
    s_lshl_b32 s70, s20, 8
    v_add_u32 v79, s70, v63
    s_lshl_b32 s80, s20, 18
    s_lshl_b32 s70, s22, 8
    s_add_u32 s80, s80, s70
    s_lshl_b32 s81, s20, 13
    s_lshl_b32 s82, s22, 17
    s_add_u32 s82, s82, s81
    s_lshl_b32 s83, s22, 6
    s_add_u32 s83, s83, 0x120000
    s_mov_b32 s88, 0
    v_xor_b32 v82, 0, v76
    s_add_u32 m0, s81, 0
    s_add_u32 s70, s82, 0x0
    buffer_load_dwordx4 v82, s[72:75], s70 offen lds
    v_xor_b32 v83, 64, v76
    s_add_u32 m0, s81, 1024
    s_add_u32 s70, s82, 0x400
    buffer_load_dwordx4 v83, s[72:75], s70 offen lds
    v_xor_b32 v82, 0, v76
    s_add_u32 m0, s81, 2048
    s_add_u32 s70, s82, 0x800
    buffer_load_dwordx4 v82, s[72:75], s70 offen lds
    v_xor_b32 v83, 64, v76
    s_add_u32 m0, s81, 3072
    s_add_u32 s70, s82, 0xc00
    buffer_load_dwordx4 v83, s[72:75], s70 offen lds
    v_xor_b32 v82, 0, v76
    s_add_u32 m0, s81, 4096
    s_add_u32 s70, s82, 0x1000
    buffer_load_dwordx4 v82, s[72:75], s70 offen lds
    v_xor_b32 v83, 64, v76
    s_add_u32 m0, s81, 5120
    s_add_u32 s70, s82, 0x1400
    buffer_load_dwordx4 v83, s[72:75], s70 offen lds
    v_xor_b32 v82, 0, v76
    s_add_u32 m0, s81, 6144
    s_add_u32 s70, s82, 0x1800
    buffer_load_dwordx4 v82, s[72:75], s70 offen lds
    v_xor_b32 v83, 64, v76
    s_add_u32 m0, s81, 7168
    s_add_u32 s70, s82, 0x1c00
    buffer_load_dwordx4 v83, s[72:75], s70 offen lds
    v_xor_b32 v82, 0, v76
    s_add_u32 m0, s81, 32768
    s_add_u32 s70, s82, 0x8000
    buffer_load_dwordx4 v82, s[72:75], s70 offen lds
    v_xor_b32 v83, 64, v76
    s_add_u32 m0, s81, 33792
    s_add_u32 s70, s82, 0x8400
    buffer_load_dwordx4 v83, s[72:75], s70 offen lds
    v_xor_b32 v82, 0, v76
    s_add_u32 m0, s81, 34816
    s_add_u32 s70, s82, 0x8800
    buffer_load_dwordx4 v82, s[72:75], s70 offen lds
    v_xor_b32 v83, 64, v76
    s_add_u32 m0, s81, 35840
    s_add_u32 s70, s82, 0x8c00
    buffer_load_dwordx4 v83, s[72:75], s70 offen lds
    v_xor_b32 v82, 0, v76
    s_add_u32 m0, s81, 36864
    s_add_u32 s70, s82, 0x9000
    buffer_load_dwordx4 v82, s[72:75], s70 offen lds
    v_xor_b32 v83, 64, v76
    s_add_u32 m0, s81, 37888
    s_add_u32 s70, s82, 0x9400
    buffer_load_dwordx4 v83, s[72:75], s70 offen lds
    v_xor_b32 v82, 0, v76
    s_add_u32 m0, s81, 38912
    s_add_u32 s70, s82, 0x9800
    buffer_load_dwordx4 v82, s[72:75], s70 offen lds
    v_xor_b32 v83, 64, v76
    s_add_u32 m0, s81, 39936
    s_add_u32 s70, s82, 0x9c00
    buffer_load_dwordx4 v83, s[72:75], s70 offen lds
    v_xor_b32 v82, 0, v76
    s_add_u32 m0, s81, 65536
    s_add_u32 s70, s82, 0x10000
    buffer_load_dwordx4 v82, s[72:75], s70 offen lds
    v_xor_b32 v83, 64, v76
    s_add_u32 m0, s81, 66560
    s_add_u32 s70, s82, 0x10400
    buffer_load_dwordx4 v83, s[72:75], s70 offen lds
    v_xor_b32 v82, 0, v76
    s_add_u32 m0, s81, 67584
    s_add_u32 s70, s82, 0x10800
    buffer_load_dwordx4 v82, s[72:75], s70 offen lds
    v_xor_b32 v83, 64, v76
    s_add_u32 m0, s81, 68608
    s_add_u32 s70, s82, 0x10c00
    buffer_load_dwordx4 v83, s[72:75], s70 offen lds
    v_xor_b32 v82, 0, v76
    s_add_u32 m0, s81, 69632
    s_add_u32 s70, s82, 0x11000
    buffer_load_dwordx4 v82, s[72:75], s70 offen lds
    v_xor_b32 v83, 64, v76
    s_add_u32 m0, s81, 70656
    s_add_u32 s70, s82, 0x11400
    buffer_load_dwordx4 v83, s[72:75], s70 offen lds
    v_xor_b32 v82, 0, v76
    s_add_u32 m0, s81, 71680
    s_add_u32 s70, s82, 0x11800
    buffer_load_dwordx4 v82, s[72:75], s70 offen lds
    v_xor_b32 v83, 64, v76
    s_add_u32 m0, s81, 72704
    s_add_u32 s70, s82, 0x11c00
    buffer_load_dwordx4 v83, s[72:75], s70 offen lds
    s_waitcnt vmcnt(24)
    s_barrier
    s_cmp_lg_u32 s20, 0
    s_cbranch_scc1 L_tinit_132
    v_mov_b32 v80, 4
    v_mov_b32 v81, 1
    s_mov_b64 exec, 1
    buffer_atomic_add v81, v80, s[76:79], 0 offen
    s_mov_b64 exec, -1
L_tinit_132:
    s_waitcnt vmcnt(16) lgkmcnt(0)
    s_barrier
    v_xor_b32 v82, 0, v76
    s_add_u32 m0, s81, 98304
    s_add_u32 s70, s82, 0x18000
    buffer_load_dwordx4 v82, s[72:75], s70 offen lds
    v_xor_b32 v83, 64, v76
    s_add_u32 m0, s81, 99328
    s_add_u32 s70, s82, 0x18400
    buffer_load_dwordx4 v83, s[72:75], s70 offen lds
    v_xor_b32 v82, 0, v76
    s_add_u32 m0, s81, 100352
    s_add_u32 s70, s82, 0x18800
    buffer_load_dwordx4 v82, s[72:75], s70 offen lds
    v_xor_b32 v83, 64, v76
    s_add_u32 m0, s81, 101376
    s_add_u32 s70, s82, 0x18c00
    buffer_load_dwordx4 v83, s[72:75], s70 offen lds
    v_xor_b32 v82, 0, v76
    s_add_u32 m0, s81, 102400
    s_add_u32 s70, s82, 0x19000
    buffer_load_dwordx4 v82, s[72:75], s70 offen lds
    v_xor_b32 v83, 64, v76
    s_add_u32 m0, s81, 103424
    s_add_u32 s70, s82, 0x19400
    buffer_load_dwordx4 v83, s[72:75], s70 offen lds
    v_xor_b32 v82, 0, v76
    s_add_u32 m0, s81, 104448
    s_add_u32 s70, s82, 0x19800
    buffer_load_dwordx4 v82, s[72:75], s70 offen lds
    v_xor_b32 v83, 64, v76
    s_add_u32 m0, s81, 105472
    s_add_u32 s70, s82, 0x19c00
    buffer_load_dwordx4 v83, s[72:75], s70 offen lds
    v_xor_b32 v80, 0, v79
    ds_read_b64_tr_b16 a[128:129], v80 offset:0
    ds_read_b64_tr_b16 a[130:131], v80 offset:2048
    ds_read_b64_tr_b16 a[132:133], v80 offset:8192
    ds_read_b64_tr_b16 a[134:135], v80 offset:10240
    v_xor_b32 v80, 64, v79
    ds_read_b64_tr_b16 a[160:161], v80 offset:0
    ds_read_b64_tr_b16 a[162:163], v80 offset:2048
    ds_read_b64_tr_b16 a[164:165], v80 offset:8192
    ds_read_b64_tr_b16 a[166:167], v80 offset:10240
    v_xor_b32 v80, 128, v79
    ds_read_b64_tr_b16 a[192:193], v80 offset:0
    ds_read_b64_tr_b16 a[194:195], v80 offset:2048
    ds_read_b64_tr_b16 a[196:197], v80 offset:8192
    ds_read_b64_tr_b16 a[198:199], v80 offset:10240
    v_xor_b32 v80, 192, v79
    ds_read_b64_tr_b16 a[224:225], v80 offset:0
    ds_read_b64_tr_b16 a[226:227], v80 offset:2048
    ds_read_b64_tr_b16 a[228:229], v80 offset:8192
    ds_read_b64_tr_b16 a[230:231], v80 offset:10240
    s_waitcnt vmcnt(16) lgkmcnt(0)
    s_barrier
    s_add_u32 m0, s81, 0
    s_add_u32 s70, s80, 0x0
    buffer_load_dwordx4 v72, s[8:11], s70 offen lds
    s_add_u32 m0, s81, 1024
    s_add_u32 s70, s80, 0x8000
    buffer_load_dwordx4 v73, s[8:11], s70 offen lds
    s_add_u32 m0, s81, 2048
    s_add_u32 s70, s80, 0x10000
    buffer_load_dwordx4 v74, s[8:11], s70 offen lds
    s_add_u32 m0, s81, 3072
    s_add_u32 s70, s80, 0x18000
    buffer_load_dwordx4 v75, s[8:11], s70 offen lds
    s_add_u32 m0, s81, 4096
    s_add_u32 s70, s80, 0x20000
    buffer_load_dwordx4 v72, s[8:11], s70 offen lds
    s_add_u32 m0, s81, 5120
    s_add_u32 s70, s80, 0x28000
    buffer_load_dwordx4 v73, s[8:11], s70 offen lds
    s_add_u32 m0, s81, 6144
    s_add_u32 s70, s80, 0x30000
    buffer_load_dwordx4 v74, s[8:11], s70 offen lds
    s_add_u32 m0, s81, 7168
    s_add_u32 s70, s80, 0x38000
    buffer_load_dwordx4 v75, s[8:11], s70 offen lds
    v_xor_b32 v80, 0, v79
    ds_read_b64_tr_b16 a[136:137], v80 offset:32768
    ds_read_b64_tr_b16 a[138:139], v80 offset:34816
    ds_read_b64_tr_b16 a[140:141], v80 offset:40960
    ds_read_b64_tr_b16 a[142:143], v80 offset:43008
    v_xor_b32 v80, 64, v79
    ds_read_b64_tr_b16 a[168:169], v80 offset:32768
    ds_read_b64_tr_b16 a[170:171], v80 offset:34816
    ds_read_b64_tr_b16 a[172:173], v80 offset:40960
    ds_read_b64_tr_b16 a[174:175], v80 offset:43008
    v_xor_b32 v80, 128, v79
    ds_read_b64_tr_b16 a[200:201], v80 offset:32768
    ds_read_b64_tr_b16 a[202:203], v80 offset:34816
    ds_read_b64_tr_b16 a[204:205], v80 offset:40960
    ds_read_b64_tr_b16 a[206:207], v80 offset:43008
    v_xor_b32 v80, 192, v79
    ds_read_b64_tr_b16 a[232:233], v80 offset:32768
    ds_read_b64_tr_b16 a[234:235], v80 offset:34816
    ds_read_b64_tr_b16 a[236:237], v80 offset:40960
    ds_read_b64_tr_b16 a[238:239], v80 offset:43008
    s_waitcnt vmcnt(16) lgkmcnt(0)
    s_barrier
    s_add_u32 m0, s81, 32768
    s_add_u32 s70, s80, 0x100000
    buffer_load_dwordx4 v72, s[8:11], s70 offen lds
    s_add_u32 m0, s81, 33792
    s_add_u32 s70, s80, 0x108000
    buffer_load_dwordx4 v73, s[8:11], s70 offen lds
    s_add_u32 m0, s81, 34816
    s_add_u32 s70, s80, 0x110000
    buffer_load_dwordx4 v74, s[8:11], s70 offen lds
    s_add_u32 m0, s81, 35840
    s_add_u32 s70, s80, 0x118000
    buffer_load_dwordx4 v75, s[8:11], s70 offen lds
    s_add_u32 m0, s81, 36864
    s_add_u32 s70, s80, 0x120000
    buffer_load_dwordx4 v72, s[8:11], s70 offen lds
    s_add_u32 m0, s81, 37888
    s_add_u32 s70, s80, 0x128000
    buffer_load_dwordx4 v73, s[8:11], s70 offen lds
    s_add_u32 m0, s81, 38912
    s_add_u32 s70, s80, 0x130000
    buffer_load_dwordx4 v74, s[8:11], s70 offen lds
    s_add_u32 m0, s81, 39936
    s_add_u32 s70, s80, 0x138000
    buffer_load_dwordx4 v75, s[8:11], s70 offen lds
    v_xor_b32 v80, 65536, v79
    ds_read_b64_tr_b16 a[144:145], v80 offset:0
    ds_read_b64_tr_b16 a[146:147], v80 offset:2048
    ds_read_b64_tr_b16 a[148:149], v80 offset:8192
    ds_read_b64_tr_b16 a[150:151], v80 offset:10240
    v_xor_b32 v80, 65600, v79
    ds_read_b64_tr_b16 a[176:177], v80 offset:0
    ds_read_b64_tr_b16 a[178:179], v80 offset:2048
    ds_read_b64_tr_b16 a[180:181], v80 offset:8192
    ds_read_b64_tr_b16 a[182:183], v80 offset:10240
    v_xor_b32 v80, 65664, v79
    ds_read_b64_tr_b16 a[208:209], v80 offset:0
    ds_read_b64_tr_b16 a[210:211], v80 offset:2048
    ds_read_b64_tr_b16 a[212:213], v80 offset:8192
    ds_read_b64_tr_b16 a[214:215], v80 offset:10240
    v_xor_b32 v80, 65728, v79
    ds_read_b64_tr_b16 a[240:241], v80 offset:0
    ds_read_b64_tr_b16 a[242:243], v80 offset:2048
    ds_read_b64_tr_b16 a[244:245], v80 offset:8192
    ds_read_b64_tr_b16 a[246:247], v80 offset:10240
    s_waitcnt vmcnt(16) lgkmcnt(0)
    s_barrier
    s_add_u32 m0, s81, 65536
    s_add_u32 s70, s80, 0x200000
    buffer_load_dwordx4 v72, s[8:11], s70 offen lds
    s_add_u32 m0, s81, 66560
    s_add_u32 s70, s80, 0x208000
    buffer_load_dwordx4 v73, s[8:11], s70 offen lds
    s_add_u32 m0, s81, 67584
    s_add_u32 s70, s80, 0x210000
    buffer_load_dwordx4 v74, s[8:11], s70 offen lds
    s_add_u32 m0, s81, 68608
    s_add_u32 s70, s80, 0x218000
    buffer_load_dwordx4 v75, s[8:11], s70 offen lds
    s_add_u32 m0, s81, 69632
    s_add_u32 s70, s80, 0x220000
    buffer_load_dwordx4 v72, s[8:11], s70 offen lds
    s_add_u32 m0, s81, 70656
    s_add_u32 s70, s80, 0x228000
    buffer_load_dwordx4 v73, s[8:11], s70 offen lds
    s_add_u32 m0, s81, 71680
    s_add_u32 s70, s80, 0x230000
    buffer_load_dwordx4 v74, s[8:11], s70 offen lds
    s_add_u32 m0, s81, 72704
    s_add_u32 s70, s80, 0x238000
    buffer_load_dwordx4 v75, s[8:11], s70 offen lds
    v_xor_b32 v80, 65536, v79
    ds_read_b64_tr_b16 a[152:153], v80 offset:32768
    ds_read_b64_tr_b16 a[154:155], v80 offset:34816
    ds_read_b64_tr_b16 a[156:157], v80 offset:40960
    ds_read_b64_tr_b16 a[158:159], v80 offset:43008
    v_xor_b32 v80, 65600, v79
    ds_read_b64_tr_b16 a[184:185], v80 offset:32768
    ds_read_b64_tr_b16 a[186:187], v80 offset:34816
    ds_read_b64_tr_b16 a[188:189], v80 offset:40960
    ds_read_b64_tr_b16 a[190:191], v80 offset:43008
    v_xor_b32 v80, 65664, v79
    ds_read_b64_tr_b16 a[216:217], v80 offset:32768
    ds_read_b64_tr_b16 a[218:219], v80 offset:34816
    ds_read_b64_tr_b16 a[220:221], v80 offset:40960
    ds_read_b64_tr_b16 a[222:223], v80 offset:43008
    v_xor_b32 v80, 65728, v79
    ds_read_b64_tr_b16 a[248:249], v80 offset:32768
    ds_read_b64_tr_b16 a[250:251], v80 offset:34816
    ds_read_b64_tr_b16 a[252:253], v80 offset:40960
    ds_read_b64_tr_b16 a[254:255], v80 offset:43008
    s_waitcnt vmcnt(16) lgkmcnt(0)
    s_barrier
    s_add_u32 m0, s81, 98304
    s_add_u32 s70, s80, 0x300000
    buffer_load_dwordx4 v72, s[8:11], s70 offen lds
    s_add_u32 m0, s81, 99328
    s_add_u32 s70, s80, 0x308000
    buffer_load_dwordx4 v73, s[8:11], s70 offen lds
    s_add_u32 m0, s81, 100352
    s_add_u32 s70, s80, 0x310000
    buffer_load_dwordx4 v74, s[8:11], s70 offen lds
    s_add_u32 m0, s81, 101376
    s_add_u32 s70, s80, 0x318000
    buffer_load_dwordx4 v75, s[8:11], s70 offen lds
    s_add_u32 m0, s81, 102400
    s_add_u32 s70, s80, 0x320000
    buffer_load_dwordx4 v72, s[8:11], s70 offen lds
    s_add_u32 m0, s81, 103424
    s_add_u32 s70, s80, 0x328000
    buffer_load_dwordx4 v73, s[8:11], s70 offen lds
    s_add_u32 m0, s81, 104448
    s_add_u32 s70, s80, 0x330000
    buffer_load_dwordx4 v74, s[8:11], s70 offen lds
    s_add_u32 m0, s81, 105472
    s_add_u32 s70, s80, 0x338000
    buffer_load_dwordx4 v75, s[8:11], s70 offen lds
    ds_read_b64_tr_b16 a[0:1], v77 offset:0
    ds_read_b64_tr_b16 a[2:3], v77 offset:512
    ds_read_b64_tr_b16 a[4:5], v77 offset:8192
    ds_read_b64_tr_b16 a[6:7], v77 offset:8704
    ds_read_b64_tr_b16 v[40:41], v78 offset:0
    ds_read_b64_tr_b16 v[42:43], v78 offset:512
    ds_read_b64_tr_b16 v[44:45], v78 offset:8192
    ds_read_b64_tr_b16 v[46:47], v78 offset:8704
    ds_read_b64_tr_b16 a[8:9], v77 offset:16384
    ds_read_b64_tr_b16 a[10:11], v77 offset:16896
    ds_read_b64_tr_b16 a[12:13], v77 offset:24576
    ds_read_b64_tr_b16 a[14:15], v77 offset:25088
    ds_read_b64_tr_b16 v[48:49], v78 offset:16384
    ds_read_b64_tr_b16 v[50:51], v78 offset:16896
    ds_read_b64_tr_b16 v[52:53], v78 offset:24576
    ds_read_b64_tr_b16 v[54:55], v78 offset:25088
    s_waitcnt vmcnt(16) lgkmcnt(0)
    s_barrier
    s_add_u32 m0, s81, 0
    s_add_u32 s70, s80, 0x0
    buffer_load_dwordx4 v72, s[16:19], s70 offen lds
    s_add_u32 m0, s81, 1024
    s_add_u32 s70, s80, 0x8000
    buffer_load_dwordx4 v73, s[16:19], s70 offen lds
    s_add_u32 m0, s81, 2048
    s_add_u32 s70, s80, 0x10000
    buffer_load_dwordx4 v74, s[16:19], s70 offen lds
    s_add_u32 m0, s81, 3072
    s_add_u32 s70, s80, 0x18000
    buffer_load_dwordx4 v75, s[16:19], s70 offen lds
    s_add_u32 m0, s81, 4096
    s_add_u32 s70, s80, 0x20000
    buffer_load_dwordx4 v72, s[16:19], s70 offen lds
    s_add_u32 m0, s81, 5120
    s_add_u32 s70, s80, 0x28000
    buffer_load_dwordx4 v73, s[16:19], s70 offen lds
    s_add_u32 m0, s81, 6144
    s_add_u32 s70, s80, 0x30000
    buffer_load_dwordx4 v74, s[16:19], s70 offen lds
    s_add_u32 m0, s81, 7168
    s_add_u32 s70, s80, 0x38000
    buffer_load_dwordx4 v75, s[16:19], s70 offen lds
    ds_read_b64_tr_b16 a[16:17], v77 offset:32768
    ds_read_b64_tr_b16 a[18:19], v77 offset:33280
    ds_read_b64_tr_b16 a[20:21], v77 offset:40960
    ds_read_b64_tr_b16 a[22:23], v77 offset:41472
    ds_read_b64_tr_b16 v[84:85], v78 offset:32768
    ds_read_b64_tr_b16 v[86:87], v78 offset:33280
    ds_read_b64_tr_b16 v[88:89], v78 offset:40960
    ds_read_b64_tr_b16 v[90:91], v78 offset:41472
    ds_read_b64_tr_b16 a[24:25], v77 offset:49152
    ds_read_b64_tr_b16 a[26:27], v77 offset:49664
    ds_read_b64_tr_b16 a[28:29], v77 offset:57344
    ds_read_b64_tr_b16 a[30:31], v77 offset:57856
    ds_read_b64_tr_b16 v[92:93], v78 offset:49152
    ds_read_b64_tr_b16 v[94:95], v78 offset:49664
    ds_read_b64_tr_b16 v[96:97], v78 offset:57344
    ds_read_b64_tr_b16 v[98:99], v78 offset:57856
    s_waitcnt vmcnt(16) lgkmcnt(0)
    s_barrier
    s_add_u32 m0, s81, 32768
    s_add_u32 s70, s80, 0x100000
    buffer_load_dwordx4 v72, s[16:19], s70 offen lds
    s_add_u32 m0, s81, 33792
    s_add_u32 s70, s80, 0x108000
    buffer_load_dwordx4 v73, s[16:19], s70 offen lds
    s_add_u32 m0, s81, 34816
    s_add_u32 s70, s80, 0x110000
    buffer_load_dwordx4 v74, s[16:19], s70 offen lds
    s_add_u32 m0, s81, 35840
    s_add_u32 s70, s80, 0x118000
    buffer_load_dwordx4 v75, s[16:19], s70 offen lds
    s_add_u32 m0, s81, 36864
    s_add_u32 s70, s80, 0x120000
    buffer_load_dwordx4 v72, s[16:19], s70 offen lds
    s_add_u32 m0, s81, 37888
    s_add_u32 s70, s80, 0x128000
    buffer_load_dwordx4 v73, s[16:19], s70 offen lds
    s_add_u32 m0, s81, 38912
    s_add_u32 s70, s80, 0x130000
    buffer_load_dwordx4 v74, s[16:19], s70 offen lds
    s_add_u32 m0, s81, 39936
    s_add_u32 s70, s80, 0x138000
    buffer_load_dwordx4 v75, s[16:19], s70 offen lds
    v_add_u32 v80, 0x10000, v77
    v_add_u32 v81, 0x10000, v78
    ds_read_b64_tr_b16 a[32:33], v80 offset:0
    ds_read_b64_tr_b16 a[34:35], v80 offset:512
    ds_read_b64_tr_b16 a[36:37], v80 offset:8192
    ds_read_b64_tr_b16 a[38:39], v80 offset:8704
    ds_read_b64_tr_b16 v[100:101], v81 offset:0
    ds_read_b64_tr_b16 v[102:103], v81 offset:512
    ds_read_b64_tr_b16 v[104:105], v81 offset:8192
    ds_read_b64_tr_b16 v[106:107], v81 offset:8704
    ds_read_b64_tr_b16 a[40:41], v80 offset:16384
    ds_read_b64_tr_b16 a[42:43], v80 offset:16896
    ds_read_b64_tr_b16 a[44:45], v80 offset:24576
    ds_read_b64_tr_b16 a[46:47], v80 offset:25088
    ds_read_b64_tr_b16 v[108:109], v81 offset:16384
    ds_read_b64_tr_b16 v[110:111], v81 offset:16896
    ds_read_b64_tr_b16 v[112:113], v81 offset:24576
    ds_read_b64_tr_b16 v[114:115], v81 offset:25088
    s_waitcnt vmcnt(16) lgkmcnt(0)
    s_barrier
    s_add_u32 m0, s81, 65536
    s_add_u32 s70, s80, 0x200000
    buffer_load_dwordx4 v72, s[16:19], s70 offen lds
    s_add_u32 m0, s81, 66560
    s_add_u32 s70, s80, 0x208000
    buffer_load_dwordx4 v73, s[16:19], s70 offen lds
    s_add_u32 m0, s81, 67584
    s_add_u32 s70, s80, 0x210000
    buffer_load_dwordx4 v74, s[16:19], s70 offen lds
    s_add_u32 m0, s81, 68608
    s_add_u32 s70, s80, 0x218000
    buffer_load_dwordx4 v75, s[16:19], s70 offen lds
    s_add_u32 m0, s81, 69632
    s_add_u32 s70, s80, 0x220000
    buffer_load_dwordx4 v72, s[16:19], s70 offen lds
    s_add_u32 m0, s81, 70656
    s_add_u32 s70, s80, 0x228000
    buffer_load_dwordx4 v73, s[16:19], s70 offen lds
    s_add_u32 m0, s81, 71680
    s_add_u32 s70, s80, 0x230000
    buffer_load_dwordx4 v74, s[16:19], s70 offen lds
    s_add_u32 m0, s81, 72704
    s_add_u32 s70, s80, 0x238000
    buffer_load_dwordx4 v75, s[16:19], s70 offen lds
    v_add_u32 v80, 0x10000, v77
    v_add_u32 v81, 0x10000, v78
    ds_read_b64_tr_b16 a[48:49], v80 offset:32768
    ds_read_b64_tr_b16 a[50:51], v80 offset:33280
    ds_read_b64_tr_b16 a[52:53], v80 offset:40960
    ds_read_b64_tr_b16 a[54:55], v80 offset:41472
    ds_read_b64_tr_b16 v[24:25], v81 offset:32768
    ds_read_b64_tr_b16 v[26:27], v81 offset:33280
    ds_read_b64_tr_b16 v[28:29], v81 offset:40960
    ds_read_b64_tr_b16 v[30:31], v81 offset:41472
    ds_read_b64_tr_b16 a[56:57], v80 offset:49152
    ds_read_b64_tr_b16 a[58:59], v80 offset:49664
    ds_read_b64_tr_b16 a[60:61], v80 offset:57344
    ds_read_b64_tr_b16 a[62:63], v80 offset:57856
    ds_read_b64_tr_b16 v[32:33], v81 offset:49152
    ds_read_b64_tr_b16 v[34:35], v81 offset:49664
    ds_read_b64_tr_b16 v[36:37], v81 offset:57344
    ds_read_b64_tr_b16 v[38:39], v81 offset:57856
    s_waitcnt vmcnt(16) lgkmcnt(0)
    s_barrier
    s_add_u32 m0, s81, 98304
    s_add_u32 s70, s80, 0x300000
    buffer_load_dwordx4 v72, s[16:19], s70 offen lds
    s_add_u32 m0, s81, 99328
    s_add_u32 s70, s80, 0x308000
    buffer_load_dwordx4 v73, s[16:19], s70 offen lds
    s_add_u32 m0, s81, 100352
    s_add_u32 s70, s80, 0x310000
    buffer_load_dwordx4 v74, s[16:19], s70 offen lds
    s_add_u32 m0, s81, 101376
    s_add_u32 s70, s80, 0x318000
    buffer_load_dwordx4 v75, s[16:19], s70 offen lds
    s_add_u32 m0, s81, 102400
    s_add_u32 s70, s80, 0x320000
    buffer_load_dwordx4 v72, s[16:19], s70 offen lds
    s_add_u32 m0, s81, 103424
    s_add_u32 s70, s80, 0x328000
    buffer_load_dwordx4 v73, s[16:19], s70 offen lds
    s_add_u32 m0, s81, 104448
    s_add_u32 s70, s80, 0x330000
    buffer_load_dwordx4 v74, s[16:19], s70 offen lds
    s_add_u32 m0, s81, 105472
    s_add_u32 s70, s80, 0x338000
    buffer_load_dwordx4 v75, s[16:19], s70 offen lds
    ds_read_b64_tr_b16 v[128:129], v77 offset:0
    ds_read_b64_tr_b16 v[130:131], v77 offset:512
    ds_read_b64_tr_b16 v[132:133], v77 offset:8192
    ds_read_b64_tr_b16 v[134:135], v77 offset:8704
    ds_read_b64_tr_b16 v[136:137], v78 offset:0
    ds_read_b64_tr_b16 v[138:139], v78 offset:512
    ds_read_b64_tr_b16 v[140:141], v78 offset:8192
    ds_read_b64_tr_b16 v[142:143], v78 offset:8704
    ds_read_b64_tr_b16 v[144:145], v77 offset:16384
    ds_read_b64_tr_b16 v[146:147], v77 offset:16896
    ds_read_b64_tr_b16 v[148:149], v77 offset:24576
    ds_read_b64_tr_b16 v[150:151], v77 offset:25088
    ds_read_b64_tr_b16 v[152:153], v78 offset:16384
    ds_read_b64_tr_b16 v[154:155], v78 offset:16896
    ds_read_b64_tr_b16 v[156:157], v78 offset:24576
    ds_read_b64_tr_b16 v[158:159], v78 offset:25088
    s_waitcnt vmcnt(16) lgkmcnt(0)
    s_barrier
    s_add_u32 m0, s81, 0
    s_add_u32 s70, s80, 0x0
    buffer_load_dwordx4 v72, s[12:15], s70 offen lds
    s_add_u32 m0, s81, 1024
    s_add_u32 s70, s80, 0x8000
    buffer_load_dwordx4 v73, s[12:15], s70 offen lds
    s_add_u32 m0, s81, 2048
    s_add_u32 s70, s80, 0x10000
    buffer_load_dwordx4 v74, s[12:15], s70 offen lds
    s_add_u32 m0, s81, 3072
    s_add_u32 s70, s80, 0x18000
    buffer_load_dwordx4 v75, s[12:15], s70 offen lds
    s_add_u32 m0, s81, 4096
    s_add_u32 s70, s80, 0x20000
    buffer_load_dwordx4 v72, s[12:15], s70 offen lds
    s_add_u32 m0, s81, 5120
    s_add_u32 s70, s80, 0x28000
    buffer_load_dwordx4 v73, s[12:15], s70 offen lds
    s_add_u32 m0, s81, 6144
    s_add_u32 s70, s80, 0x30000
    buffer_load_dwordx4 v74, s[12:15], s70 offen lds
    s_add_u32 m0, s81, 7168
    s_add_u32 s70, s80, 0x38000
    buffer_load_dwordx4 v75, s[12:15], s70 offen lds
    ds_read_b64_tr_b16 v[160:161], v77 offset:32768
    ds_read_b64_tr_b16 v[162:163], v77 offset:33280
    ds_read_b64_tr_b16 v[164:165], v77 offset:40960
    ds_read_b64_tr_b16 v[166:167], v77 offset:41472
    ds_read_b64_tr_b16 v[168:169], v78 offset:32768
    ds_read_b64_tr_b16 v[170:171], v78 offset:33280
    ds_read_b64_tr_b16 v[172:173], v78 offset:40960
    ds_read_b64_tr_b16 v[174:175], v78 offset:41472
    ds_read_b64_tr_b16 v[176:177], v77 offset:49152
    ds_read_b64_tr_b16 v[178:179], v77 offset:49664
    ds_read_b64_tr_b16 v[180:181], v77 offset:57344
    ds_read_b64_tr_b16 v[182:183], v77 offset:57856
    ds_read_b64_tr_b16 v[184:185], v78 offset:49152
    ds_read_b64_tr_b16 v[186:187], v78 offset:49664
    ds_read_b64_tr_b16 v[188:189], v78 offset:57344
    ds_read_b64_tr_b16 v[190:191], v78 offset:57856
    s_waitcnt vmcnt(16) lgkmcnt(0)
    s_barrier
    s_add_u32 m0, s81, 32768
    s_add_u32 s70, s80, 0x100000
    buffer_load_dwordx4 v72, s[12:15], s70 offen lds
    s_add_u32 m0, s81, 33792
    s_add_u32 s70, s80, 0x108000
    buffer_load_dwordx4 v73, s[12:15], s70 offen lds
    s_add_u32 m0, s81, 34816
    s_add_u32 s70, s80, 0x110000
    buffer_load_dwordx4 v74, s[12:15], s70 offen lds
    s_add_u32 m0, s81, 35840
    s_add_u32 s70, s80, 0x118000
    buffer_load_dwordx4 v75, s[12:15], s70 offen lds
    s_add_u32 m0, s81, 36864
    s_add_u32 s70, s80, 0x120000
    buffer_load_dwordx4 v72, s[12:15], s70 offen lds
    s_add_u32 m0, s81, 37888
    s_add_u32 s70, s80, 0x128000
    buffer_load_dwordx4 v73, s[12:15], s70 offen lds
    s_add_u32 m0, s81, 38912
    s_add_u32 s70, s80, 0x130000
    buffer_load_dwordx4 v74, s[12:15], s70 offen lds
    s_add_u32 m0, s81, 39936
    s_add_u32 s70, s80, 0x138000
    buffer_load_dwordx4 v75, s[12:15], s70 offen lds
    v_add_u32 v80, 0x10000, v77
    v_add_u32 v81, 0x10000, v78
    ds_read_b64_tr_b16 v[192:193], v80 offset:0
    ds_read_b64_tr_b16 v[194:195], v80 offset:512
    ds_read_b64_tr_b16 v[196:197], v80 offset:8192
    ds_read_b64_tr_b16 v[198:199], v80 offset:8704
    ds_read_b64_tr_b16 v[200:201], v81 offset:0
    ds_read_b64_tr_b16 v[202:203], v81 offset:512
    ds_read_b64_tr_b16 v[204:205], v81 offset:8192
    ds_read_b64_tr_b16 v[206:207], v81 offset:8704
    ds_read_b64_tr_b16 v[208:209], v80 offset:16384
    ds_read_b64_tr_b16 v[210:211], v80 offset:16896
    ds_read_b64_tr_b16 v[212:213], v80 offset:24576
    ds_read_b64_tr_b16 v[214:215], v80 offset:25088
    ds_read_b64_tr_b16 v[216:217], v81 offset:16384
    ds_read_b64_tr_b16 v[218:219], v81 offset:16896
    ds_read_b64_tr_b16 v[220:221], v81 offset:24576
    ds_read_b64_tr_b16 v[222:223], v81 offset:25088
    s_waitcnt vmcnt(16) lgkmcnt(0)
    s_barrier
    s_add_u32 m0, s81, 65536
    s_add_u32 s70, s80, 0x200000
    buffer_load_dwordx4 v72, s[12:15], s70 offen lds
    s_add_u32 m0, s81, 66560
    s_add_u32 s70, s80, 0x208000
    buffer_load_dwordx4 v73, s[12:15], s70 offen lds
    s_add_u32 m0, s81, 67584
    s_add_u32 s70, s80, 0x210000
    buffer_load_dwordx4 v74, s[12:15], s70 offen lds
    s_add_u32 m0, s81, 68608
    s_add_u32 s70, s80, 0x218000
    buffer_load_dwordx4 v75, s[12:15], s70 offen lds
    s_add_u32 m0, s81, 69632
    s_add_u32 s70, s80, 0x220000
    buffer_load_dwordx4 v72, s[12:15], s70 offen lds
    s_add_u32 m0, s81, 70656
    s_add_u32 s70, s80, 0x228000
    buffer_load_dwordx4 v73, s[12:15], s70 offen lds
    s_add_u32 m0, s81, 71680
    s_add_u32 s70, s80, 0x230000
    buffer_load_dwordx4 v74, s[12:15], s70 offen lds
    s_add_u32 m0, s81, 72704
    s_add_u32 s70, s80, 0x238000
    buffer_load_dwordx4 v75, s[12:15], s70 offen lds
    v_add_u32 v80, 0x10000, v77
    v_add_u32 v81, 0x10000, v78
    ds_read_b64_tr_b16 v[224:225], v80 offset:32768
    ds_read_b64_tr_b16 v[226:227], v80 offset:33280
    ds_read_b64_tr_b16 v[228:229], v80 offset:40960
    ds_read_b64_tr_b16 v[230:231], v80 offset:41472
    ds_read_b64_tr_b16 v[232:233], v81 offset:32768
    ds_read_b64_tr_b16 v[234:235], v81 offset:33280
    ds_read_b64_tr_b16 v[236:237], v81 offset:40960
    ds_read_b64_tr_b16 v[238:239], v81 offset:41472
    ds_read_b64_tr_b16 v[240:241], v80 offset:49152
    ds_read_b64_tr_b16 v[242:243], v80 offset:49664
    ds_read_b64_tr_b16 v[244:245], v80 offset:57344
    ds_read_b64_tr_b16 v[246:247], v80 offset:57856
    ds_read_b64_tr_b16 v[248:249], v81 offset:49152
    ds_read_b64_tr_b16 v[250:251], v81 offset:49664
    ds_read_b64_tr_b16 v[252:253], v81 offset:57344
    ds_read_b64_tr_b16 v[254:255], v81 offset:57856
    s_waitcnt vmcnt(16) lgkmcnt(0)
    s_barrier
    s_add_u32 m0, s81, 98304
    s_add_u32 s70, s80, 0x300000
    buffer_load_dwordx4 v72, s[12:15], s70 offen lds
    s_add_u32 m0, s81, 99328
    s_add_u32 s70, s80, 0x308000
    buffer_load_dwordx4 v73, s[12:15], s70 offen lds
    s_add_u32 m0, s81, 100352
    s_add_u32 s70, s80, 0x310000
    buffer_load_dwordx4 v74, s[12:15], s70 offen lds
    s_add_u32 m0, s81, 101376
    s_add_u32 s70, s80, 0x318000
    buffer_load_dwordx4 v75, s[12:15], s70 offen lds
    s_add_u32 m0, s81, 102400
    s_add_u32 s70, s80, 0x320000
    buffer_load_dwordx4 v72, s[12:15], s70 offen lds
    s_add_u32 m0, s81, 103424
    s_add_u32 s70, s80, 0x328000
    buffer_load_dwordx4 v73, s[12:15], s70 offen lds
    s_add_u32 m0, s81, 104448
    s_add_u32 s70, s80, 0x330000
    buffer_load_dwordx4 v74, s[12:15], s70 offen lds
    s_add_u32 m0, s81, 105472
    s_add_u32 s70, s80, 0x338000
    buffer_load_dwordx4 v75, s[12:15], s70 offen lds
    buffer_load_dword v124, off, s[76:79], 0 offset:192 sc1
    buffer_load_dword v125, off, s[76:79], 0 offset:176 sc1
    ds_read_b64_tr_b16 a[64:65], v77 offset:0
    ds_read_b64_tr_b16 a[66:67], v77 offset:512
    ds_read_b64_tr_b16 a[68:69], v77 offset:8192
    ds_read_b64_tr_b16 a[70:71], v77 offset:8704
    ds_read_b64_tr_b16 v[56:57], v78 offset:0
    ds_read_b64_tr_b16 v[58:59], v78 offset:512
    ds_read_b64_tr_b16 v[60:61], v78 offset:8192
    ds_read_b64_tr_b16 v[62:63], v78 offset:8704
    ds_read_b64_tr_b16 a[72:73], v77 offset:16384
    ds_read_b64_tr_b16 a[74:75], v77 offset:16896
    ds_read_b64_tr_b16 a[76:77], v77 offset:24576
    ds_read_b64_tr_b16 a[78:79], v77 offset:25088
    ds_read_b64_tr_b16 v[116:117], v78 offset:16384
    ds_read_b64_tr_b16 v[118:119], v78 offset:16896
    ds_read_b64_tr_b16 v[120:121], v78 offset:24576
    ds_read_b64_tr_b16 v[122:123], v78 offset:25088
    s_waitcnt lgkmcnt(0)
    s_barrier
    ds_write_b128 v12, v[56:59] offset:0
    ds_write_b128 v12, v[60:63] offset:1024
    ds_write_b128 v12, v[116:119] offset:2048
    ds_write_b128 v12, v[120:123] offset:3072
    s_waitcnt vmcnt(16) lgkmcnt(0)
    s_barrier
    ds_read_b64_tr_b16 a[80:81], v77 offset:32768
    ds_read_b64_tr_b16 a[82:83], v77 offset:33280
    ds_read_b64_tr_b16 a[84:85], v77 offset:40960
    ds_read_b64_tr_b16 a[86:87], v77 offset:41472
    ds_read_b64_tr_b16 v[56:57], v78 offset:32768
    ds_read_b64_tr_b16 v[58:59], v78 offset:33280
    ds_read_b64_tr_b16 v[60:61], v78 offset:40960
    ds_read_b64_tr_b16 v[62:63], v78 offset:41472
    ds_read_b64_tr_b16 a[88:89], v77 offset:49152
    ds_read_b64_tr_b16 a[90:91], v77 offset:49664
    ds_read_b64_tr_b16 a[92:93], v77 offset:57344
    ds_read_b64_tr_b16 a[94:95], v77 offset:57856
    ds_read_b64_tr_b16 v[116:117], v78 offset:49152
    ds_read_b64_tr_b16 v[118:119], v78 offset:49664
    ds_read_b64_tr_b16 v[120:121], v78 offset:57344
    ds_read_b64_tr_b16 v[122:123], v78 offset:57856
    s_waitcnt lgkmcnt(0)
    s_barrier
    ds_write_b128 v12, v[56:59] offset:32768
    ds_write_b128 v12, v[60:63] offset:33792
    ds_write_b128 v12, v[116:119] offset:34816
    ds_write_b128 v12, v[120:123] offset:35840
    s_waitcnt vmcnt(8) lgkmcnt(0)
    s_barrier
    s_waitcnt vmcnt(0)
    v_add_u32 v124, v124, v125
    s_nop 0
    v_readfirstlane_b32 s88, v124
    s_cmp_eq_u32 s88, 64
    s_cselect_b32 s88, 1, 0
    buffer_load_dword v126, v7, s[4:7], s83 offen sc1
    v_add_u32 v80, 0x10000, v77
    v_add_u32 v81, 0x10000, v78
    ds_read_b64_tr_b16 a[96:97], v80 offset:0
    ds_read_b64_tr_b16 a[98:99], v80 offset:512
    ds_read_b64_tr_b16 a[100:101], v80 offset:8192
    ds_read_b64_tr_b16 a[102:103], v80 offset:8704
    ds_read_b64_tr_b16 v[56:57], v81 offset:0
    ds_read_b64_tr_b16 v[58:59], v81 offset:512
    ds_read_b64_tr_b16 v[60:61], v81 offset:8192
    ds_read_b64_tr_b16 v[62:63], v81 offset:8704
    ds_read_b64_tr_b16 a[104:105], v80 offset:16384
    ds_read_b64_tr_b16 a[106:107], v80 offset:16896
    ds_read_b64_tr_b16 a[108:109], v80 offset:24576
    ds_read_b64_tr_b16 a[110:111], v80 offset:25088
    ds_read_b64_tr_b16 v[116:117], v81 offset:16384
    ds_read_b64_tr_b16 v[118:119], v81 offset:16896
    ds_read_b64_tr_b16 v[120:121], v81 offset:24576
    ds_read_b64_tr_b16 v[122:123], v81 offset:25088
    s_waitcnt lgkmcnt(0)
    s_barrier
    ds_write_b128 v13, v[56:59] offset:0
    ds_write_b128 v13, v[60:63] offset:1024
    ds_write_b128 v13, v[116:119] offset:2048
    ds_write_b128 v13, v[120:123] offset:3072
    s_cmp_lg_u32 s20, 0
    s_cbranch_scc1 L_pl_133
    ds_write_b128 v12, v[40:43] offset:4096
    ds_write_b128 v12, v[44:47] offset:5120
    ds_write_b128 v12, v[48:51] offset:6144
    ds_write_b128 v12, v[52:55] offset:7168
    ds_write_b128 v12, v[84:87] offset:36864
    ds_write_b128 v12, v[88:91] offset:37888
    ds_write_b128 v12, a[232:235] offset:38912
    ds_write_b128 v12, a[236:239] offset:39936
    ds_write_b128 v13, a[240:243] offset:4096
    ds_write_b128 v13, a[244:247] offset:5120
    ds_write_b128 v13, a[248:251] offset:6144
    ds_write_b128 v13, a[252:255] offset:7168
    s_waitcnt lgkmcnt(0)
    v_mov_b64 v[56:57], v[24:25]
    v_mov_b64 v[58:59], v[26:27]
    v_mov_b64 v[60:61], v[28:29]
    v_mov_b64 v[62:63], v[30:31]
    v_mov_b64 v[116:117], v[32:33]
    v_mov_b64 v[118:119], v[34:35]
    v_mov_b64 v[120:121], v[36:37]
    v_mov_b64 v[122:123], v[38:39]
    v_mov_b64 v[24:25], v[100:101]
    v_mov_b64 v[26:27], v[102:103]
    v_mov_b64 v[28:29], v[104:105]
    v_mov_b64 v[30:31], v[106:107]
    v_mov_b64 v[32:33], v[56:57]
    v_mov_b64 v[34:35], v[58:59]
    v_mov_b64 v[36:37], v[60:61]
    v_mov_b64 v[38:39], v[62:63]
    v_accvgpr_write_b32 a232, v92
    v_accvgpr_write_b32 a233, v93
    v_accvgpr_write_b32 a234, v94
    v_accvgpr_write_b32 a235, v95
    v_accvgpr_write_b32 a236, v96
    v_accvgpr_write_b32 a237, v97
    v_accvgpr_write_b32 a238, v98
    v_accvgpr_write_b32 a239, v99
    v_accvgpr_write_b32 a240, v108
    v_accvgpr_write_b32 a241, v109
    v_accvgpr_write_b32 a242, v110
    v_accvgpr_write_b32 a243, v111
    v_accvgpr_write_b32 a244, v112
    v_accvgpr_write_b32 a245, v113
    v_accvgpr_write_b32 a246, v114
    v_accvgpr_write_b32 a247, v115
    v_accvgpr_write_b32 a248, v116
    v_accvgpr_write_b32 a249, v117
    v_accvgpr_write_b32 a250, v118
    v_accvgpr_write_b32 a251, v119
    v_accvgpr_write_b32 a252, v120
    v_accvgpr_write_b32 a253, v121
    v_accvgpr_write_b32 a254, v122
    v_accvgpr_write_b32 a255, v123
L_pl_133:
    s_cmp_lg_u32 s20, 1
    s_cbranch_scc1 L_pl_134
    ds_write_b128 v12, v[84:87] offset:4096
    ds_write_b128 v12, v[88:91] offset:5120
    ds_write_b128 v12, v[92:95] offset:6144
    ds_write_b128 v12, v[96:99] offset:7168
    ds_write_b128 v12, v[100:103] offset:36864
    ds_write_b128 v12, v[104:107] offset:37888
    ds_write_b128 v12, a[224:227] offset:38912
    ds_write_b128 v12, a[228:231] offset:39936
    ds_write_b128 v13, a[240:243] offset:4096
    ds_write_b128 v13, a[244:247] offset:5120
    ds_write_b128 v13, a[248:251] offset:6144
    ds_write_b128 v13, a[252:255] offset:7168
    s_waitcnt lgkmcnt(0)
    v_mov_b64 v[56:57], v[24:25]
    v_mov_b64 v[58:59], v[26:27]
    v_mov_b64 v[60:61], v[28:29]
    v_mov_b64 v[62:63], v[30:31]
    v_mov_b64 v[116:117], v[32:33]
    v_mov_b64 v[118:119], v[34:35]
    v_mov_b64 v[120:121], v[36:37]
    v_mov_b64 v[122:123], v[38:39]
    v_mov_b64 v[24:25], v[56:57]
    v_mov_b64 v[26:27], v[58:59]
    v_mov_b64 v[28:29], v[60:61]
    v_mov_b64 v[30:31], v[62:63]
    v_mov_b64 v[32:33], v[40:41]
    v_mov_b64 v[34:35], v[42:43]
    v_mov_b64 v[36:37], v[44:45]
    v_mov_b64 v[38:39], v[46:47]
    v_accvgpr_write_b32 a224, v108
    v_accvgpr_write_b32 a225, v109
    v_accvgpr_write_b32 a226, v110
    v_accvgpr_write_b32 a227, v111
    v_accvgpr_write_b32 a228, v112
    v_accvgpr_write_b32 a229, v113
    v_accvgpr_write_b32 a230, v114
    v_accvgpr_write_b32 a231, v115
    v_accvgpr_write_b32 a240, v116
    v_accvgpr_write_b32 a241, v117
    v_accvgpr_write_b32 a242, v118
    v_accvgpr_write_b32 a243, v119
    v_accvgpr_write_b32 a244, v120
    v_accvgpr_write_b32 a245, v121
    v_accvgpr_write_b32 a246, v122
    v_accvgpr_write_b32 a247, v123
    v_accvgpr_write_b32 a248, v48
    v_accvgpr_write_b32 a249, v49
    v_accvgpr_write_b32 a250, v50
    v_accvgpr_write_b32 a251, v51
    v_accvgpr_write_b32 a252, v52
    v_accvgpr_write_b32 a253, v53
    v_accvgpr_write_b32 a254, v54
    v_accvgpr_write_b32 a255, v55
L_pl_134:
    s_cmp_lg_u32 s20, 2
    s_cbranch_scc1 L_pl_135
    ds_write_b128 v12, v[100:103] offset:4096
    ds_write_b128 v12, v[104:107] offset:5120
    ds_write_b128 v12, v[108:111] offset:6144
    ds_write_b128 v12, v[112:115] offset:7168
    ds_write_b128 v12, v[24:27] offset:36864
    ds_write_b128 v12, v[28:31] offset:37888
    ds_write_b128 v12, a[224:227] offset:38912
    ds_write_b128 v12, a[228:231] offset:39936
    ds_write_b128 v13, a[232:235] offset:4096
    ds_write_b128 v13, a[236:239] offset:5120
    ds_write_b128 v13, a[248:251] offset:6144
    ds_write_b128 v13, a[252:255] offset:7168
    s_waitcnt lgkmcnt(0)
    v_mov_b64 v[116:117], v[32:33]
    v_mov_b64 v[118:119], v[34:35]
    v_mov_b64 v[120:121], v[36:37]
    v_mov_b64 v[122:123], v[38:39]
    v_mov_b64 v[24:25], v[40:41]
    v_mov_b64 v[26:27], v[42:43]
    v_mov_b64 v[28:29], v[44:45]
    v_mov_b64 v[30:31], v[46:47]
    v_mov_b64 v[32:33], v[84:85]
    v_mov_b64 v[34:35], v[86:87]
    v_mov_b64 v[36:37], v[88:89]
    v_mov_b64 v[38:39], v[90:91]
    v_accvgpr_write_b32 a224, v116
    v_accvgpr_write_b32 a225, v117
    v_accvgpr_write_b32 a226, v118
    v_accvgpr_write_b32 a227, v119
    v_accvgpr_write_b32 a228, v120
    v_accvgpr_write_b32 a229, v121
    v_accvgpr_write_b32 a230, v122
    v_accvgpr_write_b32 a231, v123
    v_accvgpr_write_b32 a232, v48
    v_accvgpr_write_b32 a233, v49
    v_accvgpr_write_b32 a234, v50
    v_accvgpr_write_b32 a235, v51
    v_accvgpr_write_b32 a236, v52
    v_accvgpr_write_b32 a237, v53
    v_accvgpr_write_b32 a238, v54
    v_accvgpr_write_b32 a239, v55
    v_accvgpr_write_b32 a248, v92
    v_accvgpr_write_b32 a249, v93
    v_accvgpr_write_b32 a250, v94
    v_accvgpr_write_b32 a251, v95
    v_accvgpr_write_b32 a252, v96
    v_accvgpr_write_b32 a253, v97
    v_accvgpr_write_b32 a254, v98
    v_accvgpr_write_b32 a255, v99
L_pl_135:
    s_cmp_lg_u32 s20, 3
    s_cbranch_scc1 L_pl_136
    ds_write_b128 v12, v[24:27] offset:4096
    ds_write_b128 v12, v[28:31] offset:5120
    ds_write_b128 v12, v[32:35] offset:6144
    ds_write_b128 v12, v[36:39] offset:7168
    ds_write_b128 v12, v[40:43] offset:36864
    ds_write_b128 v12, v[44:47] offset:37888
    ds_write_b128 v12, a[224:227] offset:38912
    ds_write_b128 v12, a[228:231] offset:39936
    ds_write_b128 v13, a[232:235] offset:4096
    ds_write_b128 v13, a[236:239] offset:5120
    ds_write_b128 v13, a[240:243] offset:6144
    ds_write_b128 v13, a[244:247] offset:7168
    s_waitcnt lgkmcnt(0)
    v_mov_b64 v[24:25], v[84:85]
    v_mov_b64 v[26:27], v[86:87]
    v_mov_b64 v[28:29], v[88:89]
    v_mov_b64 v[30:31], v[90:91]
    v_mov_b64 v[32:33], v[100:101]
    v_mov_b64 v[34:35], v[102:103]
    v_mov_b64 v[36:37], v[104:105]
    v_mov_b64 v[38:39], v[106:107]
    v_accvgpr_write_b32 a224, v48
    v_accvgpr_write_b32 a225, v49
    v_accvgpr_write_b32 a226, v50
    v_accvgpr_write_b32 a227, v51
    v_accvgpr_write_b32 a228, v52
    v_accvgpr_write_b32 a229, v53
    v_accvgpr_write_b32 a230, v54
    v_accvgpr_write_b32 a231, v55
    v_accvgpr_write_b32 a232, v92
    v_accvgpr_write_b32 a233, v93
    v_accvgpr_write_b32 a234, v94
    v_accvgpr_write_b32 a235, v95
    v_accvgpr_write_b32 a236, v96
    v_accvgpr_write_b32 a237, v97
    v_accvgpr_write_b32 a238, v98
    v_accvgpr_write_b32 a239, v99
    v_accvgpr_write_b32 a240, v108
    v_accvgpr_write_b32 a241, v109
    v_accvgpr_write_b32 a242, v110
    v_accvgpr_write_b32 a243, v111
    v_accvgpr_write_b32 a244, v112
    v_accvgpr_write_b32 a245, v113
    v_accvgpr_write_b32 a246, v114
    v_accvgpr_write_b32 a247, v115
L_pl_136:
    s_waitcnt vmcnt(0) lgkmcnt(0)
    s_barrier
    v_readfirstlane_b32 s89, v126
    s_cmp_gt_u32 s89, 0
    s_cselect_b32 s89, 2, 1
    s_cmp_eq_u32 s88, 1
    s_cselect_b32 s88, s89, 0
    v_add_u32 v80, 0x10000, v77
    v_add_u32 v81, 0x10000, v78
    ds_read_b64_tr_b16 a[112:113], v80 offset:32768
    ds_read_b64_tr_b16 a[114:115], v80 offset:33280
    ds_read_b64_tr_b16 a[116:117], v80 offset:40960
    ds_read_b64_tr_b16 a[118:119], v80 offset:41472
    ds_read_b64_tr_b16 v[56:57], v81 offset:32768
    ds_read_b64_tr_b16 v[58:59], v81 offset:33280
    ds_read_b64_tr_b16 v[60:61], v81 offset:40960
    ds_read_b64_tr_b16 v[62:63], v81 offset:41472
    ds_read_b64_tr_b16 a[120:121], v80 offset:49152
    ds_read_b64_tr_b16 a[122:123], v80 offset:49664
    ds_read_b64_tr_b16 a[124:125], v80 offset:57344
    ds_read_b64_tr_b16 a[126:127], v80 offset:57856
    ds_read_b64_tr_b16 v[116:117], v81 offset:49152
    ds_read_b64_tr_b16 v[118:119], v81 offset:49664
    ds_read_b64_tr_b16 v[120:121], v81 offset:57344
    ds_read_b64_tr_b16 v[122:123], v81 offset:57856
    s_waitcnt lgkmcnt(0)
    s_barrier
    ds_write_b128 v13, v[56:59] offset:32768
    ds_write_b128 v13, v[60:63] offset:33792
    ds_write_b128 v13, v[116:119] offset:34816
    ds_write_b128 v13, v[120:123] offset:35840
    s_lshl_b32 s16, s22, 6
    s_add_u32 s16, s16, 0x120000
    s_mov_b32 s12, 0
    s_mov_b32 s13, 0
    s_lshl_b32 s14, s20, 11
    s_add_u32 s14, s14, 131072
    s_lshl_b32 s15, s20, 13
    s_add_u32 s15, s15, 102400
    s_mov_b32 s23, 0
    s_mov_b32 s27, 1
    s_mov_b32 s75, s90
    s_mov_b32 s73, 0x108000
    s_mov_b32 s17, s88
    s_mov_b32 s74, 0
    s_mov_b32 s65, 0
    s_mov_b32 s28, 0
    s_lshr_b32 s18, s20, 1
    s_lshl_b32 s18, s18, 8
    s_add_u32 s18, s18, 162048
    buffer_load_dword v125, off, s[76:79], 0 offset:4 sc1
    buffer_load_dword v126, off, s[76:79], 0 offset:192 sc1
    buffer_load_dword v127, off, s[76:79], 0 offset:176 sc1
    buffer_load_dword v124, v7, s[4:7], s16 offen sc1
    s_mov_b32 m0, s14
    s_nop 0
    buffer_load_dwordx4 v15, s[4:7], s64 offen offset:0 sc1 lds
    s_mov_b32 m0, s14
    s_nop 0
    buffer_load_dwordx4 v15, s[4:7], s64 offen offset:1024 sc1 lds
    s_mov_b32 m0, s15
    s_nop 0
    buffer_load_dwordx4 v15, s[4:7], s66 offen offset:0 sc1 lds
    s_mov_b32 m0, s15
    s_nop 0
    buffer_load_dwordx4 v15, s[4:7], s66 offen offset:1024 sc1 lds
    s_branch L_st0f
L_st0:
    s_sleep 3
    s_waitcnt vmcnt(7)
    buffer_load_dword v125, off, s[76:79], 0 offset:4 sc1
    s_waitcnt vmcnt(7)
    buffer_load_dword v126, off, s[76:79], 0 offset:192 sc1
    s_waitcnt vmcnt(7)
    buffer_load_dword v127, off, s[76:79], 0 offset:176 sc1
    s_waitcnt vmcnt(7)
    buffer_load_dword v124, v7, s[4:7], s16 offen sc1
    s_mov_b32 m0, s14
    s_nop 0
    buffer_load_dwordx4 v15, s[4:7], s64 offen offset:0 sc1 lds
    s_mov_b32 m0, s14
    s_nop 0
    buffer_load_dwordx4 v15, s[4:7], s64 offen offset:1024 sc1 lds
    s_mov_b32 m0, s15
    s_nop 0
    buffer_load_dwordx4 v15, s[4:7], s66 offen offset:0 sc1 lds
    s_mov_b32 m0, s15
    s_nop 0
    buffer_load_dwordx4 v15, s[4:7], s66 offen offset:1024 sc1 lds
L_st0f:
    s_add_u32 s31, s31, 1
    s_cmp_gt_u32 s31, 1048576
    s_cbranch_scc1 L_abort
    s_waitcnt vmcnt(0)
    v_add_u32 v126, v126, v127
    v_readfirstlane_b32 s70, v125
    v_readfirstlane_b32 s71, v126
    s_cmp_lg_u32 s70, 32
    s_nop 2
    s_cbranch_scc1 L_st0
    s_cmp_lg_u32 s71, 64
    s_cbranch_scc1 L_st0
    s_cmp_eq_u32 s17, 2
    s_cbranch_scc1 L_st1
    v_readlane_b32 s70, v124, 0
    s_cmp_eq_u32 s17, 0
    s_cselect_b32 s70, 0, s70
    s_cmp_gt_u32 s70, 0
    s_cselect_b32 s17, 2, 1
    s_branch L_st0
L_st1:
    s_mov_b32 s12, 1
L_fl_p1:
    v_readlane_b32 s70, v124, s12
    s_cmp_gt_u32 s70, s13
    s_cbranch_scc0 L_flr_p1
L_flok_p1:
    s_add_u32 s12, s12, 1
    s_cmp_eq_u32 s12, 3
    s_addc_u32 s13, s13, 0
    s_cmp_eq_u32 s12, 3
    s_cselect_b32 s12, 0, s12
    s_add_u32 s64, s64, 0x40000
    s_add_u32 s66, s66, 0x40000
    s_xor_b32 s14, s14, 0x2000
    s_xor_b32 s15, s15, 0x800
    v_mov_b64 v[104:105], 0
    v_mov_b64 v[106:107], 0
    v_mov_b64 v[108:109], 0
    v_mov_b64 v[110:111], 0
    v_mov_b64 v[112:113], 0
    v_mov_b64 v[114:115], 0
    v_mov_b64 v[116:117], 0
    v_mov_b64 v[118:119], 0
    v_mov_b64 v[120:121], 0
    v_mov_b64 v[122:123], 0
    v_mov_b64 v[124:125], 0
    v_mov_b64 v[126:127], 0
    s_waitcnt vmcnt(0) lgkmcnt(0)
    s_cmp_eq_u32 s20, 1
    s_cbranch_scc1 L_top_1
    s_cmp_eq_u32 s20, 2
    s_cbranch_scc1 L_top_2
    s_cmp_eq_u32 s20, 3
    s_cbranch_scc1 L_top_3
    s_branch L_top_0
.p2align 6
    s_nop 0
    s_nop 0
    s_nop 0
    s_nop 0
    s_nop 0
    s_nop 0
    s_nop 0
    s_nop 0
    s_nop 0
    s_nop 0
    s_nop 0
    s_nop 0
L_top_0:
    s_mov_b32 s19, s24
    buffer_load_dwordx4 v[72:75], v15, s[4:7], s19 offen offset:0 sc1
    buffer_load_dwordx4 v[76:79], v15, s[4:7], s19 offen offset:1024 sc1
    ds_read_b128 v[40:43], v12 offset:4096
    ds_read_b128 v[44:47], v12 offset:5120
    ds_read_b128 v[48:51], v12 offset:0
    ds_read_b128 v[52:55], v12 offset:1024
    ds_read_b128 v[56:59], v12 offset:6144
    ds_read_b128 v[60:63], v12 offset:7168
    ds_read_b128 v[64:67], v12 offset:2048
    ds_read_b128 v[68:71], v12 offset:3072
    s_mov_b32 s24, s30
    s_add_u32 s30, s30, 8192
    s_cmp_eq_u32 s30, 0x106000
    s_cselect_b32 s30, 0x100000, s30
    s_nop 15
    buffer_load_dwordx4 v[96:99], v15, s[4:7], s19 offen offset:0 sc1
    buffer_load_dwordx4 v[84:87], v15, s[4:7], s19 offen offset:1024 sc1
    s_waitcnt vmcnt(3)
    ds_write_b128 v2, v[72:75] offset:0
    s_waitcnt vmcnt(2)
    ds_write_b128 v2, v[76:79] offset:1024
    v_max3_u32 v92, v72, v73, v74
    v_max3_u32 v93, v75, v76, v77
    v_max3_u32 v94, v92, v93, v78
    v_max_u32 v95, v94, v79
    v_cmp_eq_u32 vcc, -1, v95
    s_cbranch_vccnz L_t1r_0_0
L_t1ok_0_0:
    s_waitcnt lgkmcnt(8)
    v_smfmac_f32_16x16x64_bf16 v[112:115], v[72:75], v[40:47], v10
    ds_read_b128 v[40:43], v12 offset:36864
    ds_read_b128 v[44:47], v12 offset:37888
    s_waitcnt lgkmcnt(8)
    v_smfmac_f32_16x16x64_bf16 v[116:119], v[72:75], v[48:55], v10
    ds_read_b128 v[48:51], v12 offset:32768
    ds_read_b128 v[52:55], v12 offset:33792
    v_smfmac_f32_16x16x64_bf16 v[104:107], v[72:75], a[0:7], v10
    v_smfmac_f32_16x16x64_bf16 v[108:111], v[72:75], a[64:71], v10
    v_smfmac_f32_16x16x64_bf16 v[120:123], v[72:75], v[128:135], v10
    v_smfmac_f32_16x16x64_bf16 v[124:127], v[72:75], v[136:143], v10
    s_add_u32 s67, s67, 0x20000
    s_add_u32 s68, s68, 0x10000
    s_waitcnt lgkmcnt(4)
    s_barrier
    ds_read_b128 v[80:83], v2 offset:2048
    v_smfmac_f32_16x16x64_bf16 v[120:123], v[76:79], v[144:151], v10
    ds_read_b128 v[88:91], v2 offset:4096
    s_waitcnt vmcnt(1)
    ds_read_b128 v[96:99], v2 offset:6144
    v_smfmac_f32_16x16x64_bf16 v[124:127], v[76:79], v[152:159], v10
    s_waitcnt vmcnt(0)
    ds_read_b128 v[84:87], v2 offset:3072
    ds_read_b128 v[92:95], v2 offset:5120
    v_smfmac_f32_16x16x64_bf16 v[112:115], v[76:79], v[56:63], v10
    ds_read_b128 v[100:103], v2 offset:7168
    ds_read_b128 v[56:59], v13 offset:0
    s_mov_b32 m0, s14
    s_nop 0
    buffer_load_dwordx4 v15, s[4:7], s64 offen offset:0 sc1 lds
    v_smfmac_f32_16x16x64_bf16 v[116:119], v[76:79], v[64:71], v10
    ds_read_b128 v[60:63], v13 offset:1024
    ds_read_b128 v[64:67], v13 offset:32768
    v_smfmac_f32_16x16x64_bf16 v[104:107], v[76:79], a[8:15], v10
    ds_read_b128 v[68:71], v13 offset:33792
    v_smfmac_f32_16x16x64_bf16 v[108:111], v[76:79], a[72:79], v10
    s_waitcnt lgkmcnt(9)
    v_smfmac_f32_16x16x64_bf16 v[112:115], v[80:83], v[40:47], v10
    ds_read_b128 v[40:43], v12 offset:34816
    ds_read_b128 v[44:47], v12 offset:35840
    s_mov_b32 m0, s14
    s_nop 0
    buffer_load_dwordx4 v15, s[4:7], s64 offen offset:1024 sc1 lds
    v_smfmac_f32_16x16x64_bf16 v[116:119], v[80:83], v[48:55], v10
    ds_read_b128 v[48:51], v13 offset:2048
    ds_read_b128 v[52:55], v13 offset:3072
    v_smfmac_f32_16x16x64_bf16 v[104:107], v[80:83], a[16:23], v10
    v_smfmac_f32_16x16x64_bf16 v[108:111], v[80:83], a[80:87], v10
    s_waitcnt lgkmcnt(12)
    v_smfmac_f32_16x16x64_bf16 v[112:115], v[88:91], v[24:31], v10
    s_mov_b32 m0, s15
    s_nop 0
    buffer_load_dwordx4 v15, s[4:7], s66 offen offset:0 sc1 lds
    s_waitcnt lgkmcnt(6)
    v_smfmac_f32_16x16x64_bf16 v[116:119], v[88:91], v[56:63], v10
    ds_read_b128 v[56:59], v13 offset:34816
    ds_read_b128 v[60:63], v13 offset:35840
    v_smfmac_f32_16x16x64_bf16 v[104:107], v[88:91], a[32:39], v10
    v_smfmac_f32_16x16x64_bf16 v[108:111], v[88:91], a[96:103], v10
    v_smfmac_f32_16x16x64_bf16 v[112:115], v[96:99], v[32:39], v10
    s_mov_b32 m0, s15
    s_nop 0
    buffer_load_dwordx4 v15, s[4:7], s66 offen offset:1024 sc1 lds
    s_waitcnt lgkmcnt(6)
    v_smfmac_f32_16x16x64_bf16 v[116:119], v[96:99], v[64:71], v10
    v_smfmac_f32_16x16x64_bf16 v[104:107], v[96:99], a[48:55], v10
    v_smfmac_f32_16x16x64_bf16 v[108:111], v[96:99], a[112:119], v10
    v_smfmac_f32_16x16x64_bf16 v[112:115], v[84:87], a[232:239], v10
    v_smfmac_f32_16x16x64_bf16 v[104:107], v[84:87], a[24:31], v10
    v_smfmac_f32_16x16x64_bf16 v[112:115], v[92:95], a[240:247], v10
    v_smfmac_f32_16x16x64_bf16 v[104:107], v[92:95], a[40:47], v10
    v_smfmac_f32_16x16x64_bf16 v[112:115], v[100:103], a[248:255], v10
    v_xor_b32 v0, 16, v3
    v_smfmac_f32_16x16x64_bf16 v[104:107], v[100:103], a[56:63], v10
    s_waitcnt lgkmcnt(4)
    v_smfmac_f32_16x16x64_bf16 v[116:119], v[84:87], v[40:47], v10
    v_smfmac_f32_16x16x64_bf16 v[108:111], v[84:87], a[88:95], v10
    s_waitcnt lgkmcnt(2)
    v_smfmac_f32_16x16x64_bf16 v[116:119], v[92:95], v[48:55], v10
    v_smfmac_f32_16x16x64_bf16 v[108:111], v[92:95], a[104:111], v10
    s_nop 1
    v_permlane32_swap_b32 v104, v112
    s_waitcnt lgkmcnt(0)
    v_smfmac_f32_16x16x64_bf16 v[116:119], v[100:103], v[56:63], v10
    v_permlane32_swap_b32 v105, v113
    v_smfmac_f32_16x16x64_bf16 v[108:111], v[100:103], a[120:127], v10
    v_permlane32_swap_b32 v106, v114
    v_permlane32_swap_b32 v107, v115
    v_add_f32 v104, v104, v112
    v_add_f32 v105, v105, v113
    v_add_f32 v106, v106, v114
    v_add_f32 v107, v107, v115
    v_mul_f32 v104, s69, v104
    v_mul_f32 v105, s69, v105
    v_mul_f32 v106, s69, v106
    v_mul_f32 v107, s69, v107
    v_cvt_pk_bf16_f32 v104, v104, v105
    v_cvt_pk_bf16_f32 v105, v106, v107
    ds_write_b64 v3, v[104:105]
    v_permlane32_swap_b32 v108, v116
    v_permlane32_swap_b32 v109, v117
    v_permlane32_swap_b32 v110, v118
    v_permlane32_swap_b32 v111, v119
    v_add_f32 v108, v108, v116
    v_add_f32 v109, v109, v117
    v_add_f32 v110, v110, v118
    v_add_f32 v111, v111, v119
    v_cvt_pk_bf16_f32 v108, v108, v109
    v_cvt_pk_bf16_f32 v109, v110, v111
    ds_write_b64 v0, v[108:109]
    v_smfmac_f32_16x16x64_bf16 v[120:123], v[80:83], v[160:167], v10
    ds_read_b128 v[40:43], v14 offset:0
    ds_read_b128 v[44:47], v14 offset:4096
    v_mov_b32 v72, v11
    v_smfmac_f32_16x16x64_bf16 v[124:127], v[80:83], v[168:175], v10
    ds_read_b128 v[48:51], v14 offset:1024
    ds_read_b128 v[52:55], v14 offset:5120
    v_mov_b32 v73, v11
    v_smfmac_f32_16x16x64_bf16 v[120:123], v[84:87], v[176:183], v10
    ds_read_b128 v[56:59], v14 offset:2048
    ds_read_b128 v[60:63], v14 offset:6144
    v_mov_b32 v74, v11
    v_smfmac_f32_16x16x64_bf16 v[124:127], v[84:87], v[184:191], v10
    ds_read_b128 v[64:67], v14 offset:3072
    ds_read_b128 v[68:71], v14 offset:7168
    v_mov_b32 v75, v11
    v_smfmac_f32_16x16x64_bf16 v[120:123], v[88:91], v[192:199], v10
    v_smfmac_f32_16x16x64_bf16 v[124:127], v[88:91], v[200:207], v10
    s_waitcnt lgkmcnt(8)
    s_barrier
    ds_read_b64_tr_b16 v[104:105], v4 offset:0
    ds_read_b64_tr_b16 v[106:107], v4 offset:512
    v_smfmac_f32_16x16x64_bf16 v[120:123], v[92:95], v[208:215], v10
    ds_read_b64_tr_b16 v[108:109], v4 offset:1024
    ds_read_b64_tr_b16 v[110:111], v4 offset:1536
    v_smfmac_f32_16x16x64_bf16 v[124:127], v[92:95], v[216:223], v10
    ds_read_b64_tr_b16 v[112:113], v4 offset:2048
    ds_read_b64_tr_b16 v[114:115], v4 offset:2560
    v_smfmac_f32_16x16x64_bf16 v[120:123], v[96:99], v[224:231], v10
    ds_read_b64_tr_b16 v[116:117], v4 offset:3072
    ds_read_b64_tr_b16 v[118:119], v4 offset:3584
    v_smfmac_f32_16x16x64_bf16 v[124:127], v[96:99], v[232:239], v10
    v_smfmac_f32_16x16x64_bf16 v[120:123], v[100:103], v[240:247], v10
    v_smfmac_f32_16x16x64_bf16 v[124:127], v[100:103], v[248:255], v10
    s_xor_b32 s70, s15, 0x800
    s_waitcnt lgkmcnt(6)
    v_mfma_f32_16x16x32_bf16 v[72:75], v[104:107], v[104:107], v[72:75]
    v_add_u32 v0, s70, v1
    v_xor_b32 v14, 0x2000, v14
    v_mfma_f32_16x16x32_bf16 v[80:83], v[40:43], v[104:107], 0
    ds_read_b128 v[88:91], v0
    ds_read_b128 v[92:95], v0 offset:1024
    s_cmp_ge_u32 s23, 62
    v_mfma_f32_16x16x32_bf16 v[84:87], v[44:47], v[104:107], 0
    v_add_u32 v0, 162560, v7
    s_waitcnt lgkmcnt(6)
    v_mfma_f32_16x16x32_bf16 v[72:75], v[108:111], v[108:111], v[72:75]
    v_permlane32_swap_b32 v120, v124
    v_mfma_f32_16x16x32_bf16 v[80:83], v[48:51], v[108:111], v[80:83]
    v_permlane32_swap_b32 v121, v125
    v_mfma_f32_16x16x32_bf16 v[84:87], v[52:55], v[108:111], v[84:87]
    v_permlane32_swap_b32 v122, v126
    s_waitcnt lgkmcnt(4)
    v_mfma_f32_16x16x32_bf16 v[72:75], v[112:115], v[112:115], v[72:75]
    v_permlane32_swap_b32 v123, v127
    v_mfma_f32_16x16x32_bf16 v[80:83], v[56:59], v[112:115], v[80:83]
    v_add_f32 v120, v120, v124
    v_add_f32 v121, v121, v125
    v_mfma_f32_16x16x32_bf16 v[84:87], v[60:63], v[112:115], v[84:87]
    v_add_f32 v122, v122, v126
    v_add_f32 v123, v123, v127
    s_waitcnt lgkmcnt(2)
    v_mfma_f32_16x16x32_bf16 v[72:75], v[116:119], v[116:119], v[72:75]
    v_cvt_pk_bf16_f32 v96, v120, v121
    v_cvt_pk_bf16_f32 v97, v122, v123
    v_mfma_f32_16x16x32_bf16 v[80:83], v[64:67], v[116:119], v[80:83]
    v_mov_b64 v[98:99], v[96:97]
    v_min_u32 v20, -2, v96
    v_mfma_f32_16x16x32_bf16 v[84:87], v[68:71], v[116:119], v[84:87]
    v_min_u32 v21, -2, v97
    v_permlane32_swap_b32 v96, v98
    v_permlane32_swap_b32 v97, v99
    ds_write_b64 v0, v[20:21]
    s_cbranch_scc1 L_early_0
L_t5_0:
    v_exp_f32 v72, v72
    v_exp_f32 v73, v73
    v_exp_f32 v74, v74
    v_exp_f32 v75, v75
    v_cvt_pk_bf16_f32 v76, v72, v73
    v_cvt_pk_bf16_f32 v77, v74, v75
    v_exp_f32 v80, v80
    v_exp_f32 v81, v81
    v_mfma_f32_16x16x16_bf16 v[120:123], v[96:97], v[76:77], 0
    v_exp_f32 v82, v82
    v_exp_f32 v83, v83
    v_mfma_f32_16x16x16_bf16 v[72:75], v[22:23], v[76:77], 0
    v_cvt_pk_bf16_f32 v124, v80, v81
    v_cvt_pk_bf16_f32 v125, v82, v83
    v_exp_f32 v84, v84
    v_mfma_f32_16x16x16_bf16 v[80:83], v[98:99], v[76:77], 0
    v_exp_f32 v85, v85
    v_exp_f32 v86, v86
    v_mfma_f32_16x16x16_bf16 v[72:75], v[22:23], v[124:125], v[72:75]
    v_exp_f32 v87, v87
    v_cvt_pk_bf16_f32 v126, v84, v85
    v_cvt_pk_bf16_f32 v127, v86, v87
    s_nop 1
    v_mfma_f32_16x16x16_bf16 v[72:75], v[22:23], v[126:127], v[72:75]
    s_waitcnt lgkmcnt(2)
    v_mfma_f32_16x16x32_bf16 v[120:123], v[88:91], v[124:127], v[120:123]
    s_waitcnt lgkmcnt(1)
    v_mfma_f32_16x16x32_bf16 v[80:83], v[92:95], v[124:127], v[80:83]
L_t7_0:
    s_mov_b32 exec_lo, 0x00ff00ff
    s_mov_b32 exec_hi, 0x00ff00ff
    s_nop 1
    v_rcp_f32 v102, v72
    v_subrev_u32 v101, 0x21800000, v72
    v_cmp_lt_u32 vcc, 0x3c000000, v101
    v_mul_f32 v120, v120, v102
    v_mul_f32 v121, v121, v102
    v_mul_f32 v122, v122, v102
    v_mul_f32 v123, v123, v102
    v_cvt_pk_bf16_f32 v76, v120, v121
    v_cvt_pk_bf16_f32 v77, v122, v123
    v_pk_mul_f32 v[80:81], v[80:81], v[102:103] op_sel_hi:[1,0]
    v_pk_mul_f32 v[82:83], v[82:83], v[102:103] op_sel_hi:[1,0]
    v_cvt_pk_bf16_f32 v78, v80, v81
    v_cvt_pk_bf16_f32 v79, v82, v83
    ds_write_b128 v5, v[76:79]
    s_mov_b64 exec, -1
    v_mov_b64 v[84:85], 0
    v_mov_b64 v[86:87], 0
    v_mov_b32_dpp v76, v76 row_shr:8 row_mask:0xf bank_mask:0xc
    v_mov_b32_dpp v77, v77 row_shr:8 row_mask:0xf bank_mask:0xc
    v_mov_b32_dpp v78, v78 row_shr:8 row_mask:0xf bank_mask:0xc
    v_mov_b32_dpp v79, v79 row_shr:8 row_mask:0xf bank_mask:0xc
    v_mov_b64 v[72:73], 0
    v_mov_b64 v[74:75], 0
    v_smfmac_f32_16x16x64_bf16 v[84:87], v[76:79], a[128:135], v10
    v_mov_b64 v[80:81], 0
    v_mov_b64 v[82:83], 0
    v_smfmac_f32_16x16x64_bf16 v[72:75], v[76:79], a[160:167], v10
    v_mov_b64 v[120:121], 0
    v_mov_b64 v[122:123], 0
    v_smfmac_f32_16x16x64_bf16 v[80:83], v[76:79], a[192:199], v10
    s_cbranch_vccnz L_safe_0
L_t7ok_0:
    s_waitcnt lgkmcnt(0)
    s_barrier
    ds_read_b128 v[92:95], v6 offset:64
    ds_read_b128 v[96:99], v6 offset:128
    ds_read_b128 v[100:103], v6 offset:192
    v_smfmac_f32_16x16x64_bf16 v[120:123], v[76:79], a[224:231], v10
    s_add_u32 s64, s64, 0x40000
    s_add_u32 s66, s66, 0x40000
    s_xor_b32 s14, s14, 0x2000
    s_xor_b32 s15, s15, 0x800
    s_mov_b32 s65, 0
    ds_read_b128 v[40:43], v12 offset:38912
    ds_read_b128 v[44:47], v12 offset:39936
    s_waitcnt lgkmcnt(4)
    v_smfmac_f32_16x16x64_bf16 v[84:87], v[92:95], a[136:143], v10
    s_waitcnt lgkmcnt(3)
    v_smfmac_f32_16x16x64_bf16 v[84:87], v[96:99], a[144:151], v10
    s_waitcnt lgkmcnt(2)
    v_smfmac_f32_16x16x64_bf16 v[84:87], v[100:103], a[152:159], v10
    ds_read_b128 v[48:51], v13 offset:4096
    v_smfmac_f32_16x16x64_bf16 v[72:75], v[92:95], a[168:175], v10
    ds_read_b128 v[52:55], v13 offset:5120
    v_smfmac_f32_16x16x64_bf16 v[72:75], v[96:99], a[176:183], v10
    ds_read_b128 v[56:59], v13 offset:6144
    s_nop 2
    v_cvt_pk_bf16_f32 v76, v84, v85
    v_smfmac_f32_16x16x64_bf16 v[72:75], v[100:103], a[184:191], v10
    ds_read_b128 v[60:63], v13 offset:7168
    v_cvt_pk_bf16_f32 v77, v86, v87
    v_smfmac_f32_16x16x64_bf16 v[80:83], v[92:95], a[200:207], v10
    v_and_or_b32 v76, v76, -2, s27
    v_smfmac_f32_16x16x64_bf16 v[80:83], v[96:99], a[208:215], v10
    v_and_or_b32 v77, v77, -2, s27
    buffer_store_dwordx2 v[76:77], v7, s[4:7], s29 offen offset:0
    v_smfmac_f32_16x16x64_bf16 v[80:83], v[100:103], a[216:223], v10
    v_cvt_pk_bf16_f32 v78, v72, v73
    v_cvt_pk_bf16_f32 v79, v74, v75
    s_waitcnt lgkmcnt(4)
    v_smfmac_f32_16x16x64_bf16 v[120:123], v[92:95], v[40:47], v10
    v_and_or_b32 v78, v78, -2, s27
    v_and_or_b32 v79, v79, -2, s27
    buffer_store_dwordx2 v[78:79], v7, s[4:7], s29 offen offset:512
    s_waitcnt lgkmcnt(2)
    v_smfmac_f32_16x16x64_bf16 v[120:123], v[96:99], v[48:55], v10
    s_waitcnt lgkmcnt(0)
    v_smfmac_f32_16x16x64_bf16 v[120:123], v[100:103], v[56:63], v10
    v_cvt_pk_bf16_f32 v84, v80, v81
    v_cvt_pk_bf16_f32 v85, v82, v83
    v_and_or_b32 v84, v84, -2, s27
    v_and_or_b32 v85, v85, -2, s27
    buffer_store_dwordx2 v[84:85], v7, s[4:7], s29 offen offset:1024
    s_nop 2
    v_cvt_pk_bf16_f32 v86, v120, v121
    v_cvt_pk_bf16_f32 v87, v122, v123
    v_and_or_b32 v86, v86, -2, s27
    v_and_or_b32 v87, v87, -2, s27
    buffer_store_dwordx2 v[86:87], v7, s[4:7], s29 offen offset:1536
    s_mov_b32 s17, 0
    v_mov_b32 v60, -1
    buffer_store_dword v60, v9, s[4:7], s30 offen
    s_nop 15
    s_nop 15
    s_nop 11
    buffer_load_dwordx4 v[72:75], v8, s[4:7], s25 offen sc1
    buffer_load_dwordx4 v[76:79], v8, s[4:7], s26 offen sc1
    buffer_load_dwordx4 v[80:83], v8, s[4:7], s2 offen sc1
    buffer_load_dwordx4 v[84:87], v8, s[4:7], s3 offen sc1
    v_mov_b64 v[104:105], 0
    v_mov_b64 v[106:107], 0
    v_mov_b64 v[108:109], 0
    v_mov_b64 v[110:111], 0
    v_mov_b64 v[112:113], 0
    v_mov_b64 v[114:115], 0
    v_mov_b64 v[116:117], 0
    v_mov_b64 v[118:119], 0
    v_mov_b64 v[120:121], 0
    v_mov_b64 v[122:123], 0
    v_mov_b64 v[124:125], 0
    v_mov_b64 v[126:127], 0
    s_nop 15
    s_nop 7
    buffer_load_dwordx4 v[88:91], v8, s[4:7], s25 offen sc1
    buffer_load_dwordx4 v[92:95], v8, s[4:7], s26 offen sc1
    buffer_load_dwordx4 v[96:99], v8, s[4:7], s2 offen sc1
    buffer_load_dwordx4 v[100:103], v8, s[4:7], s3 offen sc1
    s_waitcnt vmcnt(7)
    v_mfma_f32_16x16x32_bf16 v[48:51], v[16:19], v[72:75], 0
    v_bitop3_b32 v56, v72, v73, s28 bitop3:0x42
    v_bitop3_b32 v57, v74, v75, s28 bitop3:0x42
    s_waitcnt vmcnt(6)
    v_mfma_f32_16x16x32_bf16 v[48:51], v[16:19], v[76:79], v[48:51]
    v_bitop3_b32 v58, v76, v77, s28 bitop3:0x42
    v_bitop3_b32 v59, v78, v79, s28 bitop3:0x42
    v_bitop3_b32 v56, v56, v57, v58 bitop3:0x80
    s_waitcnt vmcnt(5)
    v_mfma_f32_16x16x32_bf16 v[48:51], v[16:19], v[80:83], v[48:51]
    v_bitop3_b32 v60, v80, v81, s28 bitop3:0x42
    v_bitop3_b32 v61, v82, v83, s28 bitop3:0x42
    v_bitop3_b32 v57, v59, v60, v61 bitop3:0x80
    s_waitcnt vmcnt(4)
    v_mfma_f32_16x16x32_bf16 v[48:51], v[16:19], v[84:87], v[48:51]
    v_bitop3_b32 v62, v84, v85, s28 bitop3:0x42
    v_bitop3_b32 v63, v86, v87, s28 bitop3:0x42
    v_bitop3_b32 v56, v56, v57, 1 bitop3:0x80
    v_bitop3_b32 v56, v56, v62, v63 bitop3:0x80
    v_cmp_eq_u32 vcc, 0, v56
L_t9f_0:
    s_nop 2
    v_add_f32_dpp v52, v48, v48 row_ror:8 row_mask:0xf bank_mask:0x3
    v_add_f32_dpp v53, v50, v50 row_ror:8 row_mask:0xf bank_mask:0x3
    v_add_f32_dpp v52, v49, v49 row_ror:8 row_mask:0xf bank_mask:0xc
    v_add_f32_dpp v53, v51, v51 row_ror:8 row_mask:0xf bank_mask:0xc
    s_cbranch_vccnz L_t9s_0
    s_nop 0
    v_permlane16_swap_b32 v52, v53
    v_cvt_pk_bf16_f32 v52, v52, v53
    v_min_u32 v52, -2, v52
    buffer_store_dword v52, v9, s[4:7], s24 offen
    s_add_u32 s23, s23, 1
    s_xor_b32 s27, s27, 1
    s_not_b32 s28, s28
    s_barrier
    s_nop 15
    s_branch L_top_0
.p2align 6
    s_nop 0
    s_nop 0
    s_nop 0
    s_nop 0
    s_nop 0
    s_nop 0
    s_nop 0
    s_nop 0
    s_nop 0
    s_nop 0
    s_nop 0
    s_nop 0
L_top_1:
    s_mov_b32 s19, s24
    buffer_load_dwordx4 v[80:83], v15, s[4:7], s19 offen offset:0 sc1
    buffer_load_dwordx4 v[84:87], v15, s[4:7], s19 offen offset:1024 sc1
    ds_read_b64_tr_b16 v[88:89], v4 offset:0
    ds_read_b64_tr_b16 v[90:91], v4 offset:512
    ds_read_b64_tr_b16 v[96:97], v4 offset:1024
    ds_read_b64_tr_b16 v[98:99], v4 offset:1536
    v_add_u32 v0, 162560, v7
    ds_read_b64 v[76:77], v0
    ds_read_b128 v[40:43], v12 offset:4096
    ds_read_b128 v[44:47], v12 offset:5120
    ds_read_b128 v[48:51], v12 offset:32768
    ds_read_b128 v[52:55], v12 offset:33792
    ds_read_b128 v[56:59], v12 offset:6144
    ds_read_b128 v[60:63], v12 offset:7168
    ds_read_b128 v[64:67], v12 offset:34816
    ds_read_b128 v[68:71], v12 offset:35840
    s_waitcnt lgkmcnt(12)
    v_min_u32 v88, -2, v88
    v_min_u32 v89, -2, v89
    s_waitcnt lgkmcnt(11)
    v_min_u32 v90, -2, v90
    v_min_u32 v91, -2, v91
    s_waitcnt lgkmcnt(10)
    v_min_u32 v96, -2, v96
    v_min_u32 v97, -2, v97
    s_waitcnt lgkmcnt(9)
    v_min_u32 v98, -2, v98
    v_min_u32 v99, -2, v99
    s_mov_b32 s24, s30
    s_add_u32 s30, s30, 8192
    s_cmp_eq_u32 s30, 0x106000
    s_cselect_b32 s30, 0x100000, s30
    s_nop 15
    buffer_load_dwordx4 v[72:75], v15, s[4:7], s19 offen offset:0 sc1
    buffer_load_dwordx4 v[92:95], v15, s[4:7], s19 offen offset:1024 sc1
    s_waitcnt vmcnt(3)
    ds_write_b128 v2, v[80:83] offset:2048
    s_waitcnt vmcnt(2)
    ds_write_b128 v2, v[84:87] offset:3072
    v_max3_u32 v100, v80, v81, v82
    v_max3_u32 v101, v83, v84, v85
    v_max3_u32 v102, v100, v101, v86
    v_max_u32 v103, v102, v87
    v_cmp_eq_u32 vcc, -1, v103
    s_cbranch_vccnz L_t1r_1_0
L_t1ok_1_0:
    s_waitcnt lgkmcnt(8)
    v_smfmac_f32_16x16x64_bf16 v[112:115], v[80:83], v[40:47], v10
    ds_read_b128 v[40:43], v12 offset:36864
    ds_read_b128 v[44:47], v12 offset:37888
    buffer_store_dwordx4 v[88:91], v1, s[4:7], s67 offen offset:0 sc1
    s_waitcnt lgkmcnt(8)
    v_smfmac_f32_16x16x64_bf16 v[116:119], v[80:83], v[48:55], v10
    ds_read_b128 v[48:51], v13 offset:0
    ds_read_b128 v[52:55], v13 offset:1024
    buffer_store_dwordx4 v[96:99], v1, s[4:7], s67 offen offset:1024 sc1
    v_smfmac_f32_16x16x64_bf16 v[104:107], v[80:83], a[16:23], v10
    buffer_store_dwordx2 v[76:77], v7, s[4:7], s68 offen offset:0 sc1
    v_smfmac_f32_16x16x64_bf16 v[108:111], v[80:83], a[80:87], v10
    buffer_store_dwordx2 v[20:21], v7, s[4:7], s68 offen offset:512 sc1
    v_smfmac_f32_16x16x64_bf16 v[120:123], v[80:83], v[160:167], v10
    v_smfmac_f32_16x16x64_bf16 v[124:127], v[80:83], v[168:175], v10
    s_add_u32 s67, s67, 0x20000
    s_add_u32 s68, s68, 0x10000
    s_waitcnt lgkmcnt(4)
    s_barrier
    ds_read_b128 v[88:91], v2 offset:4096
    v_smfmac_f32_16x16x64_bf16 v[120:123], v[84:87], v[176:183], v10
    ds_read_b128 v[96:99], v2 offset:6144
    s_waitcnt vmcnt(5)
    ds_read_b128 v[72:75], v2 offset:0
    v_smfmac_f32_16x16x64_bf16 v[124:127], v[84:87], v[184:191], v10
    s_waitcnt vmcnt(4)
    ds_read_b128 v[92:95], v2 offset:5120
    ds_read_b128 v[100:103], v2 offset:7168
    v_smfmac_f32_16x16x64_bf16 v[112:115], v[84:87], v[56:63], v10
    ds_read_b128 v[76:79], v2 offset:1024
    ds_read_b128 v[56:59], v13 offset:32768
    v_smfmac_f32_16x16x64_bf16 v[116:119], v[84:87], v[64:71], v10
    ds_read_b128 v[60:63], v13 offset:33792
    ds_read_b128 v[64:67], v12 offset:0
    s_mov_b32 m0, s14
    s_nop 0
    buffer_load_dwordx4 v15, s[4:7], s64 offen offset:0 sc1 lds
    v_smfmac_f32_16x16x64_bf16 v[104:107], v[84:87], a[24:31], v10
    ds_read_b128 v[68:71], v12 offset:1024
    v_smfmac_f32_16x16x64_bf16 v[108:111], v[84:87], a[88:95], v10
    s_waitcnt lgkmcnt(9)
    v_smfmac_f32_16x16x64_bf16 v[112:115], v[88:91], v[40:47], v10
    ds_read_b128 v[40:43], v13 offset:2048
    ds_read_b128 v[44:47], v13 offset:3072
    v_smfmac_f32_16x16x64_bf16 v[116:119], v[88:91], v[48:55], v10
    ds_read_b128 v[48:51], v13 offset:34816
    ds_read_b128 v[52:55], v13 offset:35840
    s_mov_b32 m0, s14
    s_nop 0
    buffer_load_dwordx4 v15, s[4:7], s64 offen offset:1024 sc1 lds
    v_smfmac_f32_16x16x64_bf16 v[104:107], v[88:91], a[32:39], v10
    v_smfmac_f32_16x16x64_bf16 v[108:111], v[88:91], a[96:103], v10
    s_waitcnt lgkmcnt(12)
    v_smfmac_f32_16x16x64_bf16 v[112:115], v[96:99], v[24:31], v10
    s_waitcnt lgkmcnt(6)
    v_smfmac_f32_16x16x64_bf16 v[116:119], v[96:99], v[56:63], v10
    ds_read_b128 v[56:59], v12 offset:2048
    ds_read_b128 v[60:63], v12 offset:3072
    s_mov_b32 m0, s15
    s_nop 0
    buffer_load_dwordx4 v15, s[4:7], s66 offen offset:0 sc1 lds
    v_smfmac_f32_16x16x64_bf16 v[104:107], v[96:99], a[48:55], v10
    v_smfmac_f32_16x16x64_bf16 v[108:111], v[96:99], a[112:119], v10
    v_smfmac_f32_16x16x64_bf16 v[112:115], v[72:75], v[32:39], v10
    s_waitcnt lgkmcnt(6)
    v_smfmac_f32_16x16x64_bf16 v[116:119], v[72:75], v[64:71], v10
    s_mov_b32 m0, s15
    s_nop 0
    buffer_load_dwordx4 v15, s[4:7], s66 offen offset:1024 sc1 lds
    v_smfmac_f32_16x16x64_bf16 v[104:107], v[72:75], a[0:7], v10
    v_smfmac_f32_16x16x64_bf16 v[108:111], v[72:75], a[64:71], v10
    v_smfmac_f32_16x16x64_bf16 v[112:115], v[92:95], a[224:231], v10
    v_smfmac_f32_16x16x64_bf16 v[104:107], v[92:95], a[40:47], v10
    s_mov_b32 m0, s18
    s_nop 0
    buffer_load_dword v7, s[4:7], s16 offen sc1 lds
    v_smfmac_f32_16x16x64_bf16 v[112:115], v[100:103], a[240:247], v10
    v_smfmac_f32_16x16x64_bf16 v[104:107], v[100:103], a[56:63], v10
    v_smfmac_f32_16x16x64_bf16 v[112:115], v[76:79], a[248:255], v10
    v_xor_b32 v0, 16, v3
    v_smfmac_f32_16x16x64_bf16 v[104:107], v[76:79], a[8:15], v10
    s_waitcnt lgkmcnt(4)
    v_smfmac_f32_16x16x64_bf16 v[116:119], v[92:95], v[40:47], v10
    v_smfmac_f32_16x16x64_bf16 v[108:111], v[92:95], a[104:111], v10
    s_waitcnt lgkmcnt(2)
    v_smfmac_f32_16x16x64_bf16 v[116:119], v[100:103], v[48:55], v10
    v_smfmac_f32_16x16x64_bf16 v[108:111], v[100:103], a[120:127], v10
    s_nop 1
    v_permlane32_swap_b32 v104, v112
    s_waitcnt lgkmcnt(0)
    v_smfmac_f32_16x16x64_bf16 v[116:119], v[76:79], v[56:63], v10
    v_permlane32_swap_b32 v105, v113
    v_smfmac_f32_16x16x64_bf16 v[108:111], v[76:79], a[72:79], v10
    v_permlane32_swap_b32 v106, v114
    v_permlane32_swap_b32 v107, v115
    v_add_f32 v104, v104, v112
    v_add_f32 v105, v105, v113
    v_add_f32 v106, v106, v114
    v_add_f32 v107, v107, v115
    v_mul_f32 v104, s69, v104
    v_mul_f32 v105, s69, v105
    v_mul_f32 v106, s69, v106
    v_mul_f32 v107, s69, v107
    v_cvt_pk_bf16_f32 v104, v104, v105
    v_cvt_pk_bf16_f32 v105, v106, v107
    ds_write_b64 v3, v[104:105]
    v_permlane32_swap_b32 v108, v116
    v_permlane32_swap_b32 v109, v117
    v_permlane32_swap_b32 v110, v118
    v_permlane32_swap_b32 v111, v119
    v_add_f32 v108, v108, v116
    v_add_f32 v109, v109, v117
    v_add_f32 v110, v110, v118
    v_add_f32 v111, v111, v119
    v_cvt_pk_bf16_f32 v108, v108, v109
    v_cvt_pk_bf16_f32 v109, v110, v111
    ds_write_b64 v0, v[108:109]
    v_smfmac_f32_16x16x64_bf16 v[120:123], v[72:75], v[128:135], v10
    ds_read_b128 v[40:43], v14 offset:0
    ds_read_b128 v[44:47], v14 offset:4096
    v_smfmac_f32_16x16x64_bf16 v[124:127], v[72:75], v[136:143], v10
    ds_read_b128 v[48:51], v14 offset:1024
    ds_read_b128 v[52:55], v14 offset:5120
    v_mov_b32 v72, v11
    v_smfmac_f32_16x16x64_bf16 v[120:123], v[76:79], v[144:151], v10
    ds_read_b128 v[56:59], v14 offset:2048
    ds_read_b128 v[60:63], v14 offset:6144
    v_mov_b32 v73, v11
    v_smfmac_f32_16x16x64_bf16 v[124:127], v[76:79], v[152:159], v10
    ds_read_b128 v[64:67], v14 offset:3072
    ds_read_b128 v[68:71], v14 offset:7168
    v_mov_b32 v74, v11
    v_smfmac_f32_16x16x64_bf16 v[120:123], v[88:91], v[192:199], v10
    v_mov_b32 v75, v11
    v_smfmac_f32_16x16x64_bf16 v[124:127], v[88:91], v[200:207], v10
    s_waitcnt lgkmcnt(8)
    s_barrier
    ds_read_b64_tr_b16 v[104:105], v4 offset:0
    ds_read_b64_tr_b16 v[106:107], v4 offset:512
    v_smfmac_f32_16x16x64_bf16 v[120:123], v[92:95], v[208:215], v10
    ds_read_b64_tr_b16 v[108:109], v4 offset:1024
    ds_read_b64_tr_b16 v[110:111], v4 offset:1536
    v_smfmac_f32_16x16x64_bf16 v[124:127], v[92:95], v[216:223], v10
    ds_read_b64_tr_b16 v[112:113], v4 offset:2048
    ds_read_b64_tr_b16 v[114:115], v4 offset:2560
    v_smfmac_f32_16x16x64_bf16 v[120:123], v[96:99], v[224:231], v10
    ds_read_b64_tr_b16 v[116:117], v4 offset:3072
    ds_read_b64_tr_b16 v[118:119], v4 offset:3584
    v_smfmac_f32_16x16x64_bf16 v[124:127], v[96:99], v[232:239], v10
    v_smfmac_f32_16x16x64_bf16 v[120:123], v[100:103], v[240:247], v10
    v_smfmac_f32_16x16x64_bf16 v[124:127], v[100:103], v[248:255], v10
    s_xor_b32 s70, s15, 0x800
    s_waitcnt lgkmcnt(6)
    v_mfma_f32_16x16x32_bf16 v[72:75], v[104:107], v[104:107], v[72:75]
    v_add_u32 v0, s70, v1
    v_xor_b32 v14, 0x2000, v14
    v_mfma_f32_16x16x32_bf16 v[80:83], v[40:43], v[104:107], 0
    ds_read_b128 v[88:91], v0
    ds_read_b128 v[92:95], v0 offset:1024
    s_cmp_ge_u32 s23, 62
    v_mfma_f32_16x16x32_bf16 v[84:87], v[44:47], v[104:107], 0
    s_waitcnt lgkmcnt(6)
    v_mfma_f32_16x16x32_bf16 v[72:75], v[108:111], v[108:111], v[72:75]
    v_permlane32_swap_b32 v120, v124
    v_mfma_f32_16x16x32_bf16 v[80:83], v[48:51], v[108:111], v[80:83]
    v_permlane32_swap_b32 v121, v125
    v_mfma_f32_16x16x32_bf16 v[84:87], v[52:55], v[108:111], v[84:87]
    v_permlane32_swap_b32 v122, v126
    s_waitcnt lgkmcnt(4)
    v_mfma_f32_16x16x32_bf16 v[72:75], v[112:115], v[112:115], v[72:75]
    v_permlane32_swap_b32 v123, v127
    v_mfma_f32_16x16x32_bf16 v[80:83], v[56:59], v[112:115], v[80:83]
    v_add_f32 v120, v120, v124
    v_add_f32 v121, v121, v125
    v_mfma_f32_16x16x32_bf16 v[84:87], v[60:63], v[112:115], v[84:87]
    v_add_f32 v122, v122, v126
    v_add_f32 v123, v123, v127
    s_waitcnt lgkmcnt(2)
    v_mfma_f32_16x16x32_bf16 v[72:75], v[116:119], v[116:119], v[72:75]
    v_cvt_pk_bf16_f32 v96, v120, v121
    v_cvt_pk_bf16_f32 v97, v122, v123
    v_mfma_f32_16x16x32_bf16 v[80:83], v[64:67], v[116:119], v[80:83]
    v_mov_b64 v[98:99], v[96:97]
    v_min_u32 v20, -2, v96
    v_mfma_f32_16x16x32_bf16 v[84:87], v[68:71], v[116:119], v[84:87]
    v_min_u32 v21, -2, v97
    v_permlane32_swap_b32 v96, v98
    v_permlane32_swap_b32 v97, v99
    s_cbranch_scc1 L_early_1
L_t5_1:
    v_exp_f32 v72, v72
    v_exp_f32 v73, v73
    v_exp_f32 v74, v74
    v_exp_f32 v75, v75
    v_cvt_pk_bf16_f32 v76, v72, v73
    v_cvt_pk_bf16_f32 v77, v74, v75
    v_exp_f32 v80, v80
    v_exp_f32 v81, v81
    v_mfma_f32_16x16x16_bf16 v[120:123], v[96:97], v[76:77], 0
    v_exp_f32 v82, v82
    v_exp_f32 v83, v83
    v_mfma_f32_16x16x16_bf16 v[72:75], v[22:23], v[76:77], 0
    v_cvt_pk_bf16_f32 v124, v80, v81
    v_cvt_pk_bf16_f32 v125, v82, v83
    v_exp_f32 v84, v84
    v_mfma_f32_16x16x16_bf16 v[80:83], v[98:99], v[76:77], 0
    v_exp_f32 v85, v85
    v_exp_f32 v86, v86
    v_mfma_f32_16x16x16_bf16 v[72:75], v[22:23], v[124:125], v[72:75]
    v_exp_f32 v87, v87
    v_cvt_pk_bf16_f32 v126, v84, v85
    v_cvt_pk_bf16_f32 v127, v86, v87
    s_nop 1
    v_mfma_f32_16x16x16_bf16 v[72:75], v[22:23], v[126:127], v[72:75]
    s_waitcnt lgkmcnt(1)
    v_mfma_f32_16x16x32_bf16 v[120:123], v[88:91], v[124:127], v[120:123]
    s_waitcnt lgkmcnt(0)
    v_mfma_f32_16x16x32_bf16 v[80:83], v[92:95], v[124:127], v[80:83]
L_t7_1:
    s_mov_b32 exec_lo, 0x00ff00ff
    s_mov_b32 exec_hi, 0x00ff00ff
    s_nop 1
    v_rcp_f32 v102, v72
    v_subrev_u32 v101, 0x21800000, v72
    v_cmp_lt_u32 vcc, 0x3c000000, v101
    v_mul_f32 v120, v120, v102
    v_mul_f32 v121, v121, v102
    v_mul_f32 v122, v122, v102
    v_mul_f32 v123, v123, v102
    v_cvt_pk_bf16_f32 v76, v120, v121
    v_cvt_pk_bf16_f32 v77, v122, v123
    v_pk_mul_f32 v[80:81], v[80:81], v[102:103] op_sel_hi:[1,0]
    v_pk_mul_f32 v[82:83], v[82:83], v[102:103] op_sel_hi:[1,0]
    v_cvt_pk_bf16_f32 v78, v80, v81
    v_cvt_pk_bf16_f32 v79, v82, v83
    ds_write_b128 v5, v[76:79]
    s_mov_b64 exec, -1
    v_mov_b64 v[84:85], 0
    v_mov_b64 v[86:87], 0
    v_mov_b32_dpp v76, v76 row_shr:8 row_mask:0xf bank_mask:0xc
    v_mov_b32_dpp v77, v77 row_shr:8 row_mask:0xf bank_mask:0xc
    v_mov_b32_dpp v78, v78 row_shr:8 row_mask:0xf bank_mask:0xc
    v_mov_b32_dpp v79, v79 row_shr:8 row_mask:0xf bank_mask:0xc
    v_mov_b64 v[72:73], 0
    v_mov_b64 v[74:75], 0
    v_smfmac_f32_16x16x64_bf16 v[84:87], v[76:79], a[136:143], v10
    v_mov_b64 v[80:81], 0
    v_mov_b64 v[82:83], 0
    v_smfmac_f32_16x16x64_bf16 v[72:75], v[76:79], a[168:175], v10
    v_mov_b64 v[120:121], 0
    v_mov_b64 v[122:123], 0
    v_smfmac_f32_16x16x64_bf16 v[80:83], v[76:79], a[200:207], v10
    s_cbranch_vccnz L_safe_1
L_t7ok_1:
    s_waitcnt lgkmcnt(0)
    s_barrier
    ds_read_b128 v[88:91], v6 offset:0
    ds_read_b128 v[96:99], v6 offset:128
    ds_read_b128 v[100:103], v6 offset:192
    v_smfmac_f32_16x16x64_bf16 v[120:123], v[76:79], a[232:239], v10
    s_add_u32 s64, s64, 0x40000
    s_add_u32 s66, s66, 0x40000
    s_xor_b32 s14, s14, 0x2000
    s_xor_b32 s15, s15, 0x800
    s_mov_b32 s65, 0
    ds_read_b128 v[40:43], v12 offset:38912
    ds_read_b128 v[44:47], v12 offset:39936
    s_waitcnt lgkmcnt(4)
    v_smfmac_f32_16x16x64_bf16 v[84:87], v[88:91], a[128:135], v10
    s_waitcnt lgkmcnt(3)
    v_smfmac_f32_16x16x64_bf16 v[84:87], v[96:99], a[144:151], v10
    s_waitcnt lgkmcnt(2)
    v_smfmac_f32_16x16x64_bf16 v[84:87], v[100:103], a[152:159], v10
    ds_read_b128 v[48:51], v13 offset:4096
    v_smfmac_f32_16x16x64_bf16 v[72:75], v[88:91], a[160:167], v10
    ds_read_b128 v[52:55], v13 offset:5120
    v_smfmac_f32_16x16x64_bf16 v[72:75], v[96:99], a[176:183], v10
    ds_read_b128 v[56:59], v13 offset:6144
    s_nop 2
    v_cvt_pk_bf16_f32 v76, v84, v85
    v_smfmac_f32_16x16x64_bf16 v[72:75], v[100:103], a[184:191], v10
    ds_read_b128 v[60:63], v13 offset:7168
    v_cvt_pk_bf16_f32 v77, v86, v87
    v_smfmac_f32_16x16x64_bf16 v[80:83], v[88:91], a[192:199], v10
    v_and_or_b32 v76, v76, -2, s27
    v_smfmac_f32_16x16x64_bf16 v[80:83], v[96:99], a[208:215], v10
    v_and_or_b32 v77, v77, -2, s27
    v_smfmac_f32_16x16x64_bf16 v[80:83], v[100:103], a[216:223], v10
    s_nop 0
    v_cvt_pk_bf16_f32 v78, v72, v73
    v_cvt_pk_bf16_f32 v79, v74, v75
    buffer_store_dwordx2 v[76:77], v7, s[4:7], s29 offen offset:0
    s_waitcnt lgkmcnt(4)
    v_smfmac_f32_16x16x64_bf16 v[120:123], v[88:91], v[40:47], v10
    v_and_or_b32 v78, v78, -2, s27
    v_and_or_b32 v79, v79, -2, s27
    s_waitcnt lgkmcnt(2)
    v_smfmac_f32_16x16x64_bf16 v[120:123], v[96:99], v[48:55], v10
    buffer_store_dwordx2 v[78:79], v7, s[4:7], s29 offen offset:512
    s_waitcnt lgkmcnt(0)
    v_smfmac_f32_16x16x64_bf16 v[120:123], v[100:103], v[56:63], v10
    v_cvt_pk_bf16_f32 v84, v80, v81
    v_cvt_pk_bf16_f32 v85, v82, v83
    v_and_or_b32 v84, v84, -2, s27
    v_and_or_b32 v85, v85, -2, s27
    buffer_store_dwordx2 v[84:85], v7, s[4:7], s29 offen offset:1024
    s_nop 2
    v_cvt_pk_bf16_f32 v86, v120, v121
    v_cvt_pk_bf16_f32 v87, v122, v123
    v_and_or_b32 v86, v86, -2, s27
    v_and_or_b32 v87, v87, -2, s27
    buffer_store_dwordx2 v[86:87], v7, s[4:7], s29 offen offset:1536
    s_mov_b32 s17, 0
    v_lshrrev_b32 v0, 1, v7
    v_add_u32 v0, s18, v0
    s_waitcnt vmcnt(4)
    ds_read_b32 v124, v0
L_fl_1:
    s_waitcnt lgkmcnt(0)
    v_readlane_b32 s70, v124, s12
    s_cmp_gt_u32 s70, s13
    s_cbranch_scc0 L_flr_1
L_flok_1:
    s_add_u32 s12, s12, 1
    s_cmp_eq_u32 s12, 3
    s_addc_u32 s13, s13, 0
    s_cmp_eq_u32 s12, 3
    s_cselect_b32 s12, 0, s12
    v_mov_b64 v[104:105], 0
    v_mov_b64 v[106:107], 0
    v_mov_b64 v[108:109], 0
    v_mov_b64 v[110:111], 0
    v_mov_b64 v[112:113], 0
    v_mov_b64 v[114:115], 0
    v_mov_b64 v[116:117], 0
    v_mov_b64 v[118:119], 0
    v_mov_b64 v[120:121], 0
    v_mov_b64 v[122:123], 0
    v_mov_b64 v[124:125], 0
    v_mov_b64 v[126:127], 0
    s_add_u32 s23, s23, 1
    s_xor_b32 s27, s27, 1
    s_not_b32 s28, s28
    s_barrier
    s_nop 15
    s_branch L_top_1
.p2align 6
    s_nop 0
    s_nop 0
    s_nop 0
    s_nop 0
    s_nop 0
    s_nop 0
    s_nop 0
    s_nop 0
    s_nop 0
    s_nop 0
    s_nop 0
    s_nop 0
L_top_2:
    s_mov_b32 s19, s24
    buffer_load_dwordx4 v[88:91], v15, s[4:7], s19 offen offset:0 sc1
    buffer_load_dwordx4 v[92:95], v15, s[4:7], s19 offen offset:1024 sc1
    ds_read_b128 v[40:43], v12 offset:4096
    ds_read_b128 v[44:47], v12 offset:5120
    ds_read_b128 v[48:51], v13 offset:0
    ds_read_b128 v[52:55], v13 offset:1024
    ds_read_b128 v[56:59], v12 offset:6144
    ds_read_b128 v[60:63], v12 offset:7168
    ds_read_b128 v[64:67], v13 offset:2048
    ds_read_b128 v[68:71], v13 offset:3072
    s_mov_b32 s24, s30
    s_add_u32 s30, s30, 8192
    s_cmp_eq_u32 s30, 0x106000
    s_cselect_b32 s30, 0x100000, s30
    s_nop 15
    buffer_load_dwordx4 v[80:83], v15, s[4:7], s19 offen offset:0 sc1
    buffer_load_dwordx4 v[100:103], v15, s[4:7], s19 offen offset:1024 sc1
    s_waitcnt vmcnt(3)
    ds_write_b128 v2, v[88:91] offset:4096
    s_waitcnt vmcnt(2)
    ds_write_b128 v2, v[92:95] offset:5120
    v_max3_u32 v76, v88, v89, v90
    v_max3_u32 v77, v91, v92, v93
    v_max3_u32 v78, v76, v77, v94
    v_max_u32 v79, v78, v95
    v_cmp_eq_u32 vcc, -1, v79
    s_cbranch_vccnz L_t1r_2_0
L_t1ok_2_0:
    s_waitcnt lgkmcnt(8)
    v_smfmac_f32_16x16x64_bf16 v[112:115], v[88:91], v[40:47], v10
    ds_read_b128 v[40:43], v12 offset:36864
    ds_read_b128 v[44:47], v12 offset:37888
    s_waitcnt lgkmcnt(8)
    v_smfmac_f32_16x16x64_bf16 v[116:119], v[88:91], v[48:55], v10
    ds_read_b128 v[48:51], v13 offset:32768
    ds_read_b128 v[52:55], v13 offset:33792
    v_smfmac_f32_16x16x64_bf16 v[104:107], v[88:91], a[32:39], v10
    v_smfmac_f32_16x16x64_bf16 v[108:111], v[88:91], a[96:103], v10
    v_smfmac_f32_16x16x64_bf16 v[120:123], v[88:91], v[192:199], v10
    v_smfmac_f32_16x16x64_bf16 v[124:127], v[88:91], v[200:207], v10
    s_add_u32 s67, s67, 0x20000
    s_add_u32 s68, s68, 0x10000
    s_waitcnt lgkmcnt(4)
    s_barrier
    ds_read_b128 v[96:99], v2 offset:6144
    v_smfmac_f32_16x16x64_bf16 v[120:123], v[92:95], v[208:215], v10
    ds_read_b128 v[72:75], v2 offset:0
    s_waitcnt vmcnt(1)
    ds_read_b128 v[80:83], v2 offset:2048
    v_smfmac_f32_16x16x64_bf16 v[124:127], v[92:95], v[216:223], v10
    s_waitcnt vmcnt(0)
    ds_read_b128 v[100:103], v2 offset:7168
    ds_read_b128 v[76:79], v2 offset:1024
    v_smfmac_f32_16x16x64_bf16 v[112:115], v[92:95], v[56:63], v10
    ds_read_b128 v[84:87], v2 offset:3072
    ds_read_b128 v[56:59], v12 offset:0
    v_smfmac_f32_16x16x64_bf16 v[116:119], v[92:95], v[64:71], v10
    ds_read_b128 v[60:63], v12 offset:1024
    ds_read_b128 v[64:67], v12 offset:32768
    v_smfmac_f32_16x16x64_bf16 v[104:107], v[92:95], a[40:47], v10
    ds_read_b128 v[68:71], v12 offset:33792
    s_mov_b32 m0, s14
    s_nop 0
    buffer_load_dwordx4 v15, s[4:7], s64 offen offset:0 sc1 lds
    v_smfmac_f32_16x16x64_bf16 v[108:111], v[92:95], a[104:111], v10
    s_waitcnt lgkmcnt(9)
    v_smfmac_f32_16x16x64_bf16 v[112:115], v[96:99], v[40:47], v10
    ds_read_b128 v[40:43], v13 offset:34816
    ds_read_b128 v[44:47], v13 offset:35840
    v_smfmac_f32_16x16x64_bf16 v[116:119], v[96:99], v[48:55], v10
    ds_read_b128 v[48:51], v12 offset:2048
    ds_read_b128 v[52:55], v12 offset:3072
    v_smfmac_f32_16x16x64_bf16 v[104:107], v[96:99], a[48:55], v10
    s_mov_b32 m0, s14
    s_nop 0
    buffer_load_dwordx4 v15, s[4:7], s64 offen offset:1024 sc1 lds
    v_smfmac_f32_16x16x64_bf16 v[108:111], v[96:99], a[112:119], v10
    s_waitcnt lgkmcnt(12)
    v_smfmac_f32_16x16x64_bf16 v[112:115], v[72:75], v[24:31], v10
    s_waitcnt lgkmcnt(6)
    v_smfmac_f32_16x16x64_bf16 v[116:119], v[72:75], v[56:63], v10
    ds_read_b128 v[56:59], v12 offset:34816
    ds_read_b128 v[60:63], v12 offset:35840
    v_smfmac_f32_16x16x64_bf16 v[104:107], v[72:75], a[0:7], v10
    s_mov_b32 m0, s15
    s_nop 0
    buffer_load_dwordx4 v15, s[4:7], s66 offen offset:0 sc1 lds
    v_smfmac_f32_16x16x64_bf16 v[108:111], v[72:75], a[64:71], v10
    v_smfmac_f32_16x16x64_bf16 v[112:115], v[80:83], v[32:39], v10
    s_waitcnt lgkmcnt(6)
    v_smfmac_f32_16x16x64_bf16 v[116:119], v[80:83], v[64:71], v10
    v_smfmac_f32_16x16x64_bf16 v[104:107], v[80:83], a[16:23], v10
    s_mov_b32 m0, s15
    s_nop 0
    buffer_load_dwordx4 v15, s[4:7], s66 offen offset:1024 sc1 lds
    v_smfmac_f32_16x16x64_bf16 v[108:111], v[80:83], a[80:87], v10
    v_smfmac_f32_16x16x64_bf16 v[112:115], v[100:103], a[224:231], v10
    v_smfmac_f32_16x16x64_bf16 v[104:107], v[100:103], a[56:63], v10
    v_smfmac_f32_16x16x64_bf16 v[112:115], v[76:79], a[232:239], v10
    v_smfmac_f32_16x16x64_bf16 v[104:107], v[76:79], a[8:15], v10
    v_smfmac_f32_16x16x64_bf16 v[112:115], v[84:87], a[248:255], v10
    v_xor_b32 v0, 16, v3
    v_smfmac_f32_16x16x64_bf16 v[104:107], v[84:87], a[24:31], v10
    s_waitcnt lgkmcnt(4)
    v_smfmac_f32_16x16x64_bf16 v[116:119], v[100:103], v[40:47], v10
    v_smfmac_f32_16x16x64_bf16 v[108:111], v[100:103], a[120:127], v10
    s_waitcnt lgkmcnt(2)
    v_smfmac_f32_16x16x64_bf16 v[116:119], v[76:79], v[48:55], v10
    v_smfmac_f32_16x16x64_bf16 v[108:111], v[76:79], a[72:79], v10
    s_nop 1
    v_permlane32_swap_b32 v104, v112
    s_waitcnt lgkmcnt(0)
    v_smfmac_f32_16x16x64_bf16 v[116:119], v[84:87], v[56:63], v10
    v_permlane32_swap_b32 v105, v113
    v_smfmac_f32_16x16x64_bf16 v[108:111], v[84:87], a[88:95], v10
    v_permlane32_swap_b32 v106, v114
    v_permlane32_swap_b32 v107, v115
    v_add_f32 v104, v104, v112
    v_add_f32 v105, v105, v113
    v_add_f32 v106, v106, v114
    v_add_f32 v107, v107, v115
    v_mul_f32 v104, s69, v104
    v_mul_f32 v105, s69, v105
    v_mul_f32 v106, s69, v106
    v_mul_f32 v107, s69, v107
    v_cvt_pk_bf16_f32 v104, v104, v105
    v_cvt_pk_bf16_f32 v105, v106, v107
    ds_write_b64 v3, v[104:105]
    v_permlane32_swap_b32 v108, v116
    v_permlane32_swap_b32 v109, v117
    v_permlane32_swap_b32 v110, v118
    v_permlane32_swap_b32 v111, v119
    v_add_f32 v108, v108, v116
    v_add_f32 v109, v109, v117
    v_add_f32 v110, v110, v118
    v_add_f32 v111, v111, v119
    v_cvt_pk_bf16_f32 v108, v108, v109
    v_cvt_pk_bf16_f32 v109, v110, v111
    ds_write_b64 v0, v[108:109]
    v_smfmac_f32_16x16x64_bf16 v[120:123], v[72:75], v[128:135], v10
    ds_read_b128 v[40:43], v14 offset:0
    ds_read_b128 v[44:47], v14 offset:4096
    v_smfmac_f32_16x16x64_bf16 v[124:127], v[72:75], v[136:143], v10
    ds_read_b128 v[48:51], v14 offset:1024
    ds_read_b128 v[52:55], v14 offset:5120
    v_mov_b32 v72, v11
    v_smfmac_f32_16x16x64_bf16 v[120:123], v[76:79], v[144:151], v10
    ds_read_b128 v[56:59], v14 offset:2048
    ds_read_b128 v[60:63], v14 offset:6144
    v_mov_b32 v73, v11
    v_smfmac_f32_16x16x64_bf16 v[124:127], v[76:79], v[152:159], v10
    ds_read_b128 v[64:67], v14 offset:3072
    ds_read_b128 v[68:71], v14 offset:7168
    v_mov_b32 v74, v11
    v_smfmac_f32_16x16x64_bf16 v[120:123], v[80:83], v[160:167], v10
    v_mov_b32 v75, v11
    v_smfmac_f32_16x16x64_bf16 v[124:127], v[80:83], v[168:175], v10
    s_waitcnt lgkmcnt(8)
    s_barrier
    ds_read_b64_tr_b16 v[104:105], v4 offset:0
    ds_read_b64_tr_b16 v[106:107], v4 offset:512
    v_smfmac_f32_16x16x64_bf16 v[120:123], v[84:87], v[176:183], v10
    ds_read_b64_tr_b16 v[108:109], v4 offset:1024
    ds_read_b64_tr_b16 v[110:111], v4 offset:1536
    v_smfmac_f32_16x16x64_bf16 v[124:127], v[84:87], v[184:191], v10
    ds_read_b64_tr_b16 v[112:113], v4 offset:2048
    ds_read_b64_tr_b16 v[114:115], v4 offset:2560
    v_smfmac_f32_16x16x64_bf16 v[120:123], v[96:99], v[224:231], v10
    ds_read_b64_tr_b16 v[116:117], v4 offset:3072
    ds_read_b64_tr_b16 v[118:119], v4 offset:3584
    v_smfmac_f32_16x16x64_bf16 v[124:127], v[96:99], v[232:239], v10
    v_smfmac_f32_16x16x64_bf16 v[120:123], v[100:103], v[240:247], v10
    v_smfmac_f32_16x16x64_bf16 v[124:127], v[100:103], v[248:255], v10
    s_xor_b32 s70, s15, 0x800
    s_waitcnt lgkmcnt(6)
    v_mfma_f32_16x16x32_bf16 v[72:75], v[104:107], v[104:107], v[72:75]
    v_add_u32 v0, s70, v1
    v_xor_b32 v14, 0x2000, v14
    v_mfma_f32_16x16x32_bf16 v[80:83], v[40:43], v[104:107], 0
    ds_read_b128 v[88:91], v0
    ds_read_b128 v[92:95], v0 offset:1024
    s_cmp_ge_u32 s23, 62
    v_mfma_f32_16x16x32_bf16 v[84:87], v[44:47], v[104:107], 0
    v_add_u32 v0, 163072, v7
    s_waitcnt lgkmcnt(6)
    v_mfma_f32_16x16x32_bf16 v[72:75], v[108:111], v[108:111], v[72:75]
    v_permlane32_swap_b32 v120, v124
    v_mfma_f32_16x16x32_bf16 v[80:83], v[48:51], v[108:111], v[80:83]
    v_permlane32_swap_b32 v121, v125
    v_mfma_f32_16x16x32_bf16 v[84:87], v[52:55], v[108:111], v[84:87]
    v_permlane32_swap_b32 v122, v126
    s_waitcnt lgkmcnt(4)
    v_mfma_f32_16x16x32_bf16 v[72:75], v[112:115], v[112:115], v[72:75]
    v_permlane32_swap_b32 v123, v127
    v_mfma_f32_16x16x32_bf16 v[80:83], v[56:59], v[112:115], v[80:83]
    v_add_f32 v120, v120, v124
    v_add_f32 v121, v121, v125
    v_mfma_f32_16x16x32_bf16 v[84:87], v[60:63], v[112:115], v[84:87]
    v_add_f32 v122, v122, v126
    v_add_f32 v123, v123, v127
    s_waitcnt lgkmcnt(2)
    v_mfma_f32_16x16x32_bf16 v[72:75], v[116:119], v[116:119], v[72:75]
    v_cvt_pk_bf16_f32 v96, v120, v121
    v_cvt_pk_bf16_f32 v97, v122, v123
    v_mfma_f32_16x16x32_bf16 v[80:83], v[64:67], v[116:119], v[80:83]
    v_mov_b64 v[98:99], v[96:97]
    v_min_u32 v20, -2, v96
    v_mfma_f32_16x16x32_bf16 v[84:87], v[68:71], v[116:119], v[84:87]
    v_min_u32 v21, -2, v97
    v_permlane32_swap_b32 v96, v98
    v_permlane32_swap_b32 v97, v99
    ds_write_b64 v0, v[20:21]
    s_cbranch_scc1 L_early_2
L_t5_2:
    v_exp_f32 v72, v72
    v_exp_f32 v73, v73
    v_exp_f32 v74, v74
    v_exp_f32 v75, v75
    v_cvt_pk_bf16_f32 v76, v72, v73
    v_cvt_pk_bf16_f32 v77, v74, v75
    v_exp_f32 v80, v80
    v_exp_f32 v81, v81
    v_mfma_f32_16x16x16_bf16 v[120:123], v[96:97], v[76:77], 0
    v_exp_f32 v82, v82
    v_exp_f32 v83, v83
    v_mfma_f32_16x16x16_bf16 v[72:75], v[22:23], v[76:77], 0
    v_cvt_pk_bf16_f32 v124, v80, v81
    v_cvt_pk_bf16_f32 v125, v82, v83
    v_exp_f32 v84, v84
    v_mfma_f32_16x16x16_bf16 v[80:83], v[98:99], v[76:77], 0
    v_exp_f32 v85, v85
    v_exp_f32 v86, v86
    v_mfma_f32_16x16x16_bf16 v[72:75], v[22:23], v[124:125], v[72:75]
    v_exp_f32 v87, v87
    v_cvt_pk_bf16_f32 v126, v84, v85
    v_cvt_pk_bf16_f32 v127, v86, v87
    s_nop 1
    v_mfma_f32_16x16x16_bf16 v[72:75], v[22:23], v[126:127], v[72:75]
    s_waitcnt lgkmcnt(2)
    v_mfma_f32_16x16x32_bf16 v[120:123], v[88:91], v[124:127], v[120:123]
    s_waitcnt lgkmcnt(1)
    v_mfma_f32_16x16x32_bf16 v[80:83], v[92:95], v[124:127], v[80:83]
L_t7_2:
    s_mov_b32 exec_lo, 0x00ff00ff
    s_mov_b32 exec_hi, 0x00ff00ff
    s_nop 1
    v_rcp_f32 v102, v72
    v_subrev_u32 v101, 0x21800000, v72
    v_cmp_lt_u32 vcc, 0x3c000000, v101
    v_mul_f32 v120, v120, v102
    v_mul_f32 v121, v121, v102
    v_mul_f32 v122, v122, v102
    v_mul_f32 v123, v123, v102
    v_cvt_pk_bf16_f32 v76, v120, v121
    v_cvt_pk_bf16_f32 v77, v122, v123
    v_pk_mul_f32 v[80:81], v[80:81], v[102:103] op_sel_hi:[1,0]
    v_pk_mul_f32 v[82:83], v[82:83], v[102:103] op_sel_hi:[1,0]
    v_cvt_pk_bf16_f32 v78, v80, v81
    v_cvt_pk_bf16_f32 v79, v82, v83
    ds_write_b128 v5, v[76:79]
    s_mov_b64 exec, -1
    v_mov_b64 v[84:85], 0
    v_mov_b64 v[86:87], 0
    v_mov_b32_dpp v76, v76 row_shr:8 row_mask:0xf bank_mask:0xc
    v_mov_b32_dpp v77, v77 row_shr:8 row_mask:0xf bank_mask:0xc
    v_mov_b32_dpp v78, v78 row_shr:8 row_mask:0xf bank_mask:0xc
    v_mov_b32_dpp v79, v79 row_shr:8 row_mask:0xf bank_mask:0xc
    v_mov_b64 v[72:73], 0
    v_mov_b64 v[74:75], 0
    v_smfmac_f32_16x16x64_bf16 v[84:87], v[76:79], a[144:151], v10
    v_mov_b64 v[80:81], 0
    v_mov_b64 v[82:83], 0
    v_smfmac_f32_16x16x64_bf16 v[72:75], v[76:79], a[176:183], v10
    v_mov_b64 v[120:121], 0
    v_mov_b64 v[122:123], 0
    v_smfmac_f32_16x16x64_bf16 v[80:83], v[76:79], a[208:215], v10
    s_cbranch_vccnz L_safe_2
L_t7ok_2:
    s_waitcnt lgkmcnt(0)
    s_barrier
    ds_read_b128 v[88:91], v6 offset:0
    ds_read_b128 v[92:95], v6 offset:64
    ds_read_b128 v[100:103], v6 offset:192
    v_smfmac_f32_16x16x64_bf16 v[120:123], v[76:79], a[240:247], v10
    s_add_u32 s64, s64, 0x40000
    s_add_u32 s66, s66, 0x40000
    s_xor_b32 s14, s14, 0x2000
    s_xor_b32 s15, s15, 0x800
    s_mov_b32 s65, 0
    ds_read_b128 v[40:43], v12 offset:38912
    ds_read_b128 v[44:47], v12 offset:39936
    s_waitcnt lgkmcnt(4)
    v_smfmac_f32_16x16x64_bf16 v[84:87], v[88:91], a[128:135], v10
    s_waitcnt lgkmcnt(3)
    v_smfmac_f32_16x16x64_bf16 v[84:87], v[92:95], a[136:143], v10
    s_waitcnt lgkmcnt(2)
    v_smfmac_f32_16x16x64_bf16 v[84:87], v[100:103], a[152:159], v10
    ds_read_b128 v[48:51], v13 offset:4096
    v_smfmac_f32_16x16x64_bf16 v[72:75], v[88:91], a[160:167], v10
    ds_read_b128 v[52:55], v13 offset:5120
    v_smfmac_f32_16x16x64_bf16 v[72:75], v[92:95], a[168:175], v10
    ds_read_b128 v[56:59], v13 offset:6144
    s_nop 2
    v_cvt_pk_bf16_f32 v76, v84, v85
    v_smfmac_f32_16x16x64_bf16 v[72:75], v[100:103], a[184:191], v10
    ds_read_b128 v[60:63], v13 offset:7168
    v_cvt_pk_bf16_f32 v77, v86, v87
    v_smfmac_f32_16x16x64_bf16 v[80:83], v[88:91], a[192:199], v10
    v_and_or_b32 v76, v76, -2, s27
    v_smfmac_f32_16x16x64_bf16 v[80:83], v[92:95], a[200:207], v10
    v_and_or_b32 v77, v77, -2, s27
    buffer_store_dwordx2 v[76:77], v7, s[4:7], s29 offen offset:0
    v_smfmac_f32_16x16x64_bf16 v[80:83], v[100:103], a[216:223], v10
    v_cvt_pk_bf16_f32 v78, v72, v73
    v_cvt_pk_bf16_f32 v79, v74, v75
    s_waitcnt lgkmcnt(4)
    v_smfmac_f32_16x16x64_bf16 v[120:123], v[88:91], v[40:47], v10
    v_and_or_b32 v78, v78, -2, s27
    v_and_or_b32 v79, v79, -2, s27
    buffer_store_dwordx2 v[78:79], v7, s[4:7], s29 offen offset:512
    s_waitcnt lgkmcnt(2)
    v_smfmac_f32_16x16x64_bf16 v[120:123], v[92:95], v[48:55], v10
    s_waitcnt lgkmcnt(0)
    v_smfmac_f32_16x16x64_bf16 v[120:123], v[100:103], v[56:63], v10
    v_cvt_pk_bf16_f32 v84, v80, v81
    v_cvt_pk_bf16_f32 v85, v82, v83
    v_and_or_b32 v84, v84, -2, s27
    v_and_or_b32 v85, v85, -2, s27
    buffer_store_dwordx2 v[84:85], v7, s[4:7], s29 offen offset:1024
    s_nop 2
    v_cvt_pk_bf16_f32 v86, v120, v121
    v_cvt_pk_bf16_f32 v87, v122, v123
    v_and_or_b32 v86, v86, -2, s27
    v_and_or_b32 v87, v87, -2, s27
    buffer_store_dwordx2 v[86:87], v7, s[4:7], s29 offen offset:1536
    s_mov_b32 s17, 0
    v_mov_b32 v60, -1
    buffer_store_dword v60, v9, s[4:7], s30 offen
    s_nop 15
    s_nop 15
    s_nop 15
    s_nop 15
    s_nop 7
    buffer_load_dwordx4 v[88:91], v8, s[4:7], s25 offen sc1
    buffer_load_dwordx4 v[92:95], v8, s[4:7], s26 offen sc1
    buffer_load_dwordx4 v[96:99], v8, s[4:7], s2 offen sc1
    buffer_load_dwordx4 v[100:103], v8, s[4:7], s3 offen sc1
    v_mov_b64 v[104:105], 0
    v_mov_b64 v[106:107], 0
    v_mov_b64 v[108:109], 0
    v_mov_b64 v[110:111], 0
    v_mov_b64 v[112:113], 0
    v_mov_b64 v[114:115], 0
    v_mov_b64 v[116:117], 0
    v_mov_b64 v[118:119], 0
    v_mov_b64 v[120:121], 0
    v_mov_b64 v[122:123], 0
    v_mov_b64 v[124:125], 0
    v_mov_b64 v[126:127], 0
    s_nop 15
    s_nop 7
    buffer_load_dwordx4 v[72:75], v8, s[4:7], s25 offen sc1
    buffer_load_dwordx4 v[76:79], v8, s[4:7], s26 offen sc1
    buffer_load_dwordx4 v[80:83], v8, s[4:7], s2 offen sc1
    buffer_load_dwordx4 v[84:87], v8, s[4:7], s3 offen sc1
    s_waitcnt vmcnt(7)
    v_mfma_f32_16x16x32_bf16 v[48:51], v[16:19], v[88:91], 0
    v_bitop3_b32 v56, v88, v89, s28 bitop3:0x42
    v_bitop3_b32 v57, v90, v91, s28 bitop3:0x42
    s_waitcnt vmcnt(6)
    v_mfma_f32_16x16x32_bf16 v[48:51], v[16:19], v[92:95], v[48:51]
    v_bitop3_b32 v58, v92, v93, s28 bitop3:0x42
    v_bitop3_b32 v59, v94, v95, s28 bitop3:0x42
    v_bitop3_b32 v56, v56, v57, v58 bitop3:0x80
    s_waitcnt vmcnt(5)
    v_mfma_f32_16x16x32_bf16 v[48:51], v[16:19], v[96:99], v[48:51]
    v_bitop3_b32 v60, v96, v97, s28 bitop3:0x42
    v_bitop3_b32 v61, v98, v99, s28 bitop3:0x42
    v_bitop3_b32 v57, v59, v60, v61 bitop3:0x80
    s_waitcnt vmcnt(4)
    v_mfma_f32_16x16x32_bf16 v[48:51], v[16:19], v[100:103], v[48:51]
    v_bitop3_b32 v62, v100, v101, s28 bitop3:0x42
    v_bitop3_b32 v63, v102, v103, s28 bitop3:0x42
    v_bitop3_b32 v56, v56, v57, 1 bitop3:0x80
    v_bitop3_b32 v56, v56, v62, v63 bitop3:0x80
    v_cmp_eq_u32 vcc, 0, v56
L_t9f_2:
    s_nop 2
    v_add_f32_dpp v52, v48, v48 row_ror:8 row_mask:0xf bank_mask:0x3
    v_add_f32_dpp v53, v50, v50 row_ror:8 row_mask:0xf bank_mask:0x3
    v_add_f32_dpp v52, v49, v49 row_ror:8 row_mask:0xf bank_mask:0xc
    v_add_f32_dpp v53, v51, v51 row_ror:8 row_mask:0xf bank_mask:0xc
    s_cbranch_vccnz L_t9s_2
    s_nop 0
    v_permlane16_swap_b32 v52, v53
    v_cvt_pk_bf16_f32 v52, v52, v53
    v_min_u32 v52, -2, v52
    buffer_store_dword v52, v9, s[4:7], s24 offen
    s_add_u32 s23, s23, 1
    s_xor_b32 s27, s27, 1
    s_not_b32 s28, s28
    s_barrier
    s_nop 15
    s_branch L_top_2
.p2align 6
    s_nop 0
    s_nop 0
    s_nop 0
    s_nop 0
    s_nop 0
    s_nop 0
    s_nop 0
    s_nop 0
    s_nop 0
    s_nop 0
    s_nop 0
    s_nop 0
L_top_3:
    s_mov_b32 s19, s24
    buffer_load_dwordx4 v[96:99], v15, s[4:7], s19 offen offset:0 sc1
    buffer_load_dwordx4 v[100:103], v15, s[4:7], s19 offen offset:1024 sc1
    ds_read_b64_tr_b16 v[72:73], v4 offset:2048
    ds_read_b64_tr_b16 v[74:75], v4 offset:2560
    ds_read_b64_tr_b16 v[80:81], v4 offset:3072
    ds_read_b64_tr_b16 v[82:83], v4 offset:3584
    v_add_u32 v0, 163072, v7
    ds_read_b64 v[92:93], v0
    ds_read_b128 v[40:43], v12 offset:4096
    ds_read_b128 v[44:47], v12 offset:5120
    ds_read_b128 v[48:51], v13 offset:32768
    ds_read_b128 v[52:55], v13 offset:33792
    ds_read_b128 v[56:59], v12 offset:6144
    ds_read_b128 v[60:63], v12 offset:7168
    ds_read_b128 v[64:67], v13 offset:34816
    ds_read_b128 v[68:71], v13 offset:35840
    s_waitcnt lgkmcnt(12)
    v_min_u32 v72, -2, v72
    v_min_u32 v73, -2, v73
    s_waitcnt lgkmcnt(11)
    v_min_u32 v74, -2, v74
    v_min_u32 v75, -2, v75
    s_waitcnt lgkmcnt(10)
    v_min_u32 v80, -2, v80
    v_min_u32 v81, -2, v81
    s_waitcnt lgkmcnt(9)
    v_min_u32 v82, -2, v82
    v_min_u32 v83, -2, v83
    s_mov_b32 s24, s30
    s_add_u32 s30, s30, 8192
    s_cmp_eq_u32 s30, 0x106000
    s_cselect_b32 s30, 0x100000, s30
    s_nop 15
    buffer_load_dwordx4 v[88:91], v15, s[4:7], s19 offen offset:0 sc1
    buffer_load_dwordx4 v[76:79], v15, s[4:7], s19 offen offset:1024 sc1
    s_waitcnt vmcnt(3)
    ds_write_b128 v2, v[96:99] offset:6144
    s_waitcnt vmcnt(2)
    ds_write_b128 v2, v[100:103] offset:7168
    v_max3_u32 v84, v96, v97, v98
    v_max3_u32 v85, v99, v100, v101
    v_max3_u32 v86, v84, v85, v102
    v_max_u32 v87, v86, v103
    v_cmp_eq_u32 vcc, -1, v87
    s_cbranch_vccnz L_t1r_3_0
L_t1ok_3_0:
    s_waitcnt lgkmcnt(8)
    v_smfmac_f32_16x16x64_bf16 v[112:115], v[96:99], v[40:47], v10
    ds_read_b128 v[40:43], v12 offset:36864
    ds_read_b128 v[44:47], v12 offset:37888
    buffer_store_dwordx4 v[72:75], v1, s[4:7], s67 offen offset:0 sc1
    s_waitcnt lgkmcnt(8)
    v_smfmac_f32_16x16x64_bf16 v[116:119], v[96:99], v[48:55], v10
    ds_read_b128 v[48:51], v12 offset:0
    ds_read_b128 v[52:55], v12 offset:1024
    buffer_store_dwordx4 v[80:83], v1, s[4:7], s67 offen offset:1024 sc1
    v_smfmac_f32_16x16x64_bf16 v[104:107], v[96:99], a[48:55], v10
    buffer_store_dwordx2 v[92:93], v7, s[4:7], s68 offen offset:0 sc1
    v_smfmac_f32_16x16x64_bf16 v[108:111], v[96:99], a[112:119], v10
    buffer_store_dwordx2 v[20:21], v7, s[4:7], s68 offen offset:512 sc1
    v_smfmac_f32_16x16x64_bf16 v[120:123], v[96:99], v[224:231], v10
    v_smfmac_f32_16x16x64_bf16 v[124:127], v[96:99], v[232:239], v10
    s_add_u32 s67, s67, 0x20000
    s_add_u32 s68, s68, 0x10000
    s_waitcnt lgkmcnt(4)
    s_barrier
    ds_read_b128 v[72:75], v2 offset:0
    v_smfmac_f32_16x16x64_bf16 v[120:123], v[100:103], v[240:247], v10
    ds_read_b128 v[80:83], v2 offset:2048
    s_waitcnt vmcnt(5)
    ds_read_b128 v[88:91], v2 offset:4096
    v_smfmac_f32_16x16x64_bf16 v[124:127], v[100:103], v[248:255], v10
    s_waitcnt vmcnt(4)
    ds_read_b128 v[76:79], v2 offset:1024
    ds_read_b128 v[84:87], v2 offset:3072
    v_smfmac_f32_16x16x64_bf16 v[112:115], v[100:103], v[56:63], v10
    ds_read_b128 v[92:95], v2 offset:5120
    ds_read_b128 v[56:59], v12 offset:32768
    v_smfmac_f32_16x16x64_bf16 v[116:119], v[100:103], v[64:71], v10
    ds_read_b128 v[60:63], v12 offset:33792
    ds_read_b128 v[64:67], v13 offset:0
    v_smfmac_f32_16x16x64_bf16 v[104:107], v[100:103], a[56:63], v10
    ds_read_b128 v[68:71], v13 offset:1024
    v_smfmac_f32_16x16x64_bf16 v[108:111], v[100:103], a[120:127], v10
    s_mov_b32 m0, s14
    s_nop 0
    buffer_load_dwordx4 v15, s[4:7], s64 offen offset:0 sc1 lds
    s_waitcnt lgkmcnt(9)
    v_smfmac_f32_16x16x64_bf16 v[112:115], v[72:75], v[40:47], v10
    ds_read_b128 v[40:43], v12 offset:2048
    ds_read_b128 v[44:47], v12 offset:3072
    v_smfmac_f32_16x16x64_bf16 v[116:119], v[72:75], v[48:55], v10
    ds_read_b128 v[48:51], v12 offset:34816
    ds_read_b128 v[52:55], v12 offset:35840
    v_smfmac_f32_16x16x64_bf16 v[104:107], v[72:75], a[0:7], v10
    v_smfmac_f32_16x16x64_bf16 v[108:111], v[72:75], a[64:71], v10
    s_mov_b32 m0, s14
    s_nop 0
    buffer_load_dwordx4 v15, s[4:7], s64 offen offset:1024 sc1 lds
    s_waitcnt lgkmcnt(12)
    v_smfmac_f32_16x16x64_bf16 v[112:115], v[80:83], v[24:31], v10
    s_waitcnt lgkmcnt(6)
    v_smfmac_f32_16x16x64_bf16 v[116:119], v[80:83], v[56:63], v10
    ds_read_b128 v[56:59], v13 offset:2048
    ds_read_b128 v[60:63], v13 offset:3072
    v_smfmac_f32_16x16x64_bf16 v[104:107], v[80:83], a[16:23], v10
    v_smfmac_f32_16x16x64_bf16 v[108:111], v[80:83], a[80:87], v10
    s_mov_b32 m0, s15
    s_nop 0
    buffer_load_dwordx4 v15, s[4:7], s66 offen offset:0 sc1 lds
    v_smfmac_f32_16x16x64_bf16 v[112:115], v[88:91], v[32:39], v10
    s_waitcnt lgkmcnt(6)
    v_smfmac_f32_16x16x64_bf16 v[116:119], v[88:91], v[64:71], v10
    v_smfmac_f32_16x16x64_bf16 v[104:107], v[88:91], a[32:39], v10
    v_smfmac_f32_16x16x64_bf16 v[108:111], v[88:91], a[96:103], v10
    s_mov_b32 m0, s15
    s_nop 0
    buffer_load_dwordx4 v15, s[4:7], s66 offen offset:1024 sc1 lds
    v_smfmac_f32_16x16x64_bf16 v[112:115], v[76:79], a[224:231], v10
    v_smfmac_f32_16x16x64_bf16 v[104:107], v[76:79], a[8:15], v10
    v_smfmac_f32_16x16x64_bf16 v[112:115], v[84:87], a[232:239], v10
    v_smfmac_f32_16x16x64_bf16 v[104:107], v[84:87], a[24:31], v10
    s_mov_b32 m0, s18
    s_nop 0
    buffer_load_dword v7, s[4:7], s16 offen sc1 lds
    v_smfmac_f32_16x16x64_bf16 v[112:115], v[92:95], a[240:247], v10
    v_xor_b32 v0, 16, v3
    v_smfmac_f32_16x16x64_bf16 v[104:107], v[92:95], a[40:47], v10
    s_waitcnt lgkmcnt(4)
    v_smfmac_f32_16x16x64_bf16 v[116:119], v[76:79], v[40:47], v10
    v_smfmac_f32_16x16x64_bf16 v[108:111], v[76:79], a[72:79], v10
    s_waitcnt lgkmcnt(2)
    v_smfmac_f32_16x16x64_bf16 v[116:119], v[84:87], v[48:55], v10
    v_smfmac_f32_16x16x64_bf16 v[108:111], v[84:87], a[88:95], v10
    s_nop 1
    v_permlane32_swap_b32 v104, v112
    s_waitcnt lgkmcnt(0)
    v_smfmac_f32_16x16x64_bf16 v[116:119], v[92:95], v[56:63], v10
    v_permlane32_swap_b32 v105, v113
    v_smfmac_f32_16x16x64_bf16 v[108:111], v[92:95], a[104:111], v10
    v_permlane32_swap_b32 v106, v114
    v_permlane32_swap_b32 v107, v115
    v_add_f32 v104, v104, v112
    v_add_f32 v105, v105, v113
    v_add_f32 v106, v106, v114
    v_add_f32 v107, v107, v115
    v_mul_f32 v104, s69, v104
    v_mul_f32 v105, s69, v105
    v_mul_f32 v106, s69, v106
    v_mul_f32 v107, s69, v107
    v_cvt_pk_bf16_f32 v104, v104, v105
    v_cvt_pk_bf16_f32 v105, v106, v107
    ds_write_b64 v3, v[104:105]
    v_permlane32_swap_b32 v108, v116
    v_permlane32_swap_b32 v109, v117
    v_permlane32_swap_b32 v110, v118
    v_permlane32_swap_b32 v111, v119
    v_add_f32 v108, v108, v116
    v_add_f32 v109, v109, v117
    v_add_f32 v110, v110, v118
    v_add_f32 v111, v111, v119
    v_cvt_pk_bf16_f32 v108, v108, v109
    v_cvt_pk_bf16_f32 v109, v110, v111
    ds_write_b64 v0, v[108:109]
    v_smfmac_f32_16x16x64_bf16 v[120:123], v[72:75], v[128:135], v10
    ds_read_b128 v[40:43], v14 offset:0
    ds_read_b128 v[44:47], v14 offset:4096
    v_smfmac_f32_16x16x64_bf16 v[124:127], v[72:75], v[136:143], v10
    ds_read_b128 v[48:51], v14 offset:1024
    ds_read_b128 v[52:55], v14 offset:5120
    v_mov_b32 v72, v11
    v_smfmac_f32_16x16x64_bf16 v[120:123], v[76:79], v[144:151], v10
    ds_read_b128 v[56:59], v14 offset:2048
    ds_read_b128 v[60:63], v14 offset:6144
    v_mov_b32 v73, v11
    v_smfmac_f32_16x16x64_bf16 v[124:127], v[76:79], v[152:159], v10
    ds_read_b128 v[64:67], v14 offset:3072
    ds_read_b128 v[68:71], v14 offset:7168
    v_mov_b32 v74, v11
    v_smfmac_f32_16x16x64_bf16 v[120:123], v[80:83], v[160:167], v10
    v_mov_b32 v75, v11
    v_smfmac_f32_16x16x64_bf16 v[124:127], v[80:83], v[168:175], v10
    s_waitcnt lgkmcnt(8)
    s_barrier
    ds_read_b64_tr_b16 v[104:105], v4 offset:0
    ds_read_b64_tr_b16 v[106:107], v4 offset:512
    v_smfmac_f32_16x16x64_bf16 v[120:123], v[84:87], v[176:183], v10
    ds_read_b64_tr_b16 v[108:109], v4 offset:1024
    ds_read_b64_tr_b16 v[110:111], v4 offset:1536
    v_smfmac_f32_16x16x64_bf16 v[124:127], v[84:87], v[184:191], v10
    ds_read_b64_tr_b16 v[112:113], v4 offset:2048
    ds_read_b64_tr_b16 v[114:115], v4 offset:2560
    v_smfmac_f32_16x16x64_bf16 v[120:123], v[88:91], v[192:199], v10
    ds_read_b64_tr_b16 v[116:117], v4 offset:3072
    ds_read_b64_tr_b16 v[118:119], v4 offset:3584
    v_smfmac_f32_16x16x64_bf16 v[124:127], v[88:91], v[200:207], v10
    v_smfmac_f32_16x16x64_bf16 v[120:123], v[92:95], v[208:215], v10
    v_smfmac_f32_16x16x64_bf16 v[124:127], v[92:95], v[216:223], v10
    s_xor_b32 s70, s15, 0x800
    s_waitcnt lgkmcnt(6)
    v_mfma_f32_16x16x32_bf16 v[72:75], v[104:107], v[104:107], v[72:75]
    v_add_u32 v0, s70, v1
    v_xor_b32 v14, 0x2000, v14
    v_mfma_f32_16x16x32_bf16 v[80:83], v[40:43], v[104:107], 0
    ds_read_b128 v[88:91], v0
    ds_read_b128 v[92:95], v0 offset:1024
    s_cmp_ge_u32 s23, 62
    v_mfma_f32_16x16x32_bf16 v[84:87], v[44:47], v[104:107], 0
    s_waitcnt lgkmcnt(6)
    v_mfma_f32_16x16x32_bf16 v[72:75], v[108:111], v[108:111], v[72:75]
    v_permlane32_swap_b32 v120, v124
    v_mfma_f32_16x16x32_bf16 v[80:83], v[48:51], v[108:111], v[80:83]
    v_permlane32_swap_b32 v121, v125
    v_mfma_f32_16x16x32_bf16 v[84:87], v[52:55], v[108:111], v[84:87]
    v_permlane32_swap_b32 v122, v126
    s_waitcnt lgkmcnt(4)
    v_mfma_f32_16x16x32_bf16 v[72:75], v[112:115], v[112:115], v[72:75]
    v_permlane32_swap_b32 v123, v127
    v_mfma_f32_16x16x32_bf16 v[80:83], v[56:59], v[112:115], v[80:83]
    v_add_f32 v120, v120, v124
    v_add_f32 v121, v121, v125
    v_mfma_f32_16x16x32_bf16 v[84:87], v[60:63], v[112:115], v[84:87]
    v_add_f32 v122, v122, v126
    v_add_f32 v123, v123, v127
    s_waitcnt lgkmcnt(2)
    v_mfma_f32_16x16x32_bf16 v[72:75], v[116:119], v[116:119], v[72:75]
    v_cvt_pk_bf16_f32 v96, v120, v121
    v_cvt_pk_bf16_f32 v97, v122, v123
    v_mfma_f32_16x16x32_bf16 v[80:83], v[64:67], v[116:119], v[80:83]
    v_mov_b64 v[98:99], v[96:97]
    v_min_u32 v20, -2, v96
    v_mfma_f32_16x16x32_bf16 v[84:87], v[68:71], v[116:119], v[84:87]
    v_min_u32 v21, -2, v97
    v_permlane32_swap_b32 v96, v98
    v_permlane32_swap_b32 v97, v99
    s_cbranch_scc1 L_early_3
L_t5_3:
    v_exp_f32 v72, v72
    v_exp_f32 v73, v73
    v_exp_f32 v74, v74
    v_exp_f32 v75, v75
    v_cvt_pk_bf16_f32 v76, v72, v73
    v_cvt_pk_bf16_f32 v77, v74, v75
    v_exp_f32 v80, v80
    v_exp_f32 v81, v81
    v_mfma_f32_16x16x16_bf16 v[120:123], v[96:97], v[76:77], 0
    v_exp_f32 v82, v82
    v_exp_f32 v83, v83
    v_mfma_f32_16x16x16_bf16 v[72:75], v[22:23], v[76:77], 0
    v_cvt_pk_bf16_f32 v124, v80, v81
    v_cvt_pk_bf16_f32 v125, v82, v83
    v_exp_f32 v84, v84
    v_mfma_f32_16x16x16_bf16 v[80:83], v[98:99], v[76:77], 0
    v_exp_f32 v85, v85
    v_exp_f32 v86, v86
    v_mfma_f32_16x16x16_bf16 v[72:75], v[22:23], v[124:125], v[72:75]
    v_exp_f32 v87, v87
    v_cvt_pk_bf16_f32 v126, v84, v85
    v_cvt_pk_bf16_f32 v127, v86, v87
    s_nop 1
    v_mfma_f32_16x16x16_bf16 v[72:75], v[22:23], v[126:127], v[72:75]
    s_waitcnt lgkmcnt(1)
    v_mfma_f32_16x16x32_bf16 v[120:123], v[88:91], v[124:127], v[120:123]
    s_waitcnt lgkmcnt(0)
    v_mfma_f32_16x16x32_bf16 v[80:83], v[92:95], v[124:127], v[80:83]
L_t7_3:
    s_mov_b32 exec_lo, 0x00ff00ff
    s_mov_b32 exec_hi, 0x00ff00ff
    s_nop 1
    v_rcp_f32 v102, v72
    v_subrev_u32 v101, 0x21800000, v72
    v_cmp_lt_u32 vcc, 0x3c000000, v101
    v_mul_f32 v120, v120, v102
    v_mul_f32 v121, v121, v102
    v_mul_f32 v122, v122, v102
    v_mul_f32 v123, v123, v102
    v_cvt_pk_bf16_f32 v76, v120, v121
    v_cvt_pk_bf16_f32 v77, v122, v123
    v_pk_mul_f32 v[80:81], v[80:81], v[102:103] op_sel_hi:[1,0]
    v_pk_mul_f32 v[82:83], v[82:83], v[102:103] op_sel_hi:[1,0]
    v_cvt_pk_bf16_f32 v78, v80, v81
    v_cvt_pk_bf16_f32 v79, v82, v83
    ds_write_b128 v5, v[76:79]
    s_mov_b64 exec, -1
    v_mov_b64 v[84:85], 0
    v_mov_b64 v[86:87], 0
    v_mov_b32_dpp v76, v76 row_shr:8 row_mask:0xf bank_mask:0xc
    v_mov_b32_dpp v77, v77 row_shr:8 row_mask:0xf bank_mask:0xc
    v_mov_b32_dpp v78, v78 row_shr:8 row_mask:0xf bank_mask:0xc
    v_mov_b32_dpp v79, v79 row_shr:8 row_mask:0xf bank_mask:0xc
    v_mov_b64 v[72:73], 0
    v_mov_b64 v[74:75], 0
    v_smfmac_f32_16x16x64_bf16 v[84:87], v[76:79], a[152:159], v10
    v_mov_b64 v[80:81], 0
    v_mov_b64 v[82:83], 0
    v_smfmac_f32_16x16x64_bf16 v[72:75], v[76:79], a[184:191], v10
    v_mov_b64 v[120:121], 0
    v_mov_b64 v[122:123], 0
    v_smfmac_f32_16x16x64_bf16 v[80:83], v[76:79], a[216:223], v10
    s_cbranch_vccnz L_safe_3
L_t7ok_3:
    s_waitcnt lgkmcnt(0)
    s_barrier
    ds_read_b128 v[88:91], v6 offset:0
    ds_read_b128 v[92:95], v6 offset:64
    ds_read_b128 v[96:99], v6 offset:128
    v_smfmac_f32_16x16x64_bf16 v[120:123], v[76:79], a[248:255], v10
    s_add_u32 s64, s64, 0x40000
    s_add_u32 s66, s66, 0x40000
    s_xor_b32 s14, s14, 0x2000
    s_xor_b32 s15, s15, 0x800
    s_mov_b32 s65, 0
    ds_read_b128 v[40:43], v12 offset:38912
    ds_read_b128 v[44:47], v12 offset:39936
    s_waitcnt lgkmcnt(4)
    v_smfmac_f32_16x16x64_bf16 v[84:87], v[88:91], a[128:135], v10
    s_waitcnt lgkmcnt(3)
    v_smfmac_f32_16x16x64_bf16 v[84:87], v[92:95], a[136:143], v10
    s_waitcnt lgkmcnt(2)
    v_smfmac_f32_16x16x64_bf16 v[84:87], v[96:99], a[144:151], v10
    ds_read_b128 v[48:51], v13 offset:4096
    v_smfmac_f32_16x16x64_bf16 v[72:75], v[88:91], a[160:167], v10
    ds_read_b128 v[52:55], v13 offset:5120
    v_smfmac_f32_16x16x64_bf16 v[72:75], v[92:95], a[168:175], v10
    ds_read_b128 v[56:59], v13 offset:6144
    s_nop 2
    v_cvt_pk_bf16_f32 v76, v84, v85
    v_smfmac_f32_16x16x64_bf16 v[72:75], v[96:99], a[176:183], v10
    ds_read_b128 v[60:63], v13 offset:7168
    v_cvt_pk_bf16_f32 v77, v86, v87
    v_smfmac_f32_16x16x64_bf16 v[80:83], v[88:91], a[192:199], v10
    v_and_or_b32 v76, v76, -2, s27
    v_smfmac_f32_16x16x64_bf16 v[80:83], v[92:95], a[200:207], v10
    v_and_or_b32 v77, v77, -2, s27
    v_smfmac_f32_16x16x64_bf16 v[80:83], v[96:99], a[208:215], v10
    s_nop 0
    v_cvt_pk_bf16_f32 v78, v72, v73
    v_cvt_pk_bf16_f32 v79, v74, v75
    buffer_store_dwordx2 v[76:77], v7, s[4:7], s29 offen offset:0
    s_waitcnt lgkmcnt(4)
    v_smfmac_f32_16x16x64_bf16 v[120:123], v[88:91], v[40:47], v10
    v_and_or_b32 v78, v78, -2, s27
    v_and_or_b32 v79, v79, -2, s27
    s_waitcnt lgkmcnt(2)
    v_smfmac_f32_16x16x64_bf16 v[120:123], v[92:95], v[48:55], v10
    buffer_store_dwordx2 v[78:79], v7, s[4:7], s29 offen offset:512
    s_waitcnt lgkmcnt(0)
    v_smfmac_f32_16x16x64_bf16 v[120:123], v[96:99], v[56:63], v10
    v_cvt_pk_bf16_f32 v84, v80, v81
    v_cvt_pk_bf16_f32 v85, v82, v83
    v_and_or_b32 v84, v84, -2, s27
    v_and_or_b32 v85, v85, -2, s27
    buffer_store_dwordx2 v[84:85], v7, s[4:7], s29 offen offset:1024
    s_nop 2
    v_cvt_pk_bf16_f32 v86, v120, v121
    v_cvt_pk_bf16_f32 v87, v122, v123
    v_and_or_b32 v86, v86, -2, s27
    v_and_or_b32 v87, v87, -2, s27
    buffer_store_dwordx2 v[86:87], v7, s[4:7], s29 offen offset:1536
    s_mov_b32 s17, 0
    v_lshrrev_b32 v0, 1, v7
    v_add_u32 v0, s18, v0
    s_waitcnt vmcnt(4)
    ds_read_b32 v124, v0
L_fl_3:
    s_waitcnt lgkmcnt(0)
    v_readlane_b32 s70, v124, s12
    s_cmp_gt_u32 s70, s13
    s_cbranch_scc0 L_flr_3
L_flok_3:
    s_add_u32 s12, s12, 1
    s_cmp_eq_u32 s12, 3
    s_addc_u32 s13, s13, 0
    s_cmp_eq_u32 s12, 3
    s_cselect_b32 s12, 0, s12
    v_mov_b64 v[104:105], 0
    v_mov_b64 v[106:107], 0
    v_mov_b64 v[108:109], 0
    v_mov_b64 v[110:111], 0
    v_mov_b64 v[112:113], 0
    v_mov_b64 v[114:115], 0
    v_mov_b64 v[116:117], 0
    v_mov_b64 v[118:119], 0
    v_mov_b64 v[120:121], 0
    v_mov_b64 v[122:123], 0
    v_mov_b64 v[124:125], 0
    v_mov_b64 v[126:127], 0
    s_add_u32 s23, s23, 1
    s_xor_b32 s27, s27, 1
    s_not_b32 s28, s28
    s_barrier
    s_nop 15
    s_branch L_top_3
L_flr_p1:
    s_cmp_ge_u32 s13, 21
    s_cbranch_scc1 L_flok_p1
    s_sleep 4
    buffer_load_dword v124, v7, s[4:7], s16 offen sc1
    s_add_u32 s31, s31, 1
    s_cmp_gt_u32 s31, 1048576
    s_cbranch_scc1 L_abort
    s_waitcnt vmcnt(0)
    s_branch L_fl_p1
L_t1r_0_0:
    s_waitcnt vmcnt(0)
    v_mov_b64 v[72:73], v[96:97]
    v_mov_b64 v[74:75], v[98:99]
    v_mov_b64 v[76:77], v[84:85]
    v_mov_b64 v[78:79], v[86:87]
    v_max3_u32 v92, v72, v73, v74
    v_max3_u32 v93, v75, v76, v77
    v_max3_u32 v94, v92, v93, v78
    v_max_u32 v95, v94, v79
    v_cmp_eq_u32 vcc, -1, v95
    s_nop 0
    s_cbranch_vccz L_t1w_0_0
L_t1q_0_0:
    s_mov_b64 exec, vcc
    buffer_load_dwordx4 v[72:75], v15, s[4:7], s19 offen offset:0 sc1
    buffer_load_dwordx4 v[76:79], v15, s[4:7], s19 offen offset:1024 sc1
    s_mov_b64 exec, -1
    s_add_u32 s31, s31, 1
    s_cmp_gt_u32 s31, 1048576
    s_cbranch_scc1 L_abort
    s_waitcnt vmcnt(1)
    v_max3_u32 v92, v72, v73, v74
    s_waitcnt vmcnt(0)
    v_max3_u32 v93, v75, v76, v77
    v_max3_u32 v94, v92, v93, v78
    v_max_u32 v95, v94, v79
    v_cmp_eq_u32 vcc, -1, v95
    s_nop 0
    s_cbranch_vccnz L_t1q_0_0
L_t1w_0_0:
    ds_write_b128 v2, v[72:75] offset:0
    ds_write_b128 v2, v[76:79] offset:1024
    s_branch L_t1ok_0_0
L_early_0:
    ds_read_b64_tr_b16 v[76:77], v4 offset:0
    ds_read_b64_tr_b16 v[78:79], v4 offset:512
    buffer_store_dwordx2 v[20:21], v7, s[4:7], s68 offen offset:0 sc1
    s_waitcnt lgkmcnt(1)
    v_min_u32 v76, -2, v76
    v_min_u32 v77, -2, v77
    s_waitcnt lgkmcnt(0)
    v_min_u32 v78, -2, v78
    v_min_u32 v79, -2, v79
    buffer_store_dwordx4 v[76:79], v1, s[4:7], s67 offen offset:0 sc1
    s_cmp_eq_u32 s23, 62
    s_cbranch_scc1 L_t5_0
    s_endpgm
L_safe_0:
    s_cmp_eq_u32 s65, 1
    s_cbranch_scc1 L_t7ok_0
    s_mov_b32 s65, 1
    s_nop 7
    v_mov_b32 v72, v11
    v_mov_b32 v73, v11
    v_mov_b32 v74, v11
    v_mov_b32 v75, v11
    s_nop 1
    v_mfma_f32_16x16x32_bf16 v[72:75], v[104:107], v[104:107], v[72:75]
    v_mfma_f32_16x16x32_bf16 v[80:83], v[40:43], v[104:107], 0
    v_mfma_f32_16x16x32_bf16 v[84:87], v[44:47], v[104:107], 0
    v_mfma_f32_16x16x32_bf16 v[72:75], v[108:111], v[108:111], v[72:75]
    v_mfma_f32_16x16x32_bf16 v[80:83], v[48:51], v[108:111], v[80:83]
    v_mfma_f32_16x16x32_bf16 v[84:87], v[52:55], v[108:111], v[84:87]
    v_mfma_f32_16x16x32_bf16 v[72:75], v[112:115], v[112:115], v[72:75]
    v_mfma_f32_16x16x32_bf16 v[80:83], v[56:59], v[112:115], v[80:83]
    v_mfma_f32_16x16x32_bf16 v[84:87], v[60:63], v[112:115], v[84:87]
    v_mfma_f32_16x16x32_bf16 v[72:75], v[116:119], v[116:119], v[72:75]
    v_mfma_f32_16x16x32_bf16 v[80:83], v[64:67], v[116:119], v[80:83]
    v_mfma_f32_16x16x32_bf16 v[84:87], v[68:71], v[116:119], v[84:87]
    s_nop 5
    v_max3_f32 v76, v72, v73, v74
    v_max3_f32 v77, v75, v80, v81
    v_max3_f32 v78, v82, v83, v84
    v_max3_f32 v79, v85, v86, v87
    v_max3_f32 v100, v76, v77, v78
    v_max_f32 v101, v100, v79
    v_mov_b32 v102, v101
    s_nop 1
    v_permlane16_swap_b32 v101, v102
    v_max_f32 v101, v101, v102
    v_mov_b32 v102, v101
    s_nop 1
    v_permlane32_swap_b32 v101, v102
    v_max_f32 v101, v101, v102
    v_sub_f32 v72, v72, v101
    v_sub_f32 v73, v73, v101
    v_sub_f32 v74, v74, v101
    v_sub_f32 v75, v75, v101
    v_sub_f32 v80, v80, v101
    v_sub_f32 v81, v81, v101
    v_sub_f32 v82, v82, v101
    v_sub_f32 v83, v83, v101
    v_sub_f32 v84, v84, v101
    v_sub_f32 v85, v85, v101
    v_sub_f32 v86, v86, v101
    v_sub_f32 v87, v87, v101
    v_exp_f32 v72, v72
    v_exp_f32 v73, v73
    v_exp_f32 v74, v74
    v_exp_f32 v75, v75
    v_cvt_pk_bf16_f32 v76, v72, v73
    v_cvt_pk_bf16_f32 v77, v74, v75
    v_exp_f32 v80, v80
    v_exp_f32 v81, v81
    v_mfma_f32_16x16x16_bf16 v[120:123], v[96:97], v[76:77], 0
    v_exp_f32 v82, v82
    v_exp_f32 v83, v83
    v_mfma_f32_16x16x16_bf16 v[72:75], v[22:23], v[76:77], 0
    v_cvt_pk_bf16_f32 v124, v80, v81
    v_cvt_pk_bf16_f32 v125, v82, v83
    v_exp_f32 v84, v84
    v_mfma_f32_16x16x16_bf16 v[80:83], v[98:99], v[76:77], 0
    v_exp_f32 v85, v85
    v_exp_f32 v86, v86
    v_mfma_f32_16x16x16_bf16 v[72:75], v[22:23], v[124:125], v[72:75]
    v_exp_f32 v87, v87
    v_cvt_pk_bf16_f32 v126, v84, v85
    v_cvt_pk_bf16_f32 v127, v86, v87
    s_nop 1
    v_mfma_f32_16x16x16_bf16 v[72:75], v[22:23], v[126:127], v[72:75]
    v_mfma_f32_16x16x32_bf16 v[120:123], v[88:91], v[124:127], v[120:123]
    v_mfma_f32_16x16x32_bf16 v[80:83], v[92:95], v[124:127], v[80:83]
    s_nop 6
    s_branch L_t7_0
L_t9s_0:
    s_cmp_eq_u32 s17, 0
    s_mov_b32 s17, 1
    s_cbranch_scc0 L_t9t_0
    s_waitcnt vmcnt(3)
    v_mfma_f32_16x16x32_bf16 v[48:51], v[16:19], v[88:91], 0
    v_bitop3_b32 v56, v88, v89, s28 bitop3:0x42
    v_bitop3_b32 v57, v90, v91, s28 bitop3:0x42
    s_waitcnt vmcnt(2)
    v_mfma_f32_16x16x32_bf16 v[48:51], v[16:19], v[92:95], v[48:51]
    v_bitop3_b32 v58, v92, v93, s28 bitop3:0x42
    v_bitop3_b32 v59, v94, v95, s28 bitop3:0x42
    v_bitop3_b32 v56, v56, v57, v58 bitop3:0x80
    s_waitcnt vmcnt(1)
    v_mfma_f32_16x16x32_bf16 v[48:51], v[16:19], v[96:99], v[48:51]
    v_bitop3_b32 v60, v96, v97, s28 bitop3:0x42
    v_bitop3_b32 v61, v98, v99, s28 bitop3:0x42
    v_bitop3_b32 v57, v59, v60, v61 bitop3:0x80
    s_waitcnt vmcnt(0)
    v_mfma_f32_16x16x32_bf16 v[48:51], v[16:19], v[100:103], v[48:51]
    v_bitop3_b32 v62, v100, v101, s28 bitop3:0x42
    v_bitop3_b32 v63, v102, v103, s28 bitop3:0x42
    v_bitop3_b32 v56, v56, v57, 1 bitop3:0x80
    v_bitop3_b32 v56, v56, v62, v63 bitop3:0x80
    v_cmp_eq_u32 vcc, 0, v56
    s_nop 1
    s_cbranch_vccz L_t9f_0
    s_mov_b64 vcc, -1
L_t9t_0:
    s_mov_b64 exec, vcc
    s_mov_b32 s17, 1
    buffer_load_dwordx4 v[72:75], v8, s[4:7], s25 offen sc1
    buffer_load_dwordx4 v[76:79], v8, s[4:7], s26 offen sc1
    buffer_load_dwordx4 v[80:83], v8, s[4:7], s2 offen sc1
    buffer_load_dwordx4 v[84:87], v8, s[4:7], s3 offen sc1
    s_mov_b64 exec, -1
    s_add_u32 s31, s31, 1
    s_cmp_gt_u32 s31, 1048576
    s_cbranch_scc1 L_abort
    s_waitcnt vmcnt(3)
    v_mfma_f32_16x16x32_bf16 v[48:51], v[16:19], v[72:75], 0
    v_bitop3_b32 v56, v72, v73, s28 bitop3:0x42
    v_bitop3_b32 v57, v74, v75, s28 bitop3:0x42
    s_waitcnt vmcnt(2)
    v_mfma_f32_16x16x32_bf16 v[48:51], v[16:19], v[76:79], v[48:51]
    v_bitop3_b32 v58, v76, v77, s28 bitop3:0x42
    v_bitop3_b32 v59, v78, v79, s28 bitop3:0x42
    v_bitop3_b32 v56, v56, v57, v58 bitop3:0x80
    s_waitcnt vmcnt(1)
    v_mfma_f32_16x16x32_bf16 v[48:51], v[16:19], v[80:83], v[48:51]
    v_bitop3_b32 v60, v80, v81, s28 bitop3:0x42
    v_bitop3_b32 v61, v82, v83, s28 bitop3:0x42
    v_bitop3_b32 v57, v59, v60, v61 bitop3:0x80
    s_waitcnt vmcnt(0)
    v_mfma_f32_16x16x32_bf16 v[48:51], v[16:19], v[84:87], v[48:51]
    v_bitop3_b32 v62, v84, v85, s28 bitop3:0x42
    v_bitop3_b32 v63, v86, v87, s28 bitop3:0x42
    v_bitop3_b32 v56, v56, v57, 1 bitop3:0x80
    v_bitop3_b32 v56, v56, v62, v63 bitop3:0x80
    v_cmp_eq_u32 vcc, 0, v56
    s_nop 1
    s_branch L_t9f_0
L_t1r_1_0:
    s_waitcnt vmcnt(0)
    v_mov_b64 v[80:81], v[72:73]
    v_mov_b64 v[82:83], v[74:75]
    v_mov_b64 v[84:85], v[92:93]
    v_mov_b64 v[86:87], v[94:95]
    v_max3_u32 v100, v80, v81, v82
    v_max3_u32 v101, v83, v84, v85
    v_max3_u32 v102, v100, v101, v86
    v_max_u32 v103, v102, v87
    v_cmp_eq_u32 vcc, -1, v103
    s_nop 0
    s_cbranch_vccz L_t1w_1_0
L_t1q_1_0:
    s_mov_b64 exec, vcc
    buffer_load_dwordx4 v[80:83], v15, s[4:7], s19 offen offset:0 sc1
    buffer_load_dwordx4 v[84:87], v15, s[4:7], s19 offen offset:1024 sc1
    s_mov_b64 exec, -1
    s_add_u32 s31, s31, 1
    s_cmp_gt_u32 s31, 1048576
    s_cbranch_scc1 L_abort
    s_waitcnt vmcnt(1)
    v_max3_u32 v100, v80, v81, v82
    s_waitcnt vmcnt(0)
    v_max3_u32 v101, v83, v84, v85
    v_max3_u32 v102, v100, v101, v86
    v_max_u32 v103, v102, v87
    v_cmp_eq_u32 vcc, -1, v103
    s_nop 0
    s_cbranch_vccnz L_t1q_1_0
L_t1w_1_0:
    ds_write_b128 v2, v[80:83] offset:2048
    ds_write_b128 v2, v[84:87] offset:3072
    s_branch L_t1ok_1_0
L_early_1:
    ds_read_b64_tr_b16 v[76:77], v4 offset:1024
    ds_read_b64_tr_b16 v[78:79], v4 offset:1536
    buffer_store_dwordx2 v[20:21], v7, s[4:7], s68 offen offset:512 sc1
    s_waitcnt lgkmcnt(1)
    v_min_u32 v76, -2, v76
    v_min_u32 v77, -2, v77
    s_waitcnt lgkmcnt(0)
    v_min_u32 v78, -2, v78
    v_min_u32 v79, -2, v79
    buffer_store_dwordx4 v[76:79], v1, s[4:7], s67 offen offset:1024 sc1
    s_cmp_eq_u32 s23, 62
    s_cbranch_scc1 L_t5_1
    s_endpgm
L_safe_1:
    s_cmp_eq_u32 s65, 1
    s_cbranch_scc1 L_t7ok_1
    s_mov_b32 s65, 1
    s_nop 7
    v_mov_b32 v72, v11
    v_mov_b32 v73, v11
    v_mov_b32 v74, v11
    v_mov_b32 v75, v11
    s_nop 1
    v_mfma_f32_16x16x32_bf16 v[72:75], v[104:107], v[104:107], v[72:75]
    v_mfma_f32_16x16x32_bf16 v[80:83], v[40:43], v[104:107], 0
    v_mfma_f32_16x16x32_bf16 v[84:87], v[44:47], v[104:107], 0
    v_mfma_f32_16x16x32_bf16 v[72:75], v[108:111], v[108:111], v[72:75]
    v_mfma_f32_16x16x32_bf16 v[80:83], v[48:51], v[108:111], v[80:83]
    v_mfma_f32_16x16x32_bf16 v[84:87], v[52:55], v[108:111], v[84:87]
    v_mfma_f32_16x16x32_bf16 v[72:75], v[112:115], v[112:115], v[72:75]
    v_mfma_f32_16x16x32_bf16 v[80:83], v[56:59], v[112:115], v[80:83]
    v_mfma_f32_16x16x32_bf16 v[84:87], v[60:63], v[112:115], v[84:87]
    v_mfma_f32_16x16x32_bf16 v[72:75], v[116:119], v[116:119], v[72:75]
    v_mfma_f32_16x16x32_bf16 v[80:83], v[64:67], v[116:119], v[80:83]
    v_mfma_f32_16x16x32_bf16 v[84:87], v[68:71], v[116:119], v[84:87]
    s_nop 5
    v_max3_f32 v76, v72, v73, v74
    v_max3_f32 v77, v75, v80, v81
    v_max3_f32 v78, v82, v83, v84
    v_max3_f32 v79, v85, v86, v87
    v_max3_f32 v100, v76, v77, v78
    v_max_f32 v101, v100, v79
    v_mov_b32 v102, v101
    s_nop 1
    v_permlane16_swap_b32 v101, v102
    v_max_f32 v101, v101, v102
    v_mov_b32 v102, v101
    s_nop 1
    v_permlane32_swap_b32 v101, v102
    v_max_f32 v101, v101, v102
    v_sub_f32 v72, v72, v101
    v_sub_f32 v73, v73, v101
    v_sub_f32 v74, v74, v101
    v_sub_f32 v75, v75, v101
    v_sub_f32 v80, v80, v101
    v_sub_f32 v81, v81, v101
    v_sub_f32 v82, v82, v101
    v_sub_f32 v83, v83, v101
    v_sub_f32 v84, v84, v101
    v_sub_f32 v85, v85, v101
    v_sub_f32 v86, v86, v101
    v_sub_f32 v87, v87, v101
    v_exp_f32 v72, v72
    v_exp_f32 v73, v73
    v_exp_f32 v74, v74
    v_exp_f32 v75, v75
    v_cvt_pk_bf16_f32 v76, v72, v73
    v_cvt_pk_bf16_f32 v77, v74, v75
    v_exp_f32 v80, v80
    v_exp_f32 v81, v81
    v_mfma_f32_16x16x16_bf16 v[120:123], v[96:97], v[76:77], 0
    v_exp_f32 v82, v82
    v_exp_f32 v83, v83
    v_mfma_f32_16x16x16_bf16 v[72:75], v[22:23], v[76:77], 0
    v_cvt_pk_bf16_f32 v124, v80, v81
    v_cvt_pk_bf16_f32 v125, v82, v83
    v_exp_f32 v84, v84
    v_mfma_f32_16x16x16_bf16 v[80:83], v[98:99], v[76:77], 0
    v_exp_f32 v85, v85
    v_exp_f32 v86, v86
    v_mfma_f32_16x16x16_bf16 v[72:75], v[22:23], v[124:125], v[72:75]
    v_exp_f32 v87, v87
    v_cvt_pk_bf16_f32 v126, v84, v85
    v_cvt_pk_bf16_f32 v127, v86, v87
    s_nop 1
    v_mfma_f32_16x16x16_bf16 v[72:75], v[22:23], v[126:127], v[72:75]
    v_mfma_f32_16x16x32_bf16 v[120:123], v[88:91], v[124:127], v[120:123]
    v_mfma_f32_16x16x32_bf16 v[80:83], v[92:95], v[124:127], v[80:83]
    s_nop 6
    s_branch L_t7_1
L_flr_1:
    s_cmp_ge_u32 s13, 21
    s_cbranch_scc1 L_flok_1
    s_sleep 4
    buffer_load_dword v124, v7, s[4:7], s16 offen sc1
    s_add_u32 s31, s31, 1
    s_cmp_gt_u32 s31, 1048576
    s_cbranch_scc1 L_abort
    s_waitcnt vmcnt(0)
    s_branch L_fl_1
L_t1r_2_0:
    s_waitcnt vmcnt(0)
    v_mov_b64 v[88:89], v[80:81]
    v_mov_b64 v[90:91], v[82:83]
    v_mov_b64 v[92:93], v[100:101]
    v_mov_b64 v[94:95], v[102:103]
    v_max3_u32 v76, v88, v89, v90
    v_max3_u32 v77, v91, v92, v93
    v_max3_u32 v78, v76, v77, v94
    v_max_u32 v79, v78, v95
    v_cmp_eq_u32 vcc, -1, v79
    s_nop 0
    s_cbranch_vccz L_t1w_2_0
L_t1q_2_0:
    s_mov_b64 exec, vcc
    buffer_load_dwordx4 v[88:91], v15, s[4:7], s19 offen offset:0 sc1
    buffer_load_dwordx4 v[92:95], v15, s[4:7], s19 offen offset:1024 sc1
    s_mov_b64 exec, -1
    s_add_u32 s31, s31, 1
    s_cmp_gt_u32 s31, 1048576
    s_cbranch_scc1 L_abort
    s_waitcnt vmcnt(1)
    v_max3_u32 v76, v88, v89, v90
    s_waitcnt vmcnt(0)
    v_max3_u32 v77, v91, v92, v93
    v_max3_u32 v78, v76, v77, v94
    v_max_u32 v79, v78, v95
    v_cmp_eq_u32 vcc, -1, v79
    s_nop 0
    s_cbranch_vccnz L_t1q_2_0
L_t1w_2_0:
    ds_write_b128 v2, v[88:91] offset:4096
    ds_write_b128 v2, v[92:95] offset:5120
    s_branch L_t1ok_2_0
L_early_2:
    ds_read_b64_tr_b16 v[76:77], v4 offset:2048
    ds_read_b64_tr_b16 v[78:79], v4 offset:2560
    buffer_store_dwordx2 v[20:21], v7, s[4:7], s68 offen offset:0 sc1
    s_waitcnt lgkmcnt(1)
    v_min_u32 v76, -2, v76
    v_min_u32 v77, -2, v77
    s_waitcnt lgkmcnt(0)
    v_min_u32 v78, -2, v78
    v_min_u32 v79, -2, v79
    buffer_store_dwordx4 v[76:79], v1, s[4:7], s67 offen offset:0 sc1
    s_cmp_eq_u32 s23, 62
    s_cbranch_scc1 L_t5_2
    s_endpgm
L_safe_2:
    s_cmp_eq_u32 s65, 1
    s_cbranch_scc1 L_t7ok_2
    s_mov_b32 s65, 1
    s_nop 7
    v_mov_b32 v72, v11
    v_mov_b32 v73, v11
    v_mov_b32 v74, v11
    v_mov_b32 v75, v11
    s_nop 1
    v_mfma_f32_16x16x32_bf16 v[72:75], v[104:107], v[104:107], v[72:75]
    v_mfma_f32_16x16x32_bf16 v[80:83], v[40:43], v[104:107], 0
    v_mfma_f32_16x16x32_bf16 v[84:87], v[44:47], v[104:107], 0
    v_mfma_f32_16x16x32_bf16 v[72:75], v[108:111], v[108:111], v[72:75]
    v_mfma_f32_16x16x32_bf16 v[80:83], v[48:51], v[108:111], v[80:83]
    v_mfma_f32_16x16x32_bf16 v[84:87], v[52:55], v[108:111], v[84:87]
    v_mfma_f32_16x16x32_bf16 v[72:75], v[112:115], v[112:115], v[72:75]
    v_mfma_f32_16x16x32_bf16 v[80:83], v[56:59], v[112:115], v[80:83]
    v_mfma_f32_16x16x32_bf16 v[84:87], v[60:63], v[112:115], v[84:87]
    v_mfma_f32_16x16x32_bf16 v[72:75], v[116:119], v[116:119], v[72:75]
    v_mfma_f32_16x16x32_bf16 v[80:83], v[64:67], v[116:119], v[80:83]
    v_mfma_f32_16x16x32_bf16 v[84:87], v[68:71], v[116:119], v[84:87]
    s_nop 5
    v_max3_f32 v76, v72, v73, v74
    v_max3_f32 v77, v75, v80, v81
    v_max3_f32 v78, v82, v83, v84
    v_max3_f32 v79, v85, v86, v87
    v_max3_f32 v100, v76, v77, v78
    v_max_f32 v101, v100, v79
    v_mov_b32 v102, v101
    s_nop 1
    v_permlane16_swap_b32 v101, v102
    v_max_f32 v101, v101, v102
    v_mov_b32 v102, v101
    s_nop 1
    v_permlane32_swap_b32 v101, v102
    v_max_f32 v101, v101, v102
    v_sub_f32 v72, v72, v101
    v_sub_f32 v73, v73, v101
    v_sub_f32 v74, v74, v101
    v_sub_f32 v75, v75, v101
    v_sub_f32 v80, v80, v101
    v_sub_f32 v81, v81, v101
    v_sub_f32 v82, v82, v101
    v_sub_f32 v83, v83, v101
    v_sub_f32 v84, v84, v101
    v_sub_f32 v85, v85, v101
    v_sub_f32 v86, v86, v101
    v_sub_f32 v87, v87, v101
    v_exp_f32 v72, v72
    v_exp_f32 v73, v73
    v_exp_f32 v74, v74
    v_exp_f32 v75, v75
    v_cvt_pk_bf16_f32 v76, v72, v73
    v_cvt_pk_bf16_f32 v77, v74, v75
    v_exp_f32 v80, v80
    v_exp_f32 v81, v81
    v_mfma_f32_16x16x16_bf16 v[120:123], v[96:97], v[76:77], 0
    v_exp_f32 v82, v82
    v_exp_f32 v83, v83
    v_mfma_f32_16x16x16_bf16 v[72:75], v[22:23], v[76:77], 0
    v_cvt_pk_bf16_f32 v124, v80, v81
    v_cvt_pk_bf16_f32 v125, v82, v83
    v_exp_f32 v84, v84
    v_mfma_f32_16x16x16_bf16 v[80:83], v[98:99], v[76:77], 0
    v_exp_f32 v85, v85
    v_exp_f32 v86, v86
    v_mfma_f32_16x16x16_bf16 v[72:75], v[22:23], v[124:125], v[72:75]
    v_exp_f32 v87, v87
    v_cvt_pk_bf16_f32 v126, v84, v85
    v_cvt_pk_bf16_f32 v127, v86, v87
    s_nop 1
    v_mfma_f32_16x16x16_bf16 v[72:75], v[22:23], v[126:127], v[72:75]
    v_mfma_f32_16x16x32_bf16 v[120:123], v[88:91], v[124:127], v[120:123]
    v_mfma_f32_16x16x32_bf16 v[80:83], v[92:95], v[124:127], v[80:83]
    s_nop 6
    s_branch L_t7_2
L_t9s_2:
    s_cmp_eq_u32 s17, 0
    s_mov_b32 s17, 1
    s_cbranch_scc0 L_t9t_2
    s_waitcnt vmcnt(3)
    v_mfma_f32_16x16x32_bf16 v[48:51], v[16:19], v[72:75], 0
    v_bitop3_b32 v56, v72, v73, s28 bitop3:0x42
    v_bitop3_b32 v57, v74, v75, s28 bitop3:0x42
    s_waitcnt vmcnt(2)
    v_mfma_f32_16x16x32_bf16 v[48:51], v[16:19], v[76:79], v[48:51]
    v_bitop3_b32 v58, v76, v77, s28 bitop3:0x42
    v_bitop3_b32 v59, v78, v79, s28 bitop3:0x42
    v_bitop3_b32 v56, v56, v57, v58 bitop3:0x80
    s_waitcnt vmcnt(1)
    v_mfma_f32_16x16x32_bf16 v[48:51], v[16:19], v[80:83], v[48:51]
    v_bitop3_b32 v60, v80, v81, s28 bitop3:0x42
    v_bitop3_b32 v61, v82, v83, s28 bitop3:0x42
    v_bitop3_b32 v57, v59, v60, v61 bitop3:0x80
    s_waitcnt vmcnt(0)
    v_mfma_f32_16x16x32_bf16 v[48:51], v[16:19], v[84:87], v[48:51]
    v_bitop3_b32 v62, v84, v85, s28 bitop3:0x42
    v_bitop3_b32 v63, v86, v87, s28 bitop3:0x42
    v_bitop3_b32 v56, v56, v57, 1 bitop3:0x80
    v_bitop3_b32 v56, v56, v62, v63 bitop3:0x80
    v_cmp_eq_u32 vcc, 0, v56
    s_nop 1
    s_cbranch_vccz L_t9f_2
    s_mov_b64 vcc, -1
L_t9t_2:
    s_mov_b64 exec, vcc
    s_mov_b32 s17, 1
    buffer_load_dwordx4 v[88:91], v8, s[4:7], s25 offen sc1
    buffer_load_dwordx4 v[92:95], v8, s[4:7], s26 offen sc1
    buffer_load_dwordx4 v[96:99], v8, s[4:7], s2 offen sc1
    buffer_load_dwordx4 v[100:103], v8, s[4:7], s3 offen sc1
    s_mov_b64 exec, -1
    s_add_u32 s31, s31, 1
    s_cmp_gt_u32 s31, 1048576
    s_cbranch_scc1 L_abort
    s_waitcnt vmcnt(3)
    v_mfma_f32_16x16x32_bf16 v[48:51], v[16:19], v[88:91], 0
    v_bitop3_b32 v56, v88, v89, s28 bitop3:0x42
    v_bitop3_b32 v57, v90, v91, s28 bitop3:0x42
    s_waitcnt vmcnt(2)
    v_mfma_f32_16x16x32_bf16 v[48:51], v[16:19], v[92:95], v[48:51]
    v_bitop3_b32 v58, v92, v93, s28 bitop3:0x42
    v_bitop3_b32 v59, v94, v95, s28 bitop3:0x42
    v_bitop3_b32 v56, v56, v57, v58 bitop3:0x80
    s_waitcnt vmcnt(1)
    v_mfma_f32_16x16x32_bf16 v[48:51], v[16:19], v[96:99], v[48:51]
    v_bitop3_b32 v60, v96, v97, s28 bitop3:0x42
    v_bitop3_b32 v61, v98, v99, s28 bitop3:0x42
    v_bitop3_b32 v57, v59, v60, v61 bitop3:0x80
    s_waitcnt vmcnt(0)
    v_mfma_f32_16x16x32_bf16 v[48:51], v[16:19], v[100:103], v[48:51]
    v_bitop3_b32 v62, v100, v101, s28 bitop3:0x42
    v_bitop3_b32 v63, v102, v103, s28 bitop3:0x42
    v_bitop3_b32 v56, v56, v57, 1 bitop3:0x80
    v_bitop3_b32 v56, v56, v62, v63 bitop3:0x80
    v_cmp_eq_u32 vcc, 0, v56
    s_nop 1
    s_branch L_t9f_2
L_t1r_3_0:
    s_waitcnt vmcnt(0)
    v_mov_b64 v[96:97], v[88:89]
    v_mov_b64 v[98:99], v[90:91]
    v_mov_b64 v[100:101], v[76:77]
    v_mov_b64 v[102:103], v[78:79]
    v_max3_u32 v84, v96, v97, v98
    v_max3_u32 v85, v99, v100, v101
    v_max3_u32 v86, v84, v85, v102
    v_max_u32 v87, v86, v103
    v_cmp_eq_u32 vcc, -1, v87
    s_nop 0
    s_cbranch_vccz L_t1w_3_0
L_t1q_3_0:
    s_mov_b64 exec, vcc
    buffer_load_dwordx4 v[96:99], v15, s[4:7], s19 offen offset:0 sc1
    buffer_load_dwordx4 v[100:103], v15, s[4:7], s19 offen offset:1024 sc1
    s_mov_b64 exec, -1
    s_add_u32 s31, s31, 1
    s_cmp_gt_u32 s31, 1048576
    s_cbranch_scc1 L_abort
    s_waitcnt vmcnt(1)
    v_max3_u32 v84, v96, v97, v98
    s_waitcnt vmcnt(0)
    v_max3_u32 v85, v99, v100, v101
    v_max3_u32 v86, v84, v85, v102
    v_max_u32 v87, v86, v103
    v_cmp_eq_u32 vcc, -1, v87
    s_nop 0
    s_cbranch_vccnz L_t1q_3_0
L_t1w_3_0:
    ds_write_b128 v2, v[96:99] offset:6144
    ds_write_b128 v2, v[100:103] offset:7168
    s_branch L_t1ok_3_0
L_early_3:
    ds_read_b64_tr_b16 v[76:77], v4 offset:3072
    ds_read_b64_tr_b16 v[78:79], v4 offset:3584
    buffer_store_dwordx2 v[20:21], v7, s[4:7], s68 offen offset:512 sc1
    s_waitcnt lgkmcnt(1)
    v_min_u32 v76, -2, v76
    v_min_u32 v77, -2, v77
    s_waitcnt lgkmcnt(0)
    v_min_u32 v78, -2, v78
    v_min_u32 v79, -2, v79
    buffer_store_dwordx4 v[76:79], v1, s[4:7], s67 offen offset:1024 sc1
    s_cmp_eq_u32 s23, 62
    s_cbranch_scc1 L_t5_3
    s_endpgm
L_safe_3:
    s_cmp_eq_u32 s65, 1
    s_cbranch_scc1 L_t7ok_3
    s_mov_b32 s65, 1
    s_nop 7
    v_mov_b32 v72, v11
    v_mov_b32 v73, v11
    v_mov_b32 v74, v11
    v_mov_b32 v75, v11
    s_nop 1
    v_mfma_f32_16x16x32_bf16 v[72:75], v[104:107], v[104:107], v[72:75]
    v_mfma_f32_16x16x32_bf16 v[80:83], v[40:43], v[104:107], 0
    v_mfma_f32_16x16x32_bf16 v[84:87], v[44:47], v[104:107], 0
    v_mfma_f32_16x16x32_bf16 v[72:75], v[108:111], v[108:111], v[72:75]
    v_mfma_f32_16x16x32_bf16 v[80:83], v[48:51], v[108:111], v[80:83]
    v_mfma_f32_16x16x32_bf16 v[84:87], v[52:55], v[108:111], v[84:87]
    v_mfma_f32_16x16x32_bf16 v[72:75], v[112:115], v[112:115], v[72:75]
    v_mfma_f32_16x16x32_bf16 v[80:83], v[56:59], v[112:115], v[80:83]
    v_mfma_f32_16x16x32_bf16 v[84:87], v[60:63], v[112:115], v[84:87]
    v_mfma_f32_16x16x32_bf16 v[72:75], v[116:119], v[116:119], v[72:75]
    v_mfma_f32_16x16x32_bf16 v[80:83], v[64:67], v[116:119], v[80:83]
    v_mfma_f32_16x16x32_bf16 v[84:87], v[68:71], v[116:119], v[84:87]
    s_nop 5
    v_max3_f32 v76, v72, v73, v74
    v_max3_f32 v77, v75, v80, v81
    v_max3_f32 v78, v82, v83, v84
    v_max3_f32 v79, v85, v86, v87
    v_max3_f32 v100, v76, v77, v78
    v_max_f32 v101, v100, v79
    v_mov_b32 v102, v101
    s_nop 1
    v_permlane16_swap_b32 v101, v102
    v_max_f32 v101, v101, v102
    v_mov_b32 v102, v101
    s_nop 1
    v_permlane32_swap_b32 v101, v102
    v_max_f32 v101, v101, v102
    v_sub_f32 v72, v72, v101
    v_sub_f32 v73, v73, v101
    v_sub_f32 v74, v74, v101
    v_sub_f32 v75, v75, v101
    v_sub_f32 v80, v80, v101
    v_sub_f32 v81, v81, v101
    v_sub_f32 v82, v82, v101
    v_sub_f32 v83, v83, v101
    v_sub_f32 v84, v84, v101
    v_sub_f32 v85, v85, v101
    v_sub_f32 v86, v86, v101
    v_sub_f32 v87, v87, v101
    v_exp_f32 v72, v72
    v_exp_f32 v73, v73
    v_exp_f32 v74, v74
    v_exp_f32 v75, v75
    v_cvt_pk_bf16_f32 v76, v72, v73
    v_cvt_pk_bf16_f32 v77, v74, v75
    v_exp_f32 v80, v80
    v_exp_f32 v81, v81
    v_mfma_f32_16x16x16_bf16 v[120:123], v[96:97], v[76:77], 0
    v_exp_f32 v82, v82
    v_exp_f32 v83, v83
    v_mfma_f32_16x16x16_bf16 v[72:75], v[22:23], v[76:77], 0
    v_cvt_pk_bf16_f32 v124, v80, v81
    v_cvt_pk_bf16_f32 v125, v82, v83
    v_exp_f32 v84, v84
    v_mfma_f32_16x16x16_bf16 v[80:83], v[98:99], v[76:77], 0
    v_exp_f32 v85, v85
    v_exp_f32 v86, v86
    v_mfma_f32_16x16x16_bf16 v[72:75], v[22:23], v[124:125], v[72:75]
    v_exp_f32 v87, v87
    v_cvt_pk_bf16_f32 v126, v84, v85
    v_cvt_pk_bf16_f32 v127, v86, v87
    s_nop 1
    v_mfma_f32_16x16x16_bf16 v[72:75], v[22:23], v[126:127], v[72:75]
    v_mfma_f32_16x16x32_bf16 v[120:123], v[88:91], v[124:127], v[120:123]
    v_mfma_f32_16x16x32_bf16 v[80:83], v[92:95], v[124:127], v[80:83]
    s_nop 6
    s_branch L_t7_3
L_flr_3:
    s_cmp_ge_u32 s13, 21
    s_cbranch_scc1 L_flok_3
    s_sleep 4
    buffer_load_dword v124, v7, s[4:7], s16 offen sc1
    s_add_u32 s31, s31, 1
    s_cmp_gt_u32 s31, 1048576
    s_cbranch_scc1 L_abort
    s_waitcnt vmcnt(0)
    s_branch L_fl_3
L_abort:
    s_endpgm
.section .rodata,"a"
.p2align 6
.amdhsa_kernel adaLN_cond__memory_aug_recurrent_mem_tr__geglu_ffn__prompt_kernel
  .amdhsa_next_free_vgpr 512
  .amdhsa_next_free_sgpr 102
  .amdhsa_accum_offset 256
  .amdhsa_group_segment_fixed_size 0
  .amdhsa_kernarg_size 128
  .amdhsa_user_sgpr_count 2
  .amdhsa_user_sgpr_kernarg_segment_ptr 1
  .amdhsa_system_sgpr_workgroup_id_x 1
  .amdhsa_float_denorm_mode_32 3
.end_amdhsa_kernel
```
